```python
import torch

def _softmax(x, axis=-1):
    return torch.softmax(x, dim=axis)

def _gelu(x):
    return torch.nn.functional.gelu(x, approximate='tanh')

def _silu(x):
    return torch.nn.functional.silu(x)

def _sigmoid(x):
    return torch.sigmoid(x)

def _layernorm(x, axis=-1, eps=1e-05):
    m = x.mean(dim=axis, keepdim=True)
    v = x.var(dim=axis, keepdim=True, unbiased=False)
    return (x - m) / torch.sqrt(v + eps)

def _scatter_add(tgt, idx, src, axis=0):
    return tgt.clone().index_add_(axis, idx, src)

def _segment_sum(src, seg, n):
    out = torch.zeros((n,) + src.shape[1:], dtype=src.dtype)
    return out.index_add_(0, seg, src)

def _pad(x, pw):
    flat = tuple((v for pair in reversed(pw) for v in pair))
    return torch.nn.functional.pad(x, flat)
kernel_name = 'adaLN_cond__ssm_conv_s4__glu_gated_reglu__prompt'

def setup_inputs():

    _w = lambda a: (lambda t: t.to(torch.bfloat16) if t.is_floating_point() else t)(torch.as_tensor(a))

    def _A_setup():
        B, L, D, N = (1, 2048, 448, 256)
        A_re = -(lambda _x: torch.exp(torch.as_tensor(_x)))((lambda *s: torch.randn(*s, dtype=torch.bfloat16) * 3.2)(D, N))
        A_im = torch.pi * (lambda *s: torch.randn(*s, dtype=torch.bfloat16) * 0.1)(D, N)
        B_re = (lambda *s: torch.randn(*s, dtype=torch.bfloat16) * 0.1)(D, N)
        B_im = (lambda *s: torch.randn(*s, dtype=torch.bfloat16) * 0.1)(D, N)
        C_re = (lambda *s: torch.randn(*s, dtype=torch.bfloat16) * 0.1)(D, N)
        C_im = (lambda *s: torch.randn(*s, dtype=torch.bfloat16) * 0.1)(D, N)
        log_dt = (lambda *s: torch.randn(*s, dtype=torch.bfloat16) * 0.1)(D) * 0.5 - 4.0
        Dskip = (lambda *s: torch.randn(*s, dtype=torch.bfloat16) * 0.1)(D)
        return {'u': _w((lambda *s: torch.randn(*s, dtype=torch.bfloat16) * 0.05)(B, L, D)), 'A_re': _w(A_re), 'A_im': _w(A_im), 'B_re': _w(B_re), 'B_im': _w(B_im), 'C_re': _w(C_re), 'C_im': _w(C_im), 'log_dt': _w(log_dt), 'Dskip': _w(Dskip)}
    _A_in = _A_setup()

    def _B_setup():
        B, S, D, F = (1, 2048, 448, 1792)
        return {'x': _w((lambda *s: torch.randn(*s, dtype=torch.bfloat16) * 0.05)(B, S, D)), 'W_gate': _w((lambda *s: torch.randn(*s, dtype=torch.bfloat16) * 1.6)(D, F) * (2.0 / D) ** 0.5), 'W_up': _w((lambda *s: torch.randn(*s, dtype=torch.bfloat16) * 1.6)(D, F) * (2.0 / D) ** 0.5), 'W_down': _w((lambda *s: torch.randn(*s, dtype=torch.bfloat16) * 1.6)(F, D) * (1.0 / F) ** 0.5)}
    _B_in = _B_setup()
    return {'A_u': _A_in['u'], 'A_A_re': _A_in['A_re'], 'A_A_im': _A_in['A_im'], 'A_B_re': _A_in['B_re'], 'A_B_im': _A_in['B_im'], 'A_C_re': _A_in['C_re'], 'A_C_im': _A_in['C_im'], 'A_log_dt': _A_in['log_dt'], 'A_Dskip': _A_in['Dskip'], 'B_x': _B_in['x'], 'B_W_gate': _B_in['W_gate'], 'B_W_up': _B_in['W_up'], 'B_W_down': _B_in['W_down'], 'c': _w((lambda *s: torch.randn(*s, dtype=torch.bfloat16) * 0.2)(1, 448) * 8.0), 'w_mod': _w((lambda *s: torch.randn(*s, dtype=torch.bfloat16) * 0.2)(448, 6 * 448) * 448 ** (-0.5) * 8.0)}

def reference(A_u, A_A_re, A_A_im, A_B_re, A_B_im, A_C_re, A_C_im, A_log_dt, A_Dskip, B_x, B_W_gate, B_W_up, B_W_down, c, w_mod):

    def _A_ref(u, A_re, A_im, B_re, B_im, C_re, C_im, log_dt, Dskip):
        Bsz, L, D = u.shape
        dt = torch.exp(log_dt)[:, None]
        A = A_re + 1j * A_im
        Bc = B_re + 1j * B_im
        Cc = C_re + 1j * C_im
        logdA = dt * A
        dB = dt * Bc
        l = (lambda x, dt: x.to(dt))(torch.arange(L), A_re.dtype)
        P = torch.exp(logdA[:, :, None] * l[None, None, :])
        K = torch.einsum('dn,dnl,dn->dl', Cc, P, dB).real
        L2 = 2 * L
        Kp = _pad(K, ((0, 0), (0, L)))
        up = (lambda x, *d: x.permute(*d))(u, 0, 2, 1)
        up = _pad(up, ((0, 0), (0, 0), (0, L)))
        Kf = (lambda x, axes=(-2, -1): torch.fft.rfft2(x.float(), dim=axes))(Kp[:, None, :], axes=(-2, -1))
        Uf = (lambda x, axes=(-2, -1): torch.fft.rfft2(x.float(), dim=axes))(up[:, :, None, :], axes=(-2, -1))
        Yf = Uf * Kf[None, :, :, :]
        y = (lambda x, s, axes=(-2, -1): torch.fft.irfft2(x, s=s, dim=axes).to(torch.bfloat16))(Yf, (1, L2), axes=(-2, -1))[:, :, 0, :L]
        y = (lambda x, *d: x.permute(*d))(y, 0, 2, 1) + u * Dskip[None, None, :]
        return y

    def _B_ref(x, W_gate, W_up, W_down):
        gate = torch.einsum('bsd,df->bsf', x, W_gate)
        up = torch.einsum('bsd,df->bsf', x, W_up)
        gate = gate * (lambda x, dt: x.to(dt))(gate > 0, gate.dtype)
        h = gate * up
        return torch.einsum('bsf,fd->bsd', h, W_down)
    x = A_u
    mod = (_silu(c) @ w_mod).reshape(c.shape[0], 6, 1, -1)
    sa, ca, ga, sb, cb, gb = (mod[:, 0].clone(), mod[:, 1].clone(), mod[:, 2].clone(), mod[:, 3].clone(), mod[:, 4].clone(), mod[:, 5].clone())
    h = _layernorm(x, axis=-1) * (1 + ca) + sa
    x = x + ga * _A_ref(h, A_A_re, A_A_im, A_B_re, A_B_im, A_C_re, A_C_im, A_log_dt, A_Dskip)
    h = _layernorm(x, axis=-1) * (1 + cb) + sb
    x = x + gb * _B_ref(h, B_W_gate, B_W_up, B_W_down)
    return x
```

```asm
; @launch grid=(256,1,1) block=(256,1,1) lds=163840
.amdgcn_target "amdgcn-amd-amdhsa--gfx950"
.text
.p2align 12
.p2align 8
.globl adaLN_cond__ssm_conv_s4__glu_gated_reglu__prompt_kernel
.type adaLN_cond__ssm_conv_s4__glu_gated_reglu__prompt_kernel,@function
adaLN_cond__ssm_conv_s4__glu_gated_reglu__prompt_kernel:
    s_cmp_ge_u32 s2, 256
    s_cbranch_scc1 kf_end
    s_load_dwordx2 s[8:9], s[0:1], 0
    s_load_dwordx16 s[24:39], s[0:1], 8
    s_load_dwordx2 s[56:57], s[0:1], 128
    s_memrealtime s[10:11]
    s_getpc_b64 s[6:7]
kf_pc0:
    s_lshl_b32 s3, s2, 9
    s_and_b32 s3, s3, 0xf000
    v_lshrrev_b32 v1, 3, v0
    v_lshl_add_u32 v1, v1, 7, s3
    v_min_u32 v1, code_end-kf_pc0-4, v1
    global_load_dword a252, v1, s[6:7]
    s_cmp_ge_u32 s2, 64
    s_cbranch_scc1 kf_heavy
    v_lshrrev_b32 v56, 3, v0
    v_and_b32 v57, 7, v0
    s_mul_i32 s6, s2, 0x2008
    s_lshr_b32 s3, s6, 8
    s_and_b32 s3, s3, 0x780
    s_and_b32 s6, s6, 24
    s_or_b32 s6, s6, s3
    v_and_b32 v1, 0x30, v0
    v_lshrrev_b32 v2, 6, v0
    v_add_lshl_u32 v1, v1, v2, 1
    v_and_b32 v2, 1, v56
    v_add3_u32 v1, v1, v2, s6
    v_mul_u32_u24 v1, 896, v1
    v_lshl_add_u32 v1, v57, 4, v1
    v_or_b32_e64 v2, s2, v0
    v_cmp_eq_u32 vcc, 0, v2
    s_waitcnt lgkmcnt(0)
    v_or_b32 v3, s10, 1
    s_and_saveexec_b64 s[12:13], vcc
    global_store_dword v2, v3, s[56:57] sc1
    s_mov_b64 exec, s[12:13]
    global_load_dwordx4 v[64:67], v1, s[8:9] offset:0 nt
    global_load_dwordx4 v[68:71], v1, s[8:9] offset:128 nt
    global_load_dwordx4 v[72:75], v1, s[8:9] offset:256 nt
    global_load_dwordx4 v[76:79], v1, s[8:9] offset:384 nt
    global_load_dwordx4 v[80:83], v1, s[8:9] offset:512 nt
    global_load_dwordx4 v[84:87], v1, s[8:9] offset:640 nt
    global_load_dwordx4 v[88:91], v1, s[8:9] offset:768 nt
kf_heavy:
    s_load_dwordx2 s[4:5], s[0:1], 136
    s_add_u32 s3, s2, 192
    s_and_b32 s90, s3, 0xe0
    s_and_b32 s6, s3, 7
    s_lshl_b32 s6, s6, 2
    s_or_b32 s90, s90, s6
    s_bfe_u32 s6, s3, 0x20003
    s_or_b32 s90, s90, s6
    v_lshrrev_b32 v1, 6, v0
    v_and_b32 v2, 63, v0
    v_readfirstlane_b32 s20, v1
    v_lshlrev_b32 v3, 4, v2
    v_lshlrev_b32_e64 v4, 4, v0
    s_cmp_lt_u32 s2, 64
    s_cbranch_scc1 kf_light
    s_load_dwordx4 s[48:51], s[0:1], 104
    s_load_dwordx4 s[40:43], s[0:1], 80
    s_add_u32 s91, s90, 256
    s_lshl_b32 s3, s90, 9
    v_lshl_add_u32 v72, v0, 1, s3
    s_lshl_b32 s3, s90, 1
    v_mov_b32_e64 v73, s3
    s_lshl_b32 s3, s91, 9
    v_lshl_add_u32 v168, v0, 1, s3
    s_lshl_b32 s3, s91, 1
    v_mov_b32 v169, s3
    s_waitcnt lgkmcnt(0)
    global_load_ushort v64, v72, s[24:25] nt
    global_load_ushort v65, v72, s[26:27] nt
    global_load_ushort v66, v72, s[28:29] nt
    global_load_ushort v67, v72, s[30:31] nt
    global_load_ushort v68, v72, s[32:33] nt
    global_load_ushort v69, v72, s[34:35] nt
    global_load_ushort v70, v73, s[36:37]
    global_load_ushort v71, v73, s[38:39]
    global_load_ushort v160, v168, s[24:25] nt
    global_load_ushort v161, v168, s[26:27] nt
    global_load_ushort v162, v168, s[28:29] nt
    global_load_ushort v163, v168, s[30:31] nt
    global_load_ushort v164, v168, s[32:33] nt
    global_load_ushort v165, v168, s[34:35] nt
    global_load_ushort v166, v169, s[36:37]
    global_load_ushort v167, v169, s[38:39]
    s_sub_u32 s8, 255, s2
    s_mul_i32 s9, s8, 49
    s_lshr_b32 s9, s9, 11
    s_mul_i32 s10, s9, 42
    s_sub_u32 s10, s8, s10
    s_min_u32 s9, s9, 3
    s_mul_i32 s54, s9, 112
    v_min_u32 v1, 111, v0
    v_add_lshl_u32 v57, v1, s54, 1
    global_load_ushort v150, v57, s[48:49]
    v_lshrrev_b32 v1, 3, v0
    v_mul_u32_u24 v1, 5376, v1
    v_and_b32_e64 v38, 7, v0
    v_lshl_add_u32 v38, v38, 4, v1
    s_mul_i32 s54, s54, 5376
    s_lshl_b32 s6, s10, 7
    s_add_u32 s54, s54, s6
    s_mul_i32 s52, s9, 21504
    s_lshl_b32 s6, s10, 9
    s_add_u32 s52, s52, s6
    s_lshl_b32 s6, s20, 7
    s_add_u32 s52, s52, s6
    s_add_u32 s52, s52, 2621440
    s_mov_b32 s48, s50
    s_mov_b32 s49, s51
    s_mov_b32 s51, 0x20000
    s_cmp_lt_u32 s8, 168
    s_cselect_b32 s50, 2408448, 0
    s_cselect_b32 s53, 0, 0x40000000
    s_sub_u32 s8, s2, 64
    s_bitcmp1_b32 s20, 1
    s_cselect_b32 s40, s42, s40
    s_cselect_b32 s41, s43, s41
    s_cmp_lt_u32 s8, 168
    s_cselect_b32 s42, 1605632, 0
    s_mov_b32 s43, 0x20000
    s_mul_i32 s6, s8, 171
    s_lshr_b32 s6, s6, 10
    s_mul_i32 s7, s6, 6
    s_sub_u32 s7, s8, s7
    s_mul_i32 s10, s7, 5
    s_lshl_b32 s7, s7, 2
    s_add_u32 s7, s7, 3
    s_min_u32 s7, s7, s10
    s_lshl_b32 s6, s6, 1
    s_and_b32 s10, s20, 1
    s_add_u32 s6, s6, s10
    s_mul_i32 s44, s7, 57344
    s_lshl_b32 s10, s6, 6
    s_add_u32 s44, s44, s10
    s_mov_b32 s45, 57344
    s_mul_i32 s46, s6, 57344
    s_lshl_b32 s7, s7, 1
    s_lshr_b32 s10, s20, 1
    s_add_u32 s7, s7, s10
    s_lshl_b32 s7, s7, 10
    s_add_u32 s46, s46, s7
    s_add_u32 s46, s46, 4194304
    s_mov_b32 s47, 2048
    v_bfe_u32 v24, v0, 2, 4
    v_mul_u32_u24 v24, 3584, v24
    v_and_b32 v2, 3, v0
    v_lshl_add_u32 v24, v2, 4, v24
    v_bfe_u32 v1, v0, 4, 2
    v_lshlrev_b32 v149, 4, v1
    v_bfe_u32 v2, v0, 2, 2
    v_lshl_add_u32 v1, v1, 3, v2
    v_and_b32 v2, 3, v0
    v_lshl_add_u32 v1, v1, 4, v2
    s_lshl_b32 s6, s20, 5
    s_add_u32 s6, s6, 143360
    v_lshl_add_u32 v148, v1, 3, s6
    s_mul_i32 s6, s20, 5120
    s_add_u32 s6, s6, 122880
    v_bfe_u32 v1, v0, 5, 1
    v_bfe_u32 v2, v0, 2, 2
    v_lshl_add_u32 v1, v1, 3, v2
    v_bfe_u32 v2, v0, 4, 1
    v_lshl_add_u32 v1, v1, 1, v2
    v_and_b32 v2, 3, v0
    v_lshl_add_u32 v1, v1, 2, v2
    v_lshl_add_u32 v56, v1, 3, s6
    v_mov_b32 v29, 0
    s_mov_b32 s84, s4
    s_mov_b32 s85, s5
    s_mov_b32 s86, 0x1c0000
    s_mov_b32 s87, 0x20000
    s_mov_b32 s18, 0x1c00000
    s_mov_b32 s19, 0x20000
    v_sub_u32 v36, 4080, v4
    v_lshrrev_b32 v57, 5, v0
    v_add_u32 v58, 1, v0
    v_lshrrev_b32_e64 v58, 5, v58
    v_cmp_le_u32_e64 s[24:25], 8, v58
    v_cmp_le_u32_e64 s[26:27], 7, v57
    v_cmp_le_u32_e64 s[28:29], 7, v58
    v_cmp_le_u32_e64 s[30:31], 6, v57
    v_cmp_le_u32_e64 s[32:33], 6, v58
    v_cmp_le_u32_e64 s[34:35], 4, v57
    v_cmp_le_u32_e64 s[36:37], 4, v58
    v_mov_b32 v40, 0x1000504
    v_mov_b32 v41, 0x1000100
    v_mov_b32 v42, 0x1000706
    v_mov_b32 v43, 0x5040504
    v_mov_b32 v44, 0x5040706
    v_mov_b32 v45, 0x1000302
    v_mov_b32 v46, 0xc0c0c0c
    v_and_b32 v59, 1, v0
    v_mul_u32_u24 v59, 0x202, v59
    v_lshlrev_b32 v59, 16, v59
    v_sub_u32 v47, 0x07060706, v59
    v_add_u32 v48, v44, v59
    s_lshl_b32 s94, s20, 8
    s_add_u32 s94, s94, 55808
    s_lshr_b32 s6, s20, 1
    s_and_b32 s7, s20, 1
    v_cndmask_b32_e64 v46, v45, v46, s[24:25]
    v_cndmask_b32_e64 v16, v40, v45, s[26:27]
    v_cndmask_b32_e64 v17, v41, v45, s[26:27]
    v_cndmask_b32_e64 v18, v42, v45, s[26:27]
    v_cndmask_b32_e64 v19, v41, v45, s[26:27]
    v_cndmask_b32_e64 v20, v40, v46, s[28:29]
    v_cndmask_b32_e64 v21, v41, v46, s[28:29]
    v_cndmask_b32_e64 v16, v43, v16, s[30:31]
    v_cndmask_b32_e64 v18, v44, v18, s[30:31]
    v_cndmask_b32_e64 v20, v43, v20, s[32:33]
    v_cndmask_b32_e64 v17, v47, v17, s[34:35]
    v_cndmask_b32_e64 v18, v43, v18, s[34:35]
    v_cndmask_b32_e64 v21, v48, v21, s[36:37]
    v_and_b32_e64 v61, 15, v0
    v_bfe_u32 v62, v0, 4, 2
    v_mul_u32_u24 v57, 2080, v61
    v_lshl_add_u32 v57, v62, 4, v57
    s_lshl_b32 s3, s6, 10
    s_add_u32 s3, s3, 76288
    v_add_u32 v26, s3, v57
    s_mul_i32 s15, s7, 33280
    s_sub_u32 s15, s15, 66560
    v_add_u32 v25, s15, v26
    s_mul_i32 s3, s6, 4608
    s_lshl_b32 s7, s7, 8
    s_add_u32 s3, s3, s7
    s_add_u32 s3, s3, 16
    v_lshl_add_u32 v62, v62, 6, s3
    v_lshlrev_b32 v57, 1, v61
    v_subrev_u32 v57, 8, v57
    v_lshlrev_b32 v60, 2, v61
    v_subrev_u32 v60, 32, v60
    v_max3_i32 v57, v61, v57, v60
    v_and_b32 v60, 7, v57
    v_lshrrev_b32 v57, 3, v57
    v_lshl_add_u32 v57, v57, 8, v60
    v_lshl_add_u32 v28, v57, 1, v62
    v_lshlrev_b32 v57, 9, v61
    v_min_u32 v57, 2050, v57
    v_add_u32 v27, v57, v62
    v_and_b32 v58, 31, v0
    v_bfe_u32 v59, v0, 5, 1
    v_lshrrev_b32 v61, 3, v0
    v_bfe_u32 v57, v0, 3, 2
    v_cmp_eq_u32 vcc, 3, v57
    s_nop 1
    v_addc_co_u32 v60, vcc, 0, v57, vcc
    v_mul_u32_u24 v60, 3584, v60
    v_and_b32 v63, 3, v0
    v_mul_u32_u24 v63, 21504, v63
    v_add_u32 v31, v60, v63
    v_lshrrev_b32 v63, 4, v0
    v_and_b32 v57, 15, v0
    v_lshrrev_b32 v60, 2, v0
    v_and_b32 v33, 0x30, v4
    v_lshl_add_u32 v32, v60, 8, v33
    v_lshrrev_b32 v60, 1, v0
    v_and_b32 v33, 16, v4
    v_mul_u32_u24 v60, 14336, v60
    v_add_u32 v33, v33, v60
    v_mul_u32_u24 v250, 320, v63
    v_lshl_add_u32 v250, v57, 2, v250
    s_lshl_b32 s6, s90, 5
    s_and_b32 s6, s6, 64
    v_and_b32 v14, 0x70, v4
    v_xor_b32 v14, s6, v14
    v_lshl_add_u32 v14, v61, 16, v14
    v_and_b32 v60, 3, v0
    v_mul_u32_u24 v60, 4160, v60
    v_add_u32 v60, 47104, v60
    v_bfe_u32 v57, v0, 2, 3
    v_lshl_add_u32 v37, v57, 4, v60
    v_lshlrev_b32 v63, 1, v59
    v_sub_u32 v57, v63, v57
    v_lshl_add_u32 v5, v57, 3, v60
    s_lshl_b32 s6, s20, 9
    s_sub_u32 s6, 1592, s6
    v_add_u32 v5, s6, v5
    s_lshl_b32 s6, s20, 3
    s_sub_u32 s6, 25, s6
    v_add_u32_e64 v6, s6, v58
    v_mul_u32_u24 v6, 80, v6
    v_lshl_add_u32 v6, v59, 4, v6
    v_add_u32 v249, 47104, v4
    v_and_b32 v57, 1, v0
    v_and_b32 v60, 1, v61
    v_lshl_or_b32 v57, v57, 1, v60
    v_mul_u32_u24 v57, 8224, v57
    v_and_b32 v60, 0x70, v0
    v_and_b32 v63, 6, v0
    v_and_b32 v62, 4, v0
    v_add_lshl_u32 v63, v63, v62, 6
    s_lshr_b32 s6, s20, 1
    s_lshl_b32 s6, s6, 12
    s_add_u32 s6, s6, 98304
    v_add3_u32 v12, v57, v60, v63
    v_add_u32 v12, s6, v12
    v_bfe_u32 v57, v0, 3, 2
    v_lshl_add_u32 v15, v57, 2, v4
    v_mov_b32 v252, -1
    v_mov_b32 v253, -1
    v_mov_b32 v254, -1
    v_mov_b32 v255, -1
    s_sub_u32 s3, s2, 32
    s_and_b32 s3, s3, 255
    s_and_b32 s6, s3, 7
    s_lshr_b32 s7, s3, 3
    s_mul_i32 s15, s7, 37
    s_lshr_b32 s15, s15, 8
    s_mul_i32 s12, s15, 7
    s_sub_u32 s12, s7, s12
    s_lshr_b32 s13, s6, 1
    s_lshl_b32 s13, s13, 2
    s_add_u32 s13, s13, s15
    s_and_b32 s14, s6, 1
    s_mul_i32 s15, s14, 7
    s_add_u32 s15, s15, s12
    s_lshl1_add_u32 s21, s13, s14
    s_lshl_b32 s21, s21, 16
    s_mul_i32 s6, s20, 0x1400
    s_and_b32 s6, s6, 0x2400
    s_add_u32 s21, s21, s6
    s_add_u32 s21, s21, 8388608
    s_lshl_b32 s22, s15, 2
    s_add_u32 s22, s22, s20
    s_mul_i32 s23, s22, 57344
    s_add_u32 s23, s23, 4194304
    s_lshl_b32 s25, s20, 10
    s_lshl_b32 s26, s90, 5
    s_lshl_b32 s38, s90, 3
    s_add_u32 s38, s38, 2621440
    s_lshl_b32 s30, s91, 5
    s_lshl_b32 s39, s91, 3
    s_add_u32 s39, s39, 2621440
    s_mov_b32 s8, 2490368
    s_and_b32 s101, s90, 0x8f
    s_lshl_b32 s101, s101, 7
    s_and_b32 s6, s90, 0x60
    s_lshl_b32 s6, s6, 6
    s_add_u32 s101, s101, s6
    s_and_b32 s6, s90, 16
    s_lshl_b32 s6, s6, 9
    s_add_u32 s101, s101, s6
    v_mov_b32 v60, 0
    v_mov_b32 v61, 0
    v_mov_b32 v62, 0
    v_mov_b32 v63, 0
    s_mov_b32 s9, 0x3fb8aa3b
    s_mov_b32 s10, 0x32a57060
    s_mov_b32 s11, 0x3f317218
    s_lshr_b32 s3, s22, 1
    s_mul_i32 s3, s3, 3072
    s_and_b32 s6, s22, 1
    s_lshl_b32 s6, s6, 7
    s_add_u32 s3, s3, s6
    s_add_u32 s3, s3, 2916352
    v_min_u32 v245, 176, v3
    v_lshl_add_u32 v245, v245, 4, s3
    s_lshl_b32 s6, s20, 10
    s_add_u32 m0, s6, 143360
    s_nop 0
    buffer_load_dwordx4 v38, s[48:51], s54 offen lds
    s_add_u32 m0, s6, 147456
    s_add_u32 s54, s54, 172032
    buffer_load_dwordx4 v38, s[48:51], s54 offen lds
    s_add_u32 m0, s6, 151552
    s_add_u32 s54, s54, 172032
    buffer_load_dwordx4 v38, s[48:51], s54 offen lds
    s_add_u32 m0, s6, 155648
    s_add_u32 s54, s54, 172032
    buffer_load_dwordx4 v38, s[48:51], s54 offen lds
    s_cmp_eq_u32 s20, 0
    s_cbranch_scc1 pg0_h
    s_cmp_eq_u32 s20, 1
    s_cbranch_scc1 pg1_h
    s_cmp_eq_u32 s20, 2
    s_cbranch_scc1 pg2_h
    s_branch pg4_h
    s_nop 0
wh_ret:
    s_waitcnt vmcnt(5)
    global_load_dword v30, v29, s[56:57] sc1
    s_mov_b32 m0, s94
    v_lshlrev_b32 v64, 16, v64
    v_lshlrev_b32 v160, 16, v160
    v_lshlrev_b32 v65, 16, v65
    v_lshlrev_b32 v161, 16, v161
    v_lshlrev_b32 v66, 16, v66
    v_lshlrev_b32 v162, 16, v162
    v_lshlrev_b32 v67, 16, v67
    v_lshlrev_b32 v163, 16, v163
    v_lshlrev_b32 v68, 16, v68
    v_lshlrev_b32 v164, 16, v164
    v_lshlrev_b32 v69, 16, v69
    v_lshlrev_b32 v165, 16, v165
    v_lshlrev_b32 v70, 16, v70
    v_lshlrev_b32 v166, 16, v166
    v_readfirstlane_b32 s88, v71
    v_readfirstlane_b32 s89, v167
    v_mul_f32 v72, s9, v70
    v_mul_f32 v168, s9, v166
    v_fma_f32 v73, v70, s9, -v72
    v_fma_f32 v169, v166, s9, -v168
    v_fma_f32 v73, v70, s10, v73
    v_fma_f32 v169, v166, s10, v169
    v_exp_f32 v72, v72
    v_exp_f32 v168, v168
    v_mul_f32 v73, s11, v73
    v_mul_f32 v169, s11, v169
    v_fma_f32 v70, v72, v73, v72
    v_fma_f32 v166, v168, v169, v168
    v_cvt_pk_bf16_f32 v70, 0, v70
    v_cvt_pk_bf16_f32 v166, 0, v166
    s_lshl_b32 s88, s88, 16
    s_lshl_b32 s89, s89, 16
    v_pk_mul_f32 v[64:65], v[70:71], v[64:65] op_sel:[0,0] op_sel_hi:[0,1]
    v_pk_mul_f32 v[160:161], v[166:167], v[160:161] op_sel:[0,0] op_sel_hi:[0,1]
    v_pk_mul_f32 v[66:67], v[70:71], v[66:67] op_sel:[0,0] op_sel_hi:[0,1]
    v_pk_mul_f32 v[162:163], v[166:167], v[162:163] op_sel:[0,0] op_sel_hi:[0,1]
    v_mul_f32 v64, s9, v64
    v_mul_f32 v160, s9, v160
    v_mul_f32 v65, 0.15915494309189532, v65
    v_mul_f32 v161, 0.15915494309189532, v161
    v_exp_f32 v72, v64
    v_exp_f32 v168, v160
    v_fract_f32 v73, v65
    v_fract_f32 v169, v161
    v_cos_f32 v74, v73
    v_cos_f32 v170, v169
    v_sin_f32 v75, v73
    v_sin_f32 v171, v169
    v_pk_mul_f32 v[106:107], v[72:73], v[74:75] op_sel:[0,0] op_sel_hi:[0,1] neg_hi:[1,0]
    v_pk_mul_f32 v[202:203], v[168:169], v[170:171] op_sel:[0,0] op_sel_hi:[0,1] neg_hi:[1,0]
    v_pk_mul_f32 v[80:81], v[68:69], v[66:67] op_sel:[0,0] op_sel_hi:[0,1] neg_hi:[1,0]
    v_pk_mul_f32 v[176:177], v[164:165], v[162:163] op_sel:[0,0] op_sel_hi:[0,1] neg_hi:[1,0]
    v_pk_fma_f32 v[80:81], v[68:69], v[66:67], v[80:81] op_sel:[1,1,0] op_sel_hi:[1,0,1] neg_lo:[1,0,0] neg_hi:[1,0,0]
    v_pk_fma_f32 v[176:177], v[164:165], v[162:163], v[176:177] op_sel:[1,1,0] op_sel_hi:[1,0,1] neg_lo:[1,0,0] neg_hi:[1,0,0]
    v_pk_mul_f32 v[98:99], v[106:107], v[106:107] op_sel:[0,0] op_sel_hi:[1,0]
    v_pk_mul_f32 v[194:195], v[202:203], v[202:203] op_sel:[0,0] op_sel_hi:[1,0]
    v_pk_fma_f32 v[110:111], v[106:107], v[106:107], v[98:99] op_sel:[1,1,0] op_sel_hi:[0,1,1] neg_lo:[1,0,0]
    v_pk_fma_f32 v[206:207], v[202:203], v[202:203], v[194:195] op_sel:[1,1,0] op_sel_hi:[0,1,1] neg_lo:[1,0,0]
    v_pk_mul_f32 v[100:101], v[80:81], v[106:107] op_sel:[0,0] op_sel_hi:[1,0]
    v_pk_mul_f32 v[196:197], v[176:177], v[202:203] op_sel:[0,0] op_sel_hi:[1,0]
    s_mul_i32 s6, s20, 5120
    s_add_u32 m0, s6, 122880
    s_nop 0
    buffer_load_dwordx4 v24, s[40:43], s44 offen lds
    s_add_u32 m0, s6, 123904
    s_add_u32 s44, s44, s45
    buffer_load_dwordx4 v24, s[40:43], s44 offen lds
    s_add_u32 m0, s6, 124928
    s_add_u32 s44, s44, s45
    buffer_load_dwordx4 v24, s[40:43], s44 offen lds
    s_add_u32 m0, s6, 125952
    s_add_u32 s44, s44, s45
    buffer_load_dwordx4 v24, s[40:43], s44 offen lds
    s_add_u32 m0, s6, 126976
    s_add_u32 s44, s44, s45
    buffer_load_dwordx4 v24, s[40:43], s44 offen lds
    s_mov_b32 m0, s94
    s_cmp_lt_u32 s2, 232
    s_cselect_b32 s42, 0x1c00000, 0
    v_pk_fma_f32 v[82:83], v[80:81], v[106:107], v[100:101] op_sel:[1,1,0] op_sel_hi:[0,1,1] neg_lo:[1,0,0]
    v_pk_fma_f32 v[178:179], v[176:177], v[202:203], v[196:197] op_sel:[1,1,0] op_sel_hi:[0,1,1] neg_lo:[1,0,0]
    v_cvt_pk_bf16_f32 v76, v80, v81
    v_cvt_pk_bf16_f32 v172, v176, v177
    ds_write_addtid_b32 v76 offset:20480
    ds_write_addtid_b32 v172 offset:21504
    v_mul_f32 v72, 0x43800000, v64
    v_mul_f32 v168, 0x43800000, v160
    v_mul_f32 v73, 0x43800000, v65
    v_mul_f32 v169, 0x43800000, v161
    v_exp_f32 v72, v72
    v_exp_f32 v168, v168
    v_fract_f32 v73, v73
    v_fract_f32 v169, v169
    v_cos_f32 v74, v73
    v_cos_f32 v170, v169
    v_sin_f32 v75, v73
    v_sin_f32 v171, v169
    v_pk_mul_f32 v[108:109], v[72:73], v[74:75] op_sel:[0,0] op_sel_hi:[0,1] neg_hi:[1,0]
    v_pk_mul_f32 v[204:205], v[168:169], v[170:171] op_sel:[0,0] op_sel_hi:[0,1] neg_hi:[1,0]
    v_pk_mul_f32 v[102:103], v[80:81], v[110:111] op_sel:[0,0] op_sel_hi:[1,0]
    v_pk_mul_f32 v[198:199], v[176:177], v[206:207] op_sel:[0,0] op_sel_hi:[1,0]
    v_pk_fma_f32 v[84:85], v[80:81], v[110:111], v[102:103] op_sel:[1,1,0] op_sel_hi:[0,1,1] neg_lo:[1,0,0]
    v_pk_fma_f32 v[180:181], v[176:177], v[206:207], v[198:199] op_sel:[1,1,0] op_sel_hi:[0,1,1] neg_lo:[1,0,0]
    v_cvt_pk_bf16_f32 v77, v82, v83
    v_cvt_pk_bf16_f32 v173, v178, v179
    ds_write_addtid_b32 v77 offset:22560
    ds_write_addtid_b32 v173 offset:23584
    v_pk_mul_f32 v[104:105], v[82:83], v[110:111] op_sel:[0,0] op_sel_hi:[1,0]
    v_pk_mul_f32 v[200:201], v[178:179], v[206:207] op_sel:[0,0] op_sel_hi:[1,0]
    v_pk_fma_f32 v[86:87], v[82:83], v[110:111], v[104:105] op_sel:[1,1,0] op_sel_hi:[0,1,1] neg_lo:[1,0,0]
    v_pk_fma_f32 v[182:183], v[178:179], v[206:207], v[200:201] op_sel:[1,1,0] op_sel_hi:[0,1,1] neg_lo:[1,0,0]
    v_cvt_pk_bf16_f32 v78, v84, v85
    v_cvt_pk_bf16_f32 v174, v180, v181
    ds_write_addtid_b32 v78 offset:24640
    ds_write_addtid_b32 v174 offset:25664
    v_pk_mul_f32 v[98:99], v[84:85], v[110:111] op_sel:[0,0] op_sel_hi:[1,0]
    v_pk_mul_f32 v[194:195], v[180:181], v[206:207] op_sel:[0,0] op_sel_hi:[1,0]
    v_pk_fma_f32 v[88:89], v[84:85], v[110:111], v[98:99] op_sel:[1,1,0] op_sel_hi:[0,1,1] neg_lo:[1,0,0]
    v_pk_fma_f32 v[184:185], v[180:181], v[206:207], v[194:195] op_sel:[1,1,0] op_sel_hi:[0,1,1] neg_lo:[1,0,0]
    s_waitcnt vmcnt(10)
    v_lshlrev_b32 v150, 16, v150
    v_cvt_pk_bf16_f32 v79, v86, v87
    v_mul_f32 v1, 0xbfb8aa3b, v150
    v_cvt_pk_bf16_f32 v175, v182, v183
    v_exp_f32_e64 v1, v1
    ds_write_addtid_b32 v79 offset:26720
    v_cmp_gt_u32 vcc, 112, v0
    ds_write_addtid_b32 v175 offset:27744
    v_add_f32 v1, 1.0, v1
    v_pk_mul_f32 v[100:101], v[86:87], v[110:111] op_sel:[0,0] op_sel_hi:[1,0]
    v_rcp_f32 v1, v1
    v_pk_mul_f32 v[196:197], v[182:183], v[206:207] op_sel:[0,0] op_sel_hi:[1,0]
    v_lshlrev_b32 v2, 1, v0
    v_pk_fma_f32 v[90:91], v[86:87], v[110:111], v[100:101] op_sel:[1,1,0] op_sel_hi:[0,1,1] neg_lo:[1,0,0]
    v_mul_f32 v1, v150, v1
    v_pk_fma_f32 v[186:187], v[182:183], v[206:207], v[196:197] op_sel:[1,1,0] op_sel_hi:[0,1,1] neg_lo:[1,0,0]
    v_cvt_pk_bf16_f32 v1, v1, v1
    v_cvt_pk_bf16_f32 v76, v88, v89
    v_cndmask_b32_e64 v1, 0, v1, vcc
    v_cvt_pk_bf16_f32 v172, v184, v185
    ds_write_b16 v2, v1 offset:9216
    ds_write_addtid_b32 v76 offset:28800
    ds_write_addtid_b32 v172 offset:29824
    v_pk_mul_f32 v[102:103], v[88:89], v[110:111] op_sel:[0,0] op_sel_hi:[1,0]
    v_pk_mul_f32 v[198:199], v[184:185], v[206:207] op_sel:[0,0] op_sel_hi:[1,0]
    v_pk_fma_f32 v[92:93], v[88:89], v[110:111], v[102:103] op_sel:[1,1,0] op_sel_hi:[0,1,1] neg_lo:[1,0,0]
    v_pk_fma_f32 v[188:189], v[184:185], v[206:207], v[198:199] op_sel:[1,1,0] op_sel_hi:[0,1,1] neg_lo:[1,0,0]
    v_cvt_pk_bf16_f32 v77, v90, v91
    v_cvt_pk_bf16_f32 v173, v186, v187
    ds_write_addtid_b32 v77 offset:30880
    ds_write_addtid_b32 v173 offset:31904
    v_pk_mul_f32 v[104:105], v[90:91], v[110:111] op_sel:[0,0] op_sel_hi:[1,0]
    v_pk_mul_f32 v[200:201], v[186:187], v[206:207] op_sel:[0,0] op_sel_hi:[1,0]
    v_pk_fma_f32 v[94:95], v[90:91], v[110:111], v[104:105] op_sel:[1,1,0] op_sel_hi:[0,1,1] neg_lo:[1,0,0]
    v_pk_fma_f32 v[190:191], v[186:187], v[206:207], v[200:201] op_sel:[1,1,0] op_sel_hi:[0,1,1] neg_lo:[1,0,0]
    v_cvt_pk_bf16_f32 v78, v92, v93
    v_cvt_pk_bf16_f32 v174, v188, v189
    ds_write_addtid_b32 v78 offset:32960
    ds_write_addtid_b32 v174 offset:33984
    v_pk_mul_f32 v[98:99], v[80:81], v[108:109] op_sel:[0,0] op_sel_hi:[1,0]
    v_pk_mul_f32 v[194:195], v[176:177], v[204:205] op_sel:[0,0] op_sel_hi:[1,0]
    v_pk_fma_f32 v[112:113], v[80:81], v[108:109], v[98:99] op_sel:[1,1,0] op_sel_hi:[0,1,1] neg_lo:[1,0,0]
    v_pk_fma_f32 v[208:209], v[176:177], v[204:205], v[194:195] op_sel:[1,1,0] op_sel_hi:[0,1,1] neg_lo:[1,0,0]
    v_cvt_pk_bf16_f32 v79, v94, v95
    v_cvt_pk_bf16_f32 v175, v190, v191
    ds_write_addtid_b32 v79 offset:35040
    ds_write_addtid_b32 v175 offset:36064
    v_pk_mul_f32 v[100:101], v[84:85], v[108:109] op_sel:[0,0] op_sel_hi:[1,0]
    v_pk_mul_f32 v[196:197], v[180:181], v[204:205] op_sel:[0,0] op_sel_hi:[1,0]
    v_pk_fma_f32 v[114:115], v[84:85], v[108:109], v[100:101] op_sel:[1,1,0] op_sel_hi:[0,1,1] neg_lo:[1,0,0]
    v_pk_fma_f32 v[210:211], v[180:181], v[204:205], v[196:197] op_sel:[1,1,0] op_sel_hi:[0,1,1] neg_lo:[1,0,0]
    v_cvt_pk_bf16_f32 v76, v112, v113
    v_cvt_pk_bf16_f32 v172, v208, v209
    ds_write_addtid_b32 v76 offset:37120
    ds_write_addtid_b32 v172 offset:38144
    v_pk_mul_f32 v[102:103], v[88:89], v[108:109] op_sel:[0,0] op_sel_hi:[1,0]
    v_pk_mul_f32 v[198:199], v[184:185], v[204:205] op_sel:[0,0] op_sel_hi:[1,0]
    v_pk_fma_f32 v[116:117], v[88:89], v[108:109], v[102:103] op_sel:[1,1,0] op_sel_hi:[0,1,1] neg_lo:[1,0,0]
    v_pk_fma_f32 v[212:213], v[184:185], v[204:205], v[198:199] op_sel:[1,1,0] op_sel_hi:[0,1,1] neg_lo:[1,0,0]
    v_cvt_pk_bf16_f32 v77, v114, v115
    v_cvt_pk_bf16_f32 v173, v210, v211
    ds_write_addtid_b32 v77 offset:39200
    ds_write_addtid_b32 v173 offset:40224
    v_pk_mul_f32 v[104:105], v[92:93], v[108:109] op_sel:[0,0] op_sel_hi:[1,0]
    v_pk_mul_f32 v[200:201], v[188:189], v[204:205] op_sel:[0,0] op_sel_hi:[1,0]
    v_pk_fma_f32 v[118:119], v[92:93], v[108:109], v[104:105] op_sel:[1,1,0] op_sel_hi:[0,1,1] neg_lo:[1,0,0]
    v_pk_fma_f32 v[214:215], v[188:189], v[204:205], v[200:201] op_sel:[1,1,0] op_sel_hi:[0,1,1] neg_lo:[1,0,0]
    v_cvt_pk_bf16_f32 v78, v116, v117
    v_cvt_pk_bf16_f32 v174, v212, v213
    ds_write_addtid_b32 v78 offset:41280
    ds_write_addtid_b32 v174 offset:42304
    v_pk_mul_f32 v[98:99], v[112:113], v[108:109] op_sel:[0,0] op_sel_hi:[1,0]
    v_pk_mul_f32 v[194:195], v[208:209], v[204:205] op_sel:[0,0] op_sel_hi:[1,0]
    v_pk_fma_f32 v[120:121], v[112:113], v[108:109], v[98:99] op_sel:[1,1,0] op_sel_hi:[0,1,1] neg_lo:[1,0,0]
    v_pk_fma_f32 v[216:217], v[208:209], v[204:205], v[194:195] op_sel:[1,1,0] op_sel_hi:[0,1,1] neg_lo:[1,0,0]
    v_cvt_pk_bf16_f32 v79, v118, v119
    v_cvt_pk_bf16_f32 v175, v214, v215
    ds_write_addtid_b32 v79 offset:43360
    ds_write_addtid_b32 v175 offset:44384
    v_pk_mul_f32 v[100:101], v[116:117], v[108:109] op_sel:[0,0] op_sel_hi:[1,0]
    v_pk_mul_f32 v[196:197], v[212:213], v[204:205] op_sel:[0,0] op_sel_hi:[1,0]
    v_pk_fma_f32 v[122:123], v[116:117], v[108:109], v[100:101] op_sel:[1,1,0] op_sel_hi:[0,1,1] neg_lo:[1,0,0]
    v_pk_fma_f32 v[218:219], v[212:213], v[204:205], v[196:197] op_sel:[1,1,0] op_sel_hi:[0,1,1] neg_lo:[1,0,0]
    v_cvt_pk_bf16_f32 v76, v120, v121
    v_cvt_pk_bf16_f32 v172, v216, v217
    ds_write_addtid_b32 v76 offset:45440
    ds_write_addtid_b32 v172 offset:46464
    v_pk_mul_f32 v[102:103], v[120:121], v[108:109] op_sel:[0,0] op_sel_hi:[1,0]
    v_pk_mul_f32 v[198:199], v[216:217], v[204:205] op_sel:[0,0] op_sel_hi:[1,0]
    v_pk_fma_f32 v[80:81], v[120:121], v[108:109], v[102:103] op_sel:[1,1,0] op_sel_hi:[0,1,1] neg_lo:[1,0,0]
    v_pk_fma_f32 v[176:177], v[216:217], v[204:205], v[198:199] op_sel:[1,1,0] op_sel_hi:[0,1,1] neg_lo:[1,0,0]
    v_cvt_pk_bf16_f32 v77, v122, v123
    v_cvt_pk_bf16_f32 v173, v218, v219
    ds_write_addtid_b32 v77 offset:47520
    ds_write_addtid_b32 v173 offset:48544
    v_pk_mul_f32 v[104:105], v[122:123], v[108:109] op_sel:[0,0] op_sel_hi:[1,0]
    v_pk_mul_f32 v[200:201], v[218:219], v[204:205] op_sel:[0,0] op_sel_hi:[1,0]
    v_pk_fma_f32 v[82:83], v[122:123], v[108:109], v[104:105] op_sel:[1,1,0] op_sel_hi:[0,1,1] neg_lo:[1,0,0]
    v_pk_fma_f32 v[178:179], v[218:219], v[204:205], v[200:201] op_sel:[1,1,0] op_sel_hi:[0,1,1] neg_lo:[1,0,0]
    v_cvt_pk_bf16_f32 v78, v80, v81
    v_cvt_pk_bf16_f32 v174, v176, v177
    ds_write_addtid_b32 v78 offset:49600
    ds_write_addtid_b32 v174 offset:50624
    v_pk_mul_f32 v[98:99], v[80:81], v[108:109] op_sel:[0,0] op_sel_hi:[1,0]
    v_pk_mul_f32 v[194:195], v[176:177], v[204:205] op_sel:[0,0] op_sel_hi:[1,0]
    v_pk_fma_f32 v[84:85], v[80:81], v[108:109], v[98:99] op_sel:[1,1,0] op_sel_hi:[0,1,1] neg_lo:[1,0,0]
    v_pk_fma_f32 v[180:181], v[176:177], v[204:205], v[194:195] op_sel:[1,1,0] op_sel_hi:[0,1,1] neg_lo:[1,0,0]
    v_mul_f32 v72, 0x41000000, v64
    v_mul_f32 v168, 0x41000000, v160
    v_mul_f32 v73, 0x41000000, v65
    v_mul_f32 v169, 0x41000000, v161
    v_exp_f32 v72, v72
    v_exp_f32 v168, v168
    v_fract_f32 v73, v73
    v_fract_f32 v169, v169
    v_cos_f32 v74, v73
    v_cos_f32 v170, v169
    v_sin_f32 v75, v73
    v_sin_f32 v171, v169
    v_pk_mul_f32 v[126:127], v[72:73], v[74:75] op_sel:[0,0] op_sel_hi:[0,1]
    v_pk_mul_f32 v[222:223], v[168:169], v[170:171] op_sel:[0,0] op_sel_hi:[0,1]
    v_cvt_pk_bf16_f32 v79, v82, v83
    v_cvt_pk_bf16_f32 v175, v178, v179
    ds_write_addtid_b32 v79 offset:51680
    ds_write_addtid_b32 v175 offset:52704
    v_pk_mul_f32 v[100:101], v[84:85], v[108:109] op_sel:[0,0] op_sel_hi:[1,0]
    v_pk_mul_f32 v[196:197], v[180:181], v[204:205] op_sel:[0,0] op_sel_hi:[1,0]
    v_pk_fma_f32 v[86:87], v[84:85], v[108:109], v[100:101] op_sel:[1,1,0] op_sel_hi:[0,1,1] neg_lo:[1,0,0]
    v_pk_fma_f32 v[182:183], v[180:181], v[204:205], v[196:197] op_sel:[1,1,0] op_sel_hi:[0,1,1] neg_lo:[1,0,0]
    v_mov_b32 v124, 1.0
    v_mov_b32 v220, 1.0
    v_mov_b32 v125, 0
    v_mov_b32 v221, 0
    s_branch pg0_s
.p2align 12
pg0_h:
    s_branch pg5_h
pg0_l:
    s_endpgm
pg0_s:
    v_cvt_pk_bf16_f32 v76, v84, v85
    v_cvt_pk_bf16_f32 v172, v180, v181
    ds_write_addtid_b32 v76 offset:53760
    ds_write_addtid_b32 v172 offset:54784
    v_pk_mul_f32 v[102:103], v[86:87], v[108:109] op_sel:[0,0] op_sel_hi:[1,0]
    v_pk_mul_f32 v[198:199], v[182:183], v[204:205] op_sel:[0,0] op_sel_hi:[1,0]
    v_pk_fma_f32 v[88:89], v[86:87], v[108:109], v[102:103] op_sel:[1,1,0] op_sel_hi:[0,1,1] neg_lo:[1,0,0]
    v_pk_fma_f32 v[184:185], v[182:183], v[204:205], v[198:199] op_sel:[1,1,0] op_sel_hi:[0,1,1] neg_lo:[1,0,0]
    v_pk_mul_f32 v[72:73], v[126:127], v[126:127] op_sel:[0,0] op_sel_hi:[1,0]
    v_pk_mul_f32 v[168:169], v[222:223], v[222:223] op_sel:[0,0] op_sel_hi:[1,0]
    v_pk_fma_f32 v[128:129], v[126:127], v[126:127], v[72:73] op_sel:[1,1,0] op_sel_hi:[0,1,1] neg_lo:[1,0,0]
    v_pk_fma_f32 v[224:225], v[222:223], v[222:223], v[168:169] op_sel:[1,1,0] op_sel_hi:[0,1,1] neg_lo:[1,0,0]
    v_cvt_pk_bf16_f32 v77, v86, v87
    v_cvt_pk_bf16_f32 v173, v182, v183
    ds_write_addtid_b32 v77 offset:55840
    ds_write_addtid_b32 v173 offset:56864
    v_pk_mul_f32 v[104:105], v[88:89], v[108:109] op_sel:[0,0] op_sel_hi:[1,0]
    v_pk_mul_f32 v[200:201], v[184:185], v[204:205] op_sel:[0,0] op_sel_hi:[1,0]
    v_pk_fma_f32 v[90:91], v[88:89], v[108:109], v[104:105] op_sel:[1,1,0] op_sel_hi:[0,1,1] neg_lo:[1,0,0]
    v_pk_fma_f32 v[186:187], v[184:185], v[204:205], v[200:201] op_sel:[1,1,0] op_sel_hi:[0,1,1] neg_lo:[1,0,0]
    v_pk_mul_f32 v[72:73], v[128:129], v[126:127] op_sel:[0,0] op_sel_hi:[1,0]
    v_pk_mul_f32 v[168:169], v[224:225], v[222:223] op_sel:[0,0] op_sel_hi:[1,0]
    v_pk_fma_f32 v[130:131], v[128:129], v[126:127], v[72:73] op_sel:[1,1,0] op_sel_hi:[0,1,1] neg_lo:[1,0,0]
    v_pk_fma_f32 v[226:227], v[224:225], v[222:223], v[168:169] op_sel:[1,1,0] op_sel_hi:[0,1,1] neg_lo:[1,0,0]
    v_cvt_pk_bf16_f32 v78, v88, v89
    v_cvt_pk_bf16_f32 v174, v184, v185
    ds_write_addtid_b32 v78 offset:57920
    ds_write_addtid_b32 v174 offset:58944
    v_pk_mul_f32 v[98:99], v[90:91], v[108:109] op_sel:[0,0] op_sel_hi:[1,0]
    v_pk_mul_f32 v[194:195], v[186:187], v[204:205] op_sel:[0,0] op_sel_hi:[1,0]
    v_pk_fma_f32 v[92:93], v[90:91], v[108:109], v[98:99] op_sel:[1,1,0] op_sel_hi:[0,1,1] neg_lo:[1,0,0]
    v_pk_fma_f32 v[188:189], v[186:187], v[204:205], v[194:195] op_sel:[1,1,0] op_sel_hi:[0,1,1] neg_lo:[1,0,0]
    v_pk_mul_f32 v[74:75], v[128:129], v[128:129] op_sel:[0,0] op_sel_hi:[1,0]
    v_pk_mul_f32 v[170:171], v[224:225], v[224:225] op_sel:[0,0] op_sel_hi:[1,0]
    v_pk_fma_f32 v[96:97], v[128:129], v[128:129], v[74:75] op_sel:[1,1,0] op_sel_hi:[0,1,1] neg_lo:[1,0,0]
    v_pk_fma_f32 v[192:193], v[224:225], v[224:225], v[170:171] op_sel:[1,1,0] op_sel_hi:[0,1,1] neg_lo:[1,0,0]
    v_cvt_pk_bf16_f32 v79, v90, v91
    v_cvt_pk_bf16_f32 v175, v186, v187
    ds_write_addtid_b32 v79 offset:60000
    ds_write_addtid_b32 v175 offset:61024
    v_cvt_pk_bf16_f32 v76, v92, v93
    v_cvt_pk_bf16_f32 v172, v188, v189
    ds_write_addtid_b32 v76 offset:62080
    ds_write_addtid_b32 v172 offset:63104
    s_sub_u32 m0, s94, 46080
    s_waitcnt vmcnt(6) lgkmcnt(0)
    s_barrier
    v_cvt_pk_bf16_f32 v106, v124, v125
    ds_read_b128 a[192:195], v149 offset:9216
    v_cvt_pk_bf16_f32 v202, v220, v221
    ds_read_b64_tr_b16 a[196:197], v148 offset:0
    v_pk_mul_f32 v[98:99], v[124:125], v[96:97] op_sel:[0,0] op_sel_hi:[1,0]
    ds_read_b64_tr_b16 a[198:199], v148 offset:512
    v_pk_mul_f32 v[194:195], v[220:221], v[192:193] op_sel:[0,0] op_sel_hi:[1,0]
    ds_read_b128 a[200:203], v149 offset:9280
    v_pk_fma_f32 v[80:81], v[124:125], v[96:97], v[98:99] op_sel:[1,1,0] op_sel_hi:[0,1,1] neg_lo:[1,0,0]
    ds_read_b64_tr_b16 a[204:205], v148 offset:4096
    v_pk_fma_f32 v[176:177], v[220:221], v[192:193], v[194:195] op_sel:[1,1,0] op_sel_hi:[0,1,1] neg_lo:[1,0,0]
    ds_read_b64_tr_b16 a[206:207], v148 offset:4608
    ds_write_addtid_b32 v106 offset:0
    ds_read_b128 a[208:211], v149 offset:9344
    ds_write_addtid_b32 v202 offset:1024
    ds_read_b64_tr_b16 a[212:213], v148 offset:8192
    v_cvt_pk_bf16_f32 v107, v126, v127
    ds_read_b64_tr_b16 a[214:215], v148 offset:8704
    v_cvt_pk_bf16_f32 v203, v222, v223
    ds_read_b128 a[216:219], v149 offset:9408
    v_pk_mul_f32 v[100:101], v[126:127], v[96:97] op_sel:[0,0] op_sel_hi:[1,0]
    ds_read_b64_tr_b16 a[220:221], v148 offset:12288
    v_pk_mul_f32 v[196:197], v[222:223], v[192:193] op_sel:[0,0] op_sel_hi:[1,0]
    ds_read_b64_tr_b16 a[222:223], v148 offset:12800
    v_pk_fma_f32 v[82:83], v[126:127], v[96:97], v[100:101] op_sel:[1,1,0] op_sel_hi:[0,1,1] neg_lo:[1,0,0]
    v_pk_fma_f32 v[178:179], v[222:223], v[192:193], v[196:197] op_sel:[1,1,0] op_sel_hi:[0,1,1] neg_lo:[1,0,0]
    ds_write_addtid_b32 v107 offset:2080
    ds_write_addtid_b32 v203 offset:3104
    ds_read_b128 a[64:67], v26 offset:0
    ds_read_b128 a[68:71], v26 offset:33280
    v_cvt_pk_bf16_f32 v108, v128, v129
    v_cvt_pk_bf16_f32 v204, v224, v225
    s_bitcmp1_b32 s20, 1
    s_cselect_b32 s88, s89, s88
    s_bitcmp1_b32 s20, 0
    s_cselect_b32 s88, 0, s88
    v_mov_b32 v208, 0
    v_mov_b32 v209, 0
    v_mov_b32 v210, 0
    v_mov_b32 v211, 0
    v_writelane_b32 v208, s88, 0
    v_pk_mul_f32 v[102:103], v[128:129], v[96:97] op_sel:[0,0] op_sel_hi:[1,0]
    v_pk_mul_f32 v[198:199], v[224:225], v[192:193] op_sel:[0,0] op_sel_hi:[1,0]
    v_pk_fma_f32 v[84:85], v[128:129], v[96:97], v[102:103] op_sel:[1,1,0] op_sel_hi:[0,1,1] neg_lo:[1,0,0]
    v_pk_fma_f32 v[180:181], v[224:225], v[192:193], v[198:199] op_sel:[1,1,0] op_sel_hi:[0,1,1] neg_lo:[1,0,0]
    ds_write_addtid_b32 v108 offset:4160
    ds_write_addtid_b32 v204 offset:5184
    v_cvt_pk_bf16_f32 v109, v130, v131
    v_cvt_pk_bf16_f32 v205, v226, v227
    v_pk_mul_f32 v[104:105], v[130:131], v[96:97] op_sel:[0,0] op_sel_hi:[1,0]
    v_pk_mul_f32 v[200:201], v[226:227], v[192:193] op_sel:[0,0] op_sel_hi:[1,0]
    v_pk_fma_f32 v[86:87], v[130:131], v[96:97], v[104:105] op_sel:[1,1,0] op_sel_hi:[0,1,1] neg_lo:[1,0,0]
    v_pk_fma_f32 v[182:183], v[226:227], v[192:193], v[200:201] op_sel:[1,1,0] op_sel_hi:[0,1,1] neg_lo:[1,0,0]
    ds_write_addtid_b32 v109 offset:6240
    ds_write_addtid_b32 v205 offset:7264
    ds_read_b128 a[72:75], v26 offset:64
    ds_read_b128 a[76:79], v26 offset:33344
    s_nop 0
    s_waitcnt lgkmcnt(15)
    v_mfma_f32_16x16x32_bf16 v[152:155], a[192:195], a[196:199], 0
    v_cvt_pk_bf16_f32 v106, v80, v81
    v_cvt_pk_bf16_f32 v202, v176, v177
    v_pk_mul_f32 v[98:99], v[80:81], v[96:97] op_sel:[0,0] op_sel_hi:[1,0]
    v_mfma_f32_16x16x32_bf16 v[152:155], a[200:203], a[204:207], v[152:155]
    v_pk_mul_f32 v[194:195], v[176:177], v[192:193] op_sel:[0,0] op_sel_hi:[1,0]
    v_pk_fma_f32 v[88:89], v[80:81], v[96:97], v[98:99] op_sel:[1,1,0] op_sel_hi:[0,1,1] neg_lo:[1,0,0]
    v_pk_fma_f32 v[184:185], v[176:177], v[192:193], v[194:195] op_sel:[1,1,0] op_sel_hi:[0,1,1] neg_lo:[1,0,0]
    s_waitcnt lgkmcnt(13)
    v_mfma_f32_16x16x32_bf16 v[152:155], a[208:211], a[212:215], v[152:155]
    ds_write_addtid_b32 v106 offset:8320
    ds_write_addtid_b32 v202 offset:9344
    v_cvt_pk_bf16_f32 v107, v82, v83
    s_waitcnt lgkmcnt(12)
    v_mfma_f32_16x16x32_bf16 v[152:155], a[216:219], a[220:223], v[152:155]
    v_cvt_pk_bf16_f32 v203, v178, v179
    v_pk_mul_f32 v[100:101], v[82:83], v[96:97] op_sel:[0,0] op_sel_hi:[1,0]
    v_pk_mul_f32 v[196:197], v[178:179], v[192:193] op_sel:[0,0] op_sel_hi:[1,0]
    v_pk_fma_f32 v[90:91], v[82:83], v[96:97], v[100:101] op_sel:[1,1,0] op_sel_hi:[0,1,1] neg_lo:[1,0,0]
    v_pk_fma_f32 v[186:187], v[178:179], v[192:193], v[196:197] op_sel:[1,1,0] op_sel_hi:[0,1,1] neg_lo:[1,0,0]
    ds_write_addtid_b32 v107 offset:10400
    ds_write_addtid_b32 v203 offset:11424
    ds_read_b128 a[80:83], v26 offset:128
    ds_read_b128 a[84:87], v26 offset:33408
    v_cvt_pk_bf16_f32 v108, v84, v85
    v_cvt_pk_bf16_f32 v204, v180, v181
    s_waitcnt vmcnt(5)
    v_readfirstlane_b32 s59, v30
    s_nop 0
    s_cmp_eq_u32 s59, 0
    s_cbranch_scc1 kf_rn_h
kf_rn_h_ret:
    s_and_b32 s6, s59, 0xffff
    s_mul_i32 s6, s6, 9
    s_lshr_b32 s6, s6, 16
    s_mul_i32 s6, s6, 0x1c00000
    s_add_u32 s16, s4, s6
    s_addc_u32 s17, s5, 0
    s_mov_b64 s[40:41], s[16:17]
    v_mov_b32 v150, s59
    v_lshrrev_b32 v1, 1, v3
    v_mov_b32 v151, v152
    v_or_b32 v1, s53, v1
    s_mov_b64 exec, 0xffff
    buffer_store_dwordx2 v[150:151], v1, s[16:19], s52 offen sc1
    s_mov_b64 exec, -1
    v_pk_mul_f32 v[102:103], v[84:85], v[96:97] op_sel:[0,0] op_sel_hi:[1,0]
    v_pk_mul_f32 v[198:199], v[180:181], v[192:193] op_sel:[0,0] op_sel_hi:[1,0]
    v_pk_fma_f32 v[92:93], v[84:85], v[96:97], v[102:103] op_sel:[1,1,0] op_sel_hi:[0,1,1] neg_lo:[1,0,0]
    v_pk_fma_f32 v[188:189], v[180:181], v[192:193], v[198:199] op_sel:[1,1,0] op_sel_hi:[0,1,1] neg_lo:[1,0,0]
    s_waitcnt vmcnt(1)
    ds_read_b64_tr_b16 a[224:225], v56 offset:0
    ds_write_addtid_b32 v108 offset:12480
    ds_write_addtid_b32 v204 offset:13504
    ds_read_b64_tr_b16 a[226:227], v56 offset:256
    v_cvt_pk_bf16_f32 v109, v86, v87
    v_cvt_pk_bf16_f32 v205, v182, v183
    ds_read_b64_tr_b16 a[228:229], v56 offset:1024
    v_pk_mul_f32 v[104:105], v[86:87], v[96:97] op_sel:[0,0] op_sel_hi:[1,0]
    v_pk_mul_f32 v[200:201], v[182:183], v[192:193] op_sel:[0,0] op_sel_hi:[1,0]
    ds_read_b64_tr_b16 a[230:231], v56 offset:1280
    v_pk_fma_f32 v[94:95], v[86:87], v[96:97], v[104:105] op_sel:[1,1,0] op_sel_hi:[0,1,1] neg_lo:[1,0,0]
    v_pk_fma_f32 v[190:191], v[182:183], v[192:193], v[200:201] op_sel:[1,1,0] op_sel_hi:[0,1,1] neg_lo:[1,0,0]
    ds_read_b64_tr_b16 a[232:233], v56 offset:2048
    ds_write_addtid_b32 v109 offset:14560
    ds_write_addtid_b32 v205 offset:15584
    ds_read_b64_tr_b16 a[234:235], v56 offset:2304
    ds_read_b128 a[88:91], v26 offset:192
    ds_read_b128 a[92:95], v26 offset:33472
    ds_read_b64_tr_b16 a[236:237], v56 offset:3072
    v_cvt_pk_bf16_f32 v106, v88, v89
    v_cvt_pk_bf16_f32 v202, v184, v185
    ds_read_b64_tr_b16 a[238:239], v56 offset:3328
    v_pk_mul_f32 v[98:99], v[88:89], v[96:97] op_sel:[0,0] op_sel_hi:[1,0]
    v_pk_mul_f32 v[194:195], v[184:185], v[192:193] op_sel:[0,0] op_sel_hi:[1,0]
    ds_read_b64_tr_b16 a[240:241], v56 offset:4096
    v_pk_fma_f32 v[80:81], v[88:89], v[96:97], v[98:99] op_sel:[1,1,0] op_sel_hi:[0,1,1] neg_lo:[1,0,0]
    v_pk_fma_f32 v[176:177], v[184:185], v[192:193], v[194:195] op_sel:[1,1,0] op_sel_hi:[0,1,1] neg_lo:[1,0,0]
    ds_read_b64_tr_b16 a[242:243], v56 offset:4352
    ds_write_addtid_b32 v106 offset:16640
    ds_write_addtid_b32 v202 offset:17664
    v_cvt_pk_bf16_f32 v107, v90, v91
    v_cvt_pk_bf16_f32 v203, v186, v187
    v_pk_mul_f32 v[100:101], v[90:91], v[96:97] op_sel:[0,0] op_sel_hi:[1,0]
    v_pk_mul_f32 v[196:197], v[186:187], v[192:193] op_sel:[0,0] op_sel_hi:[1,0]
    v_pk_fma_f32 v[82:83], v[90:91], v[96:97], v[100:101] op_sel:[1,1,0] op_sel_hi:[0,1,1] neg_lo:[1,0,0]
    v_pk_fma_f32 v[178:179], v[186:187], v[192:193], v[196:197] op_sel:[1,1,0] op_sel_hi:[0,1,1] neg_lo:[1,0,0]
    ds_write_addtid_b32 v107 offset:18720
    ds_write_addtid_b32 v203 offset:19744
    ds_read_b128 a[96:99], v26 offset:256
    ds_read_b128 a[100:103], v26 offset:33536
    v_cvt_pk_bf16_f32 v108, v92, v93
    v_cvt_pk_bf16_f32 v204, v188, v189
    v_pk_mul_f32 v[102:103], v[92:93], v[96:97] op_sel:[0,0] op_sel_hi:[1,0]
    v_pk_mul_f32 v[198:199], v[188:189], v[192:193] op_sel:[0,0] op_sel_hi:[1,0]
    v_pk_fma_f32 v[84:85], v[92:93], v[96:97], v[102:103] op_sel:[1,1,0] op_sel_hi:[0,1,1] neg_lo:[1,0,0]
    v_pk_fma_f32 v[180:181], v[188:189], v[192:193], v[198:199] op_sel:[1,1,0] op_sel_hi:[0,1,1] neg_lo:[1,0,0]
    ds_write_addtid_b32 v108 offset:20800
    ds_write_addtid_b32 v204 offset:21824
    v_cvt_pk_bf16_f32 v109, v94, v95
    v_cvt_pk_bf16_f32 v205, v190, v191
    s_waitcnt lgkmcnt(15)
    buffer_store_dwordx4 a[224:227], v3, s[40:43], s46 offen sc1
    v_pk_mul_f32 v[104:105], v[94:95], v[96:97] op_sel:[0,0] op_sel_hi:[1,0]
    v_pk_mul_f32 v[200:201], v[190:191], v[192:193] op_sel:[0,0] op_sel_hi:[1,0]
    s_add_u32 s46, s46, s47
    v_pk_fma_f32 v[86:87], v[94:95], v[96:97], v[104:105] op_sel:[1,1,0] op_sel_hi:[0,1,1] neg_lo:[1,0,0]
    v_pk_fma_f32 v[182:183], v[190:191], v[192:193], v[200:201] op_sel:[1,1,0] op_sel_hi:[0,1,1] neg_lo:[1,0,0]
    buffer_store_dwordx4 a[228:231], v3, s[40:43], s46 offen sc1
    ds_write_addtid_b32 v109 offset:22880
    ds_write_addtid_b32 v205 offset:23904
    s_add_u32 s46, s46, s47
    ds_read_b128 a[104:107], v26 offset:320
    ds_read_b128 a[108:111], v26 offset:33600
    s_waitcnt lgkmcnt(15)
    buffer_store_dwordx4 a[232:235], v3, s[40:43], s46 offen sc1
    v_cvt_pk_bf16_f32 v106, v80, v81
    v_cvt_pk_bf16_f32 v202, v176, v177
    s_add_u32 s46, s46, s47
    v_pk_mul_f32 v[98:99], v[80:81], v[96:97] op_sel:[0,0] op_sel_hi:[1,0]
    v_pk_mul_f32 v[194:195], v[176:177], v[192:193] op_sel:[0,0] op_sel_hi:[1,0]
    s_waitcnt lgkmcnt(14)
    buffer_store_dwordx4 a[236:239], v3, s[40:43], s46 offen sc1
    v_pk_fma_f32 v[88:89], v[80:81], v[96:97], v[98:99] op_sel:[1,1,0] op_sel_hi:[0,1,1] neg_lo:[1,0,0]
    v_pk_fma_f32 v[184:185], v[176:177], v[192:193], v[194:195] op_sel:[1,1,0] op_sel_hi:[0,1,1] neg_lo:[1,0,0]
    s_add_u32 s46, s46, s47
    ds_write_addtid_b32 v106 offset:24960
    ds_write_addtid_b32 v202 offset:25984
    s_waitcnt lgkmcnt(14)
    buffer_store_dwordx4 a[240:243], v3, s[40:43], s46 offen sc1
    v_cvt_pk_bf16_f32 v107, v82, v83
    v_cvt_pk_bf16_f32 v203, v178, v179
    v_pk_mul_f32 v[100:101], v[82:83], v[96:97] op_sel:[0,0] op_sel_hi:[1,0]
    v_pk_mul_f32 v[196:197], v[178:179], v[192:193] op_sel:[0,0] op_sel_hi:[1,0]
    v_pk_fma_f32 v[90:91], v[82:83], v[96:97], v[100:101] op_sel:[1,1,0] op_sel_hi:[0,1,1] neg_lo:[1,0,0]
    v_pk_fma_f32 v[186:187], v[178:179], v[192:193], v[196:197] op_sel:[1,1,0] op_sel_hi:[0,1,1] neg_lo:[1,0,0]
    ds_write_addtid_b32 v107 offset:27040
    ds_write_addtid_b32 v203 offset:28064
    ds_read_b128 a[112:115], v26 offset:384
    ds_read_b128 a[116:119], v26 offset:33664
    v_cvt_pk_bf16_f32 v108, v84, v85
    v_cvt_pk_bf16_f32 v204, v180, v181
    v_pk_mul_f32 v[102:103], v[84:85], v[96:97] op_sel:[0,0] op_sel_hi:[1,0]
    v_pk_mul_f32 v[198:199], v[180:181], v[192:193] op_sel:[0,0] op_sel_hi:[1,0]
    v_pk_fma_f32 v[92:93], v[84:85], v[96:97], v[102:103] op_sel:[1,1,0] op_sel_hi:[0,1,1] neg_lo:[1,0,0]
    v_pk_fma_f32 v[188:189], v[180:181], v[192:193], v[198:199] op_sel:[1,1,0] op_sel_hi:[0,1,1] neg_lo:[1,0,0]
    ds_write_addtid_b32 v108 offset:29120
    ds_write_addtid_b32 v204 offset:30144
    v_cvt_pk_bf16_f32 v109, v86, v87
    v_cvt_pk_bf16_f32 v205, v182, v183
    v_pk_mul_f32 v[104:105], v[86:87], v[96:97] op_sel:[0,0] op_sel_hi:[1,0]
    v_pk_mul_f32 v[200:201], v[182:183], v[192:193] op_sel:[0,0] op_sel_hi:[1,0]
    v_pk_fma_f32 v[94:95], v[86:87], v[96:97], v[104:105] op_sel:[1,1,0] op_sel_hi:[0,1,1] neg_lo:[1,0,0]
    v_pk_fma_f32 v[190:191], v[182:183], v[192:193], v[200:201] op_sel:[1,1,0] op_sel_hi:[0,1,1] neg_lo:[1,0,0]
    ds_write_addtid_b32 v109 offset:31200
    ds_write_addtid_b32 v205 offset:32224
    ds_read_b128 a[120:123], v26 offset:448
    ds_read_b128 a[124:127], v26 offset:33728
    v_cvt_pk_bf16_f32 v106, v88, v89
    v_cvt_pk_bf16_f32 v202, v184, v185
    v_pk_mul_f32 v[98:99], v[88:89], v[96:97] op_sel:[0,0] op_sel_hi:[1,0]
    v_pk_mul_f32 v[194:195], v[184:185], v[192:193] op_sel:[0,0] op_sel_hi:[1,0]
    v_pk_fma_f32 v[80:81], v[88:89], v[96:97], v[98:99] op_sel:[1,1,0] op_sel_hi:[0,1,1] neg_lo:[1,0,0]
    v_pk_fma_f32 v[176:177], v[184:185], v[192:193], v[194:195] op_sel:[1,1,0] op_sel_hi:[0,1,1] neg_lo:[1,0,0]
    ds_write_addtid_b32 v106 offset:33280
    ds_write_addtid_b32 v202 offset:34304
    v_cvt_pk_bf16_f32 v107, v90, v91
    v_cvt_pk_bf16_f32 v203, v186, v187
    v_pk_mul_f32 v[100:101], v[90:91], v[96:97] op_sel:[0,0] op_sel_hi:[1,0]
    v_pk_mul_f32 v[196:197], v[186:187], v[192:193] op_sel:[0,0] op_sel_hi:[1,0]
    v_pk_fma_f32 v[82:83], v[90:91], v[96:97], v[100:101] op_sel:[1,1,0] op_sel_hi:[0,1,1] neg_lo:[1,0,0]
    v_pk_fma_f32 v[178:179], v[186:187], v[192:193], v[196:197] op_sel:[1,1,0] op_sel_hi:[0,1,1] neg_lo:[1,0,0]
    ds_write_addtid_b32 v107 offset:35360
    ds_write_addtid_b32 v203 offset:36384
    ds_read_b128 a[128:131], v26 offset:512
    ds_read_b128 a[132:135], v26 offset:33792
    v_cvt_pk_bf16_f32 v108, v92, v93
    v_cvt_pk_bf16_f32 v204, v188, v189
    v_pk_mul_f32 v[102:103], v[92:93], v[96:97] op_sel:[0,0] op_sel_hi:[1,0]
    v_pk_mul_f32 v[198:199], v[188:189], v[192:193] op_sel:[0,0] op_sel_hi:[1,0]
    v_pk_fma_f32 v[84:85], v[92:93], v[96:97], v[102:103] op_sel:[1,1,0] op_sel_hi:[0,1,1] neg_lo:[1,0,0]
    v_pk_fma_f32 v[180:181], v[188:189], v[192:193], v[198:199] op_sel:[1,1,0] op_sel_hi:[0,1,1] neg_lo:[1,0,0]
    ds_write_addtid_b32 v108 offset:37440
    ds_write_addtid_b32 v204 offset:38464
    v_cvt_pk_bf16_f32 v109, v94, v95
    v_cvt_pk_bf16_f32 v205, v190, v191
    v_pk_mul_f32 v[104:105], v[94:95], v[96:97] op_sel:[0,0] op_sel_hi:[1,0]
    v_pk_mul_f32 v[200:201], v[190:191], v[192:193] op_sel:[0,0] op_sel_hi:[1,0]
    v_pk_fma_f32 v[86:87], v[94:95], v[96:97], v[104:105] op_sel:[1,1,0] op_sel_hi:[0,1,1] neg_lo:[1,0,0]
    v_pk_fma_f32 v[182:183], v[190:191], v[192:193], v[200:201] op_sel:[1,1,0] op_sel_hi:[0,1,1] neg_lo:[1,0,0]
    ds_write_addtid_b32 v109 offset:39520
    ds_write_addtid_b32 v205 offset:40544
    ds_read_b128 a[136:139], v26 offset:576
    ds_read_b128 a[140:143], v26 offset:33856
    v_cvt_pk_bf16_f32 v106, v80, v81
    v_cvt_pk_bf16_f32 v202, v176, v177
    v_pk_mul_f32 v[98:99], v[80:81], v[96:97] op_sel:[0,0] op_sel_hi:[1,0]
    v_pk_mul_f32 v[194:195], v[176:177], v[192:193] op_sel:[0,0] op_sel_hi:[1,0]
    v_pk_fma_f32 v[88:89], v[80:81], v[96:97], v[98:99] op_sel:[1,1,0] op_sel_hi:[0,1,1] neg_lo:[1,0,0]
    v_pk_fma_f32 v[184:185], v[176:177], v[192:193], v[194:195] op_sel:[1,1,0] op_sel_hi:[0,1,1] neg_lo:[1,0,0]
    ds_write_addtid_b32 v106 offset:41600
    ds_write_addtid_b32 v202 offset:42624
    v_cvt_pk_bf16_f32 v107, v82, v83
    v_cvt_pk_bf16_f32 v203, v178, v179
    v_pk_mul_f32 v[100:101], v[82:83], v[96:97] op_sel:[0,0] op_sel_hi:[1,0]
    v_pk_mul_f32 v[196:197], v[178:179], v[192:193] op_sel:[0,0] op_sel_hi:[1,0]
    v_pk_fma_f32 v[90:91], v[82:83], v[96:97], v[100:101] op_sel:[1,1,0] op_sel_hi:[0,1,1] neg_lo:[1,0,0]
    v_pk_fma_f32 v[186:187], v[178:179], v[192:193], v[196:197] op_sel:[1,1,0] op_sel_hi:[0,1,1] neg_lo:[1,0,0]
    ds_write_addtid_b32 v107 offset:43680
    ds_write_addtid_b32 v203 offset:44704
    ds_read_b128 a[144:147], v26 offset:640
    ds_read_b128 a[148:151], v26 offset:33920
    v_cvt_pk_bf16_f32 v108, v84, v85
    v_cvt_pk_bf16_f32 v204, v180, v181
    v_pk_mul_f32 v[102:103], v[84:85], v[96:97] op_sel:[0,0] op_sel_hi:[1,0]
    v_pk_mul_f32 v[198:199], v[180:181], v[192:193] op_sel:[0,0] op_sel_hi:[1,0]
    v_pk_fma_f32 v[92:93], v[84:85], v[96:97], v[102:103] op_sel:[1,1,0] op_sel_hi:[0,1,1] neg_lo:[1,0,0]
    v_pk_fma_f32 v[188:189], v[180:181], v[192:193], v[198:199] op_sel:[1,1,0] op_sel_hi:[0,1,1] neg_lo:[1,0,0]
    ds_write_addtid_b32 v108 offset:45760
    ds_write_addtid_b32 v204 offset:46784
    v_cvt_pk_bf16_f32 v109, v86, v87
    v_cvt_pk_bf16_f32 v205, v182, v183
    v_pk_mul_f32 v[104:105], v[86:87], v[96:97] op_sel:[0,0] op_sel_hi:[1,0]
    v_pk_mul_f32 v[200:201], v[182:183], v[192:193] op_sel:[0,0] op_sel_hi:[1,0]
    v_pk_fma_f32 v[94:95], v[86:87], v[96:97], v[104:105] op_sel:[1,1,0] op_sel_hi:[0,1,1] neg_lo:[1,0,0]
    v_pk_fma_f32 v[190:191], v[182:183], v[192:193], v[200:201] op_sel:[1,1,0] op_sel_hi:[0,1,1] neg_lo:[1,0,0]
    ds_write_addtid_b32 v109 offset:47840
    ds_write_addtid_b32 v205 offset:48864
    ds_read_b128 a[152:155], v26 offset:704
    ds_read_b128 a[156:159], v26 offset:33984
    v_cvt_pk_bf16_f32 v106, v88, v89
    v_cvt_pk_bf16_f32 v202, v184, v185
    v_pk_mul_f32 v[98:99], v[88:89], v[96:97] op_sel:[0,0] op_sel_hi:[1,0]
    v_pk_mul_f32 v[194:195], v[184:185], v[192:193] op_sel:[0,0] op_sel_hi:[1,0]
    v_pk_fma_f32 v[80:81], v[88:89], v[96:97], v[98:99] op_sel:[1,1,0] op_sel_hi:[0,1,1] neg_lo:[1,0,0]
    v_pk_fma_f32 v[176:177], v[184:185], v[192:193], v[194:195] op_sel:[1,1,0] op_sel_hi:[0,1,1] neg_lo:[1,0,0]
    ds_write_addtid_b32 v106 offset:49920
    ds_write_addtid_b32 v202 offset:50944
    v_cvt_pk_bf16_f32 v107, v90, v91
    v_cvt_pk_bf16_f32 v203, v186, v187
    v_pk_mul_f32 v[100:101], v[90:91], v[96:97] op_sel:[0,0] op_sel_hi:[1,0]
    v_pk_mul_f32 v[196:197], v[186:187], v[192:193] op_sel:[0,0] op_sel_hi:[1,0]
    v_pk_fma_f32 v[82:83], v[90:91], v[96:97], v[100:101] op_sel:[1,1,0] op_sel_hi:[0,1,1] neg_lo:[1,0,0]
    v_pk_fma_f32 v[178:179], v[186:187], v[192:193], v[196:197] op_sel:[1,1,0] op_sel_hi:[0,1,1] neg_lo:[1,0,0]
    ds_write_addtid_b32 v107 offset:52000
    ds_write_addtid_b32 v203 offset:53024
    ds_read_b128 a[160:163], v26 offset:768
    ds_read_b128 a[164:167], v26 offset:34048
    v_cvt_pk_bf16_f32 v108, v92, v93
    v_cvt_pk_bf16_f32 v204, v188, v189
    v_pk_mul_f32 v[102:103], v[92:93], v[96:97] op_sel:[0,0] op_sel_hi:[1,0]
    v_pk_mul_f32 v[198:199], v[188:189], v[192:193] op_sel:[0,0] op_sel_hi:[1,0]
    v_pk_fma_f32 v[84:85], v[92:93], v[96:97], v[102:103] op_sel:[1,1,0] op_sel_hi:[0,1,1] neg_lo:[1,0,0]
    v_pk_fma_f32 v[180:181], v[188:189], v[192:193], v[198:199] op_sel:[1,1,0] op_sel_hi:[0,1,1] neg_lo:[1,0,0]
    ds_write_addtid_b32 v108 offset:54080
    ds_write_addtid_b32 v204 offset:55104
    v_cvt_pk_bf16_f32 v109, v94, v95
    v_cvt_pk_bf16_f32 v205, v190, v191
    v_pk_mul_f32 v[104:105], v[94:95], v[96:97] op_sel:[0,0] op_sel_hi:[1,0]
    v_pk_mul_f32 v[200:201], v[190:191], v[192:193] op_sel:[0,0] op_sel_hi:[1,0]
    v_pk_fma_f32 v[86:87], v[94:95], v[96:97], v[104:105] op_sel:[1,1,0] op_sel_hi:[0,1,1] neg_lo:[1,0,0]
    v_pk_fma_f32 v[182:183], v[190:191], v[192:193], v[200:201] op_sel:[1,1,0] op_sel_hi:[0,1,1] neg_lo:[1,0,0]
    ds_write_addtid_b32 v109 offset:56160
    ds_write_addtid_b32 v205 offset:57184
    ds_read_b128 a[168:171], v26 offset:832
    ds_read_b128 a[172:175], v26 offset:34112
    v_cvt_pk_bf16_f32 v106, v80, v81
    v_cvt_pk_bf16_f32 v202, v176, v177
    ds_write_addtid_b32 v106 offset:58240
    ds_write_addtid_b32 v202 offset:59264
    v_cvt_pk_bf16_f32 v107, v82, v83
    v_cvt_pk_bf16_f32 v203, v178, v179
    ds_write_addtid_b32 v107 offset:60320
    ds_write_addtid_b32 v203 offset:61344
    ds_read_b128 a[176:179], v26 offset:896
    ds_read_b128 a[180:183], v26 offset:34176
    v_cvt_pk_bf16_f32 v108, v84, v85
    v_cvt_pk_bf16_f32 v204, v180, v181
    ds_write_addtid_b32 v108 offset:62400
    buffer_load_dwordx4 v[64:67], v32, s[16:19], s8 offen offset:0 sc1
    buffer_load_dwordx4 v[68:71], v32, s[16:19], s8 offen offset:64 sc1
    buffer_load_dwordx4 v[72:75], v32, s[16:19], s8 offen offset:128 sc1
    buffer_load_dwordx4 v[76:79], v32, s[16:19], s8 offen offset:192 sc1
    ds_write_addtid_b32 v204 offset:63424
    v_cvt_pk_bf16_f32 v109, v86, v87
    v_cvt_pk_bf16_f32 v205, v182, v183
    ds_write_addtid_b32 v109 offset:64480
    ds_write_addtid_b32 v205 offset:65504
    ds_read_b128 a[184:187], v26 offset:960
    ds_read_b128 a[188:191], v26 offset:34240
    s_lshl_b32 s6, s2, 2
    s_add_u32 s6, s6, s20
    s_lshl_b32 s6, s6, 7
    s_add_u32 s6, s6, 2883584
    v_mov_b32 v2, s59
    s_waitcnt vmcnt(4)
    s_mov_b64 exec, 0xff
    buffer_store_dwordx4 v[2:5], v3, s[16:19], s6 offen sc1
    s_mov_b64 exec, -1
    s_mov_b32 s42, 0x1c00000
    s_waitcnt lgkmcnt(0)
    s_barrier
    ds_read_b128 a[0:3], v25 offset:0
    ds_read_b128 a[4:7], v25 offset:64
    ds_read_b128 a[8:11], v25 offset:128
    ds_read_b128 a[12:15], v25 offset:192
    ds_read_b128 a[16:19], v25 offset:256
    ds_read_b128 a[20:23], v25 offset:320
    ds_read_b128 a[24:27], v25 offset:384
    ds_read_b128 a[28:31], v25 offset:448
    ds_read_b128 a[32:35], v25 offset:512
    ds_read_b128 a[36:39], v25 offset:576
    ds_read_b128 a[40:43], v25 offset:640
    ds_read_b128 a[44:47], v25 offset:704
    ds_read_b128 a[48:51], v25 offset:768
    ds_read_b128 a[52:55], v25 offset:832
    ds_read_b128 a[56:59], v25 offset:896
    ds_read_b128 a[60:63], v25 offset:960
    s_waitcnt lgkmcnt(15)
    v_mfma_f32_16x16x32_bf16 v[176:179], a[0:3], a[64:67], v[208:211]
    v_mfma_f32_16x16x32_bf16 v[180:183], a[0:3], a[68:71], 0
    s_waitcnt lgkmcnt(14)
    v_mfma_f32_16x16x32_bf16 v[176:179], a[4:7], a[72:75], v[176:179]
    v_mfma_f32_16x16x32_bf16 v[180:183], a[4:7], a[76:79], v[180:183]
    s_waitcnt lgkmcnt(13)
    v_mfma_f32_16x16x32_bf16 v[176:179], a[8:11], a[80:83], v[176:179]
    v_mfma_f32_16x16x32_bf16 v[180:183], a[8:11], a[84:87], v[180:183]
    s_waitcnt lgkmcnt(12)
    v_mfma_f32_16x16x32_bf16 v[176:179], a[12:15], a[88:91], v[176:179]
    v_mfma_f32_16x16x32_bf16 v[180:183], a[12:15], a[92:95], v[180:183]
    s_waitcnt lgkmcnt(11)
    v_mfma_f32_16x16x32_bf16 v[176:179], a[16:19], a[96:99], v[176:179]
    v_mfma_f32_16x16x32_bf16 v[180:183], a[16:19], a[100:103], v[180:183]
    s_waitcnt lgkmcnt(10)
    v_mfma_f32_16x16x32_bf16 v[176:179], a[20:23], a[104:107], v[176:179]
    v_mfma_f32_16x16x32_bf16 v[180:183], a[20:23], a[108:111], v[180:183]
    s_waitcnt lgkmcnt(9)
    v_mfma_f32_16x16x32_bf16 v[176:179], a[24:27], a[112:115], v[176:179]
    v_mfma_f32_16x16x32_bf16 v[180:183], a[24:27], a[116:119], v[180:183]
    s_waitcnt lgkmcnt(8)
    v_mfma_f32_16x16x32_bf16 v[176:179], a[28:31], a[120:123], v[176:179]
    v_mfma_f32_16x16x32_bf16 v[180:183], a[28:31], a[124:127], v[180:183]
    buffer_load_dwordx2 v[124:125], v31, s[16:19], s38 offen sc1
    buffer_load_dwordx2 v[220:221], v31, s[16:19], s39 offen sc1
    s_waitcnt lgkmcnt(7)
    v_mfma_f32_16x16x32_bf16 v[176:179], a[32:35], a[128:131], v[176:179]
    v_mfma_f32_16x16x32_bf16 v[180:183], a[32:35], a[132:135], v[180:183]
    s_waitcnt lgkmcnt(6)
    v_mfma_f32_16x16x32_bf16 v[176:179], a[36:39], a[136:139], v[176:179]
    v_mfma_f32_16x16x32_bf16 v[180:183], a[36:39], a[140:143], v[180:183]
    s_waitcnt lgkmcnt(5)
    v_mfma_f32_16x16x32_bf16 v[176:179], a[40:43], a[144:147], v[176:179]
    v_mfma_f32_16x16x32_bf16 v[180:183], a[40:43], a[148:151], v[180:183]
    s_waitcnt lgkmcnt(4)
    v_mfma_f32_16x16x32_bf16 v[176:179], a[44:47], a[152:155], v[176:179]
    v_mfma_f32_16x16x32_bf16 v[180:183], a[44:47], a[156:159], v[180:183]
    s_waitcnt lgkmcnt(3)
    v_mfma_f32_16x16x32_bf16 v[176:179], a[48:51], a[160:163], v[176:179]
    v_mfma_f32_16x16x32_bf16 v[180:183], a[48:51], a[164:167], v[180:183]
    s_waitcnt lgkmcnt(2)
    v_mfma_f32_16x16x32_bf16 v[176:179], a[52:55], a[168:171], v[176:179]
    v_mfma_f32_16x16x32_bf16 v[180:183], a[52:55], a[172:175], v[180:183]
    s_waitcnt lgkmcnt(1)
    v_mfma_f32_16x16x32_bf16 v[176:179], a[56:59], a[176:179], v[176:179]
    v_mfma_f32_16x16x32_bf16 v[180:183], a[56:59], a[180:183], v[180:183]
    s_waitcnt lgkmcnt(0)
    v_mfma_f32_16x16x32_bf16 v[176:179], a[60:63], a[184:187], v[176:179]
    v_mfma_f32_16x16x32_bf16 v[180:183], a[60:63], a[188:191], v[180:183]
    s_waitcnt vmcnt(3)
    v_xor_b32 v56, s59, v64
    v_xor_b32 v57, s59, v68
    v_xor_b32 v58, s59, v72
    v_xor_b32 v59, s59, v76
    v_or3_b32 v56, v56, v57, v58
    v_or_b32 v56, v56, v59
    v_cmp_ne_u32 vcc, 0, v56
    s_cbranch_vccnz kf_rp_h
kf_rp_h_ret:
    buffer_load_dwordx4 v[132:135], v33, s[84:87], s26 offen sc1
    buffer_load_dwordx4 v[228:231], v33, s[84:87], s30 offen sc1
    v_cvt_pk_bf16_f32 v176, v176, v177
    v_cvt_pk_bf16_f32 v177, v178, v179
    ds_write_b16 v28, v176 offset:0
    ds_write_b16_d16_hi v28, v176 offset:16
    ds_write_b16 v28, v177 offset:32
    ds_write_b16_d16_hi v28, v177 offset:48
    v_cvt_pk_bf16_f32 v180, v180, v181
    v_cvt_pk_bf16_f32 v181, v182, v183
    ds_write_b16 v27, v180 offset:2048
    ds_write_b16_d16_hi v27, v180 offset:2064
    ds_write_b16 v27, v181 offset:2080
    ds_write_b16_d16_hi v27, v181 offset:2096
    s_waitcnt lgkmcnt(0)
    s_barrier
    ds_read_b128 v[84:87], v36 offset:16
    ds_read_b32 v88, v36 offset:32
    ds_read_b128 v[80:83], v36 offset:0
    ds_read_b128 v[180:183], v36 offset:4624
    ds_read_b32 v184, v36 offset:4640
    ds_read_b128 v[176:179], v36 offset:4608
    s_mov_b32 s9, 0x05040100
    v_cmp_gt_u32 vcc, 16, v0
    s_nop 0
    s_and_saveexec_b64 s[36:37], vcc
    ds_write_b128 v37, v[60:63] offset:4096
    ds_write_b128 v37, v[60:63] offset:38656
    s_mov_b64 exec, s[36:37]
    v_cmp_gt_u32 vcc, 160, v0
    s_nop 0
    s_and_saveexec_b64 s[36:37], vcc
    ds_write_b128 v4, v[60:63] offset:24576
    ds_write_b128 v4, v[60:63] offset:32256
    s_mov_b64 exec, s[36:37]
    v_lshlrev_b32 v64, 16, v65
    v_and_b32 v65, 0xffff0000, v65
    v_lshlrev_b32 v68, 16, v69
    v_and_b32 v69, 0xffff0000, v69
    v_lshlrev_b32 v72, 16, v73
    v_and_b32 v73, 0xffff0000, v73
    v_lshlrev_b32 v76, 16, v77
    v_and_b32 v77, 0xffff0000, v77
    v_pk_mul_f32 v[64:65], v[64:65], v[66:67] neg_lo:[1,0] neg_hi:[1,0]
    v_pk_mul_f32 v[68:69], v[68:69], v[70:71] neg_lo:[1,0] neg_hi:[1,0]
    v_pk_mul_f32 v[72:73], v[72:73], v[74:75] neg_lo:[1,0] neg_hi:[1,0]
    v_pk_mul_f32 v[76:77], v[76:77], v[78:79] neg_lo:[1,0] neg_hi:[1,0]
    s_waitcnt lgkmcnt(7)
    v_perm_b32 v89, v88, v84, s9
    v_perm_b32 v90, v86, v84, s9
    v_perm_b32 v96, v88, v87, v16
    v_perm_b32 v99, v84, v84, v19
    v_perm_b32 v97, v89, v86, v17
    v_perm_b32 v98, v90, v85, v18
    v_perm_b32 v91, v84, v80, s9
    v_perm_b32 v100, v84, v83, v20
    v_perm_b32 v101, v91, v82, v21
    ds_write_b128 v249, v[96:99] offset:12480
    v_pk_mov_b32 v[104:105], v[96:97], v[98:99] op_sel:[1,0]
    v_pk_mov_b32 v[106:107], v[98:99], v[100:101] op_sel:[1,0]
    ds_write_b128 v249, v[104:107] offset:4160
    v_alignbit_b32 v112, v97, v96, 16
    v_alignbit_b32 v113, v98, v97, 16
    v_alignbit_b32 v114, v99, v98, 16
    v_alignbit_b32 v115, v100, v99, 16
    ds_write_b128 v249, v[112:115] offset:8320
    s_mov_b32 s7, 2220032
    buffer_load_dwordx4 v[160:163], v3, s[16:19], s7 offen sc1
    s_waitcnt vmcnt(3)
    v_xor_b32 v57, s59, v124
    v_xor_b32 v58, s59, v220
    v_or_b32 v57, v57, v58
    s_branch pg1_s
.p2align 12
pg1_h:
    s_branch wh_ret
pg1_l:
    s_endpgm
pg1_s:
    v_cmp_ne_u32_e64 vcc, 0, v57
    s_cbranch_vccnz kf_rm_h
kf_rm_h_ret:
    v_add_f32_dpp v125, v125, v125 quad_perm:[1,0,3,2] row_mask:0xf bank_mask:0xf
    v_add_f32_dpp v221, v221, v221 quad_perm:[1,0,3,2] row_mask:0xf bank_mask:0xf
    s_nop 0
    v_add_f32_dpp v125, v125, v125 quad_perm:[2,3,0,1] row_mask:0xf bank_mask:0xf
    v_add_f32_dpp v221, v221, v221 quad_perm:[2,3,0,1] row_mask:0xf bank_mask:0xf
    v_pk_mov_b32 v[118:119], v[112:113], v[114:115] op_sel:[1,0]
    v_cvt_pk_bf16_f32 v125, 0, v125
    v_mov_b32_e64 v120, v115
    v_cvt_pk_bf16_f32 v221, 0, v221
    v_alignbit_b32 v121, v101, v100, 16
    v_add_f32 v124, 1.0, v125
    ds_write_b128 v249, v[118:121] offset:0
    v_add_f32 v220, 1.0, v221
    v_cvt_pk_bf16_f32 v124, 0, v124
    v_cvt_pk_bf16_f32 v220, 0, v220
    v_readlane_b32 s48, v125, 0
    v_readlane_b32 s49, v221, 0
    v_add_f32 v124, 0x2b800000, v124
    v_add_f32 v220, 0x2b800000, v220
    v_readlane_b32 s52, v125, 16
    v_readlane_b32 s53, v221, 16
    v_readlane_b32 s50, v124, 8
    v_readlane_b32 s51, v220, 8
    v_readlane_b32 s54, v124, 24
    v_readlane_b32 s55, v220, 24
    v_mov_b32 v124, s48
    v_mov_b32 v220, s49
    s_waitcnt vmcnt(2)
    v_lshlrev_b32 v136, 16, v132
    v_and_b32 v137, 0xffff0000, v132
    v_lshlrev_b32 v138, 16, v133
    v_and_b32 v139, 0xffff0000, v133
    v_lshlrev_b32 v140, 16, v134
    v_and_b32 v141, 0xffff0000, v134
    v_lshlrev_b32_e64 v142, 16, v135
    v_and_b32 v143, 0xffff0000, v135
    v_pk_fma_f32 v[136:137], v[136:137], v[66:67], v[64:65]
    v_pk_fma_f32 v[138:139], v[138:139], v[70:71], v[68:69]
    v_pk_fma_f32 v[140:141], v[140:141], v[74:75], v[72:73]
    v_pk_fma_f32 v[142:143], v[142:143], v[78:79], v[76:77]
    v_pk_fma_f32 v[136:137], v[136:137], s[50:51], v[124:125] op_sel:[0,0,0] op_sel_hi:[1,0,0]
    v_pk_fma_f32 v[138:139], v[138:139], s[50:51], v[124:125] op_sel:[0,0,0] op_sel_hi:[1,0,0]
    v_pk_fma_f32 v[140:141], v[140:141], s[50:51], v[124:125] op_sel:[0,0,0] op_sel_hi:[1,0,0]
    v_pk_fma_f32 v[142:143], v[142:143], s[50:51], v[124:125] op_sel:[0,0,0] op_sel_hi:[1,0,0]
    s_nop 0
    s_waitcnt lgkmcnt(8)
    v_perm_b32 v185, v184, v180, s9
    v_cvt_pk_bf16_f32 v144, v136, v137
    v_perm_b32 v186, v182, v180, s9
    ds_write_b32 v250, v144 offset:27136
    v_perm_b32 v192, v184, v183, v16
    v_cvt_pk_bf16_f32 v145, v138, v139
    v_perm_b32 v195, v180, v180, v19
    ds_write_b32 v250, v145 offset:27216
    v_perm_b32 v193, v185, v182, v17
    v_cvt_pk_bf16_f32 v146, v140, v141
    v_perm_b32 v194, v186, v181, v18
    ds_write_b32 v250, v146 offset:27296
    v_perm_b32 v187, v180, v176, s9
    v_cvt_pk_bf16_f32 v147, v142, v143
    v_perm_b32 v196, v180, v179, v20
    ds_write_b32 v250, v147 offset:27376
    v_perm_b32 v197, v187, v178, v21
    buffer_load_dword v244, v245, s[16:19], 0 offen sc1
    s_waitcnt lgkmcnt(0)
    s_barrier
    ds_read_b64 v[16:17], v5 offset:2496
    ds_read_b64 v[18:19], v5 offset:2504
    ds_read_b128 v[20:23], v6 offset:25136
    ds_read_b128 v[24:27], v6 offset:27696
    ds_read_b64 v[28:29], v5 offset:448
    ds_read_b64 v[30:31], v5 offset:456
    ds_read_b64 v[32:33], v5 offset:2528
    ds_read_b64 v[34:35], v5 offset:2536
    ds_read_b128 v[36:39], v6 offset:25168
    ds_read_b128 v[40:43], v6 offset:27728
    ds_read_b64 v[44:45], v5 offset:480
    ds_read_b64 v[46:47], v5 offset:488
    s_waitcnt lgkmcnt(6)
    v_mfma_f32_32x32x16_bf16 v[80:95], v[16:19], v[20:23], 0
    ds_read_b64 v[48:49], v5 offset:2432
    ds_read_b64 v[50:51], v5 offset:2440
    ds_read_b128 v[52:55], v6 offset:25056
    s_waitcnt vmcnt(1)
    v_xor_b32_e64 v164, s59, v160
    v_mfma_f32_32x32x16_bf16 v[96:111], v[16:19], v[24:27], 0
    ds_read_b128 v[56:59], v6 offset:27616
    ds_read_b64 v[60:61], v5 offset:384
    ds_read_b64 v[62:63], v5 offset:392
    v_xor_b32 v165, s59, v161
    v_xor_b32 v166, s59, v162
    v_mfma_f32_32x32x16_bf16 v[96:111], v[28:31], v[20:23], v[96:111]
    v_xor_b32_e64 v167, s59, v163
    v_or3_b32 v168, v164, v165, v166
    v_or_b32 v168, v168, v167
    v_cmp_lt_u32 vcc, 31, v168
    s_cbranch_vccnz kf_rv_h
kf_rv_h_ret:
    s_waitcnt lgkmcnt(6)
    v_mfma_f32_32x32x16_bf16 v[80:95], v[32:35], v[36:39], v[80:95]
    ds_read_b64 v[16:17], v5 offset:2464
    ds_read_b64 v[18:19], v5 offset:2472
    ds_read_b128 v[20:23], v6 offset:25088
    v_add_u32 v164, v164, v166
    v_add_u32 v165, v165, v167
    v_mfma_f32_32x32x16_bf16 v[96:111], v[32:35], v[40:43], v[96:111]
    ds_read_b128 v[24:27], v6 offset:27648
    ds_read_b64 v[28:29], v5 offset:416
    ds_read_b64 v[30:31], v5 offset:424
    v_cmp_gt_u32_e64 vcc, v164, v165
    s_nop 0
    s_xor_b32 vcc_lo, vcc_lo, 0xf0f0f0f0
    s_xor_b32 vcc_hi, vcc_hi, 0xf0f0f0f0
    s_bcnt1_i32_b64 s6, vcc
    s_cmp_ge_u32 s6, 32
    s_cselect_b32 s93, 0x2000, 0
    s_xor_b32 s21, s21, s93
    s_xor_b32 s101, s101, s93
    v_mfma_f32_32x32x16_bf16 v[96:111], v[44:47], v[36:39], v[96:111]
    s_add_u32 s6, s101, 8388608
    buffer_store_dwordx4 v[252:255], v14, s[16:19], s6 offen sc1
    ds_write_b128 v249, v[192:195] offset:47040
    s_waitcnt lgkmcnt(7)
    v_mfma_f32_32x32x16_bf16 v[80:95], v[48:51], v[52:55], v[80:95]
    ds_read_b64 v[32:33], v5 offset:2368
    ds_read_b64 v[34:35], v5 offset:2376
    ds_read_b128 v[36:39], v6 offset:24976
    s_add_u32 s6, s101, 8421376
    buffer_store_dwordx4 v[252:255], v14, s[16:19], s6 offen sc1
    v_mfma_f32_32x32x16_bf16 v[96:111], v[48:51], v[56:59], v[96:111]
    ds_read_b128 v[40:43], v6 offset:27536
    ds_read_b64 v[44:45], v5 offset:320
    ds_read_b64 v[46:47], v5 offset:328
    v_lshlrev_b32_e64 v232, 16, v228
    v_and_b32 v233, 0xffff0000, v228
    v_mfma_f32_32x32x16_bf16 v[96:111], v[60:63], v[52:55], v[96:111]
    v_lshlrev_b32 v234, 16, v229
    v_and_b32 v235, 0xffff0000, v229
    v_lshlrev_b32 v236, 16, v230
    v_mov_b32 v200, v193
    s_waitcnt lgkmcnt(7)
    v_mfma_f32_32x32x16_bf16 v[80:95], v[16:19], v[20:23], v[80:95]
    ds_read_b64 v[48:49], v5 offset:2400
    ds_read_b64 v[50:51], v5 offset:2408
    ds_read_b128 v[52:55], v6 offset:25008
    v_mov_b32 v201, v194
    v_mov_b32 v202, v195
    v_mfma_f32_32x32x16_bf16 v[96:111], v[16:19], v[24:27], v[96:111]
    ds_read_b128 v[56:59], v6 offset:27568
    ds_read_b64 v[60:61], v5 offset:352
    ds_read_b64 v[62:63], v5 offset:360
    v_mov_b32_e64 v203, v196
    ds_write_b128 v249, v[200:203] offset:38720
    v_mfma_f32_32x32x16_bf16 v[96:111], v[28:31], v[20:23], v[96:111]
    v_and_b32 v237, 0xffff0000, v230
    v_lshlrev_b32_e64 v238, 16, v231
    v_and_b32 v239, 0xffff0000, v231
    v_fma_f32 v232, v232, v66, v64
    s_waitcnt vmcnt(2)
    v_cmp_ne_u32 vcc, s59, v244
    s_cbranch_vccnz kf_rw_h
kf_rw_h_ret:
    s_waitcnt lgkmcnt(7)
    v_mfma_f32_32x32x16_bf16 v[80:95], v[32:35], v[36:39], v[80:95]
    buffer_load_dwordx4 a[0:3], v3, s[40:43], s23 offen offset:0 sc1
    ds_read_b64 v[16:17], v5 offset:2304
    ds_read_b64 v[18:19], v5 offset:2312
    ds_read_b128 v[20:23], v6 offset:24896
    v_fma_f32 v233, v233, v67, v65
    v_fma_f32 v234, v234, v70, v68
    v_mfma_f32_32x32x16_bf16 v[96:111], v[32:35], v[40:43], v[96:111]
    ds_read_b128 v[24:27], v6 offset:27456
    ds_read_b64 v[28:29], v5 offset:256
    buffer_load_dwordx4 a[4:7], v3, s[40:43], s23 offen offset:1024 sc1
    ds_read_b64 v[30:31], v5 offset:264
    v_mfma_f32_32x32x16_bf16 v[96:111], v[44:47], v[36:39], v[96:111]
    v_alignbit_b32 v208, v193, v192, 16
    v_alignbit_b32 v209, v194, v193, 16
    v_alignbit_b32 v210, v195, v194, 16
    v_alignbit_b32 v211, v196, v195, 16
    s_nop 0
    s_waitcnt lgkmcnt(7)
    v_mfma_f32_32x32x16_bf16 v[80:95], v[48:51], v[52:55], v[80:95]
    ds_read_b64 v[32:33], v5 offset:2336
    buffer_load_dwordx4 a[8:11], v3, s[40:43], s23 offen offset:2048 sc1
    ds_read_b64 v[34:35], v5 offset:2344
    ds_read_b128 v[36:39], v6 offset:24928
    v_mfma_f32_32x32x16_bf16 v[96:111], v[48:51], v[56:59], v[96:111]
    ds_read_b128 v[40:43], v6 offset:27488
    ds_read_b64 v[44:45], v5 offset:288
    ds_read_b64 v[46:47], v5 offset:296
    ds_write_b128 v249, v[208:211] offset:42880
    v_mfma_f32_32x32x16_bf16 v[96:111], v[60:63], v[52:55], v[96:111]
    buffer_load_dwordx4 a[12:15], v3, s[40:43], s23 offen offset:3072 sc1
    v_fma_f32 v235, v235, v71, v69
    v_fma_f32 v236, v236, v74, v72
    v_fma_f32 v237, v237, v75, v73
    v_fma_f32 v238, v238, v78, v76
    s_nop 0
    s_waitcnt lgkmcnt(7)
    v_mfma_f32_32x32x16_bf16 v[80:95], v[16:19], v[20:23], v[80:95]
    ds_read_b64 v[48:49], v5 offset:2240
    ds_read_b64 v[50:51], v5 offset:2248
    ds_read_b128 v[52:55], v6 offset:24816
    s_add_u32 s34, s23, 24576
    buffer_load_dwordx4 a[96:99], v3, s[40:43], s34 offen offset:0 sc1
    v_mfma_f32_32x32x16_bf16 v[96:111], v[16:19], v[24:27], v[96:111]
    ds_read_b128 v[56:59], v6 offset:27376
    ds_read_b64 v[60:61], v5 offset:192
    ds_read_b64 v[62:63], v5 offset:200
    v_fma_f32 v239, v239, v79, v77
    v_fma_f32 v232, v232, s51, v220
    v_mfma_f32_32x32x16_bf16 v[96:111], v[28:31], v[20:23], v[96:111]
    v_mov_b32_e64 v214, v209
    buffer_load_dwordx4 a[100:103], v3, s[40:43], s34 offen offset:1024 sc1
    v_mov_b32 v215, v210
    s_waitcnt lgkmcnt(7)
    v_mfma_f32_32x32x16_bf16 v[80:95], v[32:35], v[36:39], v[80:95]
    ds_read_b64 v[16:17], v5 offset:2272
    ds_read_b64 v[18:19], v5 offset:2280
    ds_read_b128 v[20:23], v6 offset:24848
    v_mov_b32_e64 v216, v211
    v_alignbit_b32 v217, v197, v196, 16
    v_mfma_f32_32x32x16_bf16 v[96:111], v[32:35], v[40:43], v[96:111]
    buffer_load_dwordx4 a[104:107], v3, s[40:43], s34 offen offset:2048 sc1
    ds_read_b128 v[24:27], v6 offset:27408
    ds_read_b64 v[28:29], v5 offset:224
    ds_read_b64 v[30:31], v5 offset:232
    ds_write_b128 v249, v[214:217] offset:34560
    v_mfma_f32_32x32x16_bf16 v[96:111], v[44:47], v[36:39], v[96:111]
    v_fma_f32 v233, v233, s51, v220
    v_fma_f32 v234, v234, s51, v220
    v_fma_f32 v235, v235, s51, v220
    buffer_load_dwordx4 a[108:111], v3, s[40:43], s34 offen offset:3072 sc1
    s_nop 0
    s_waitcnt lgkmcnt(7)
    v_mfma_f32_32x32x16_bf16 v[80:95], v[48:51], v[52:55], v[80:95]
    ds_read_b64 v[32:33], v5 offset:2176
    ds_read_b64 v[34:35], v5 offset:2184
    ds_read_b128 v[36:39], v6 offset:24736
    v_fma_f32 v236, v236, s51, v220
    v_fma_f32 v237, v237, s51, v220
    v_mfma_f32_32x32x16_bf16 v[96:111], v[48:51], v[56:59], v[96:111]
    ds_read_b128 v[40:43], v6 offset:27296
    s_add_u32 s34, s23, 28672
    buffer_load_dwordx4 a[112:115], v3, s[40:43], s34 offen offset:0 sc1
    ds_read_b64 v[44:45], v5 offset:128
    ds_read_b64 v[46:47], v5 offset:136
    v_mfma_f32_32x32x16_bf16 v[96:111], v[60:63], v[52:55], v[96:111]
    v_fma_f32 v238, v238, s51, v220
    v_fma_f32 v239, v239, s51, v220
    v_cvt_pk_bf16_f32 v240, v232, v233
    ds_write_b32 v250, v240 offset:34816
    s_nop 0
    s_waitcnt lgkmcnt(8)
    v_mfma_f32_32x32x16_bf16 v[80:95], v[16:19], v[20:23], v[80:95]
    buffer_load_dwordx4 a[116:119], v3, s[40:43], s34 offen offset:1024 sc1
    ds_read_b64 v[48:49], v5 offset:2208
    ds_read_b64 v[50:51], v5 offset:2216
    ds_read_b128 v[52:55], v6 offset:24768
    v_cvt_pk_bf16_f32 v241, v234, v235
    ds_write_b32 v250, v241 offset:34896
    v_mfma_f32_32x32x16_bf16 v[96:111], v[16:19], v[24:27], v[96:111]
    ds_read_b128 v[56:59], v6 offset:27328
    ds_read_b64 v[60:61], v5 offset:160
    buffer_load_dwordx4 a[120:123], v3, s[40:43], s34 offen offset:2048 sc1
    ds_read_b64 v[62:63], v5 offset:168
    v_mfma_f32_32x32x16_bf16 v[96:111], v[28:31], v[20:23], v[96:111]
    v_cvt_pk_bf16_f32 v242, v236, v237
    ds_write_b32 v250, v242 offset:34976
    v_cvt_pk_bf16_f32 v243, v238, v239
    ds_write_b32 v250, v243 offset:35056
    s_nop 0
    s_waitcnt lgkmcnt(10)
    v_mfma_f32_32x32x16_bf16 v[80:95], v[32:35], v[36:39], v[80:95]
    ds_read_b64 v[16:17], v5 offset:2112
    buffer_load_dwordx4 a[124:127], v3, s[40:43], s34 offen offset:3072 sc1
    ds_read_b64 v[18:19], v5 offset:2120
    ds_read_b128 v[20:23], v6 offset:24656
    v_mfma_f32_32x32x16_bf16 v[96:111], v[32:35], v[40:43], v[96:111]
    ds_read_b128 v[24:27], v6 offset:27216
    ds_read_b64 v[28:29], v5 offset:64
    ds_read_b64 v[30:31], v5 offset:72
    v_mfma_f32_32x32x16_bf16 v[96:111], v[44:47], v[36:39], v[96:111]
    s_waitcnt vmcnt(12) lgkmcnt(6)
    s_barrier
    s_add_u32 s34, s23, 16384
    buffer_load_dwordx4 a[64:67], v3, s[40:43], s34 offen offset:0 sc1
    v_mfma_f32_32x32x16_bf16 v[80:95], v[48:51], v[52:55], v[80:95]
    ds_read_b64 v[32:33], v5 offset:2144
    ds_read_b64 v[34:35], v5 offset:2152
    ds_read_b128 v[36:39], v6 offset:24688
    s_lshl_b32 s6, s2, 4
    s_add_u32 s6, s6, 2228224
    v_mov_b32_e64 v2, s59
    s_cmp_eq_u32 s20, 0
    s_cselect_b64 exec, 1, 0
    buffer_store_dword v2, off, s[16:19], s6 sc1
    s_mov_b64 exec, -1
    buffer_load_dwordx4 a[68:71], v3, s[40:43], s34 offen offset:1024 sc1
    v_mfma_f32_32x32x16_bf16 v[96:111], v[48:51], v[56:59], v[96:111]
    ds_read_b128 v[40:43], v6 offset:27248
    ds_read_b64 v[44:45], v5 offset:96
    ds_read_b64 v[46:47], v5 offset:104
    s_add_u32 s27, s101, 8388608
    v_lshlrev_b32_e64 v120, 16, v132
    v_mfma_f32_32x32x16_bf16 v[96:111], v[60:63], v[52:55], v[96:111]
    v_and_b32 v124, 0xffff0000, v132
    buffer_load_dwordx4 a[72:75], v3, s[40:43], s34 offen offset:2048 sc1
    v_lshlrev_b32 v121, 16, v133
    s_waitcnt lgkmcnt(6)
    v_mfma_f32_32x32x16_bf16 v[80:95], v[16:19], v[20:23], v[80:95]
    ds_read_b64 v[48:49], v5 offset:2048
    ds_read_b64 v[50:51], v5 offset:2056
    ds_read_b128 v[52:55], v6 offset:24576
    v_and_b32 v125, 0xffff0000, v133
    v_lshlrev_b32_e64 v122, 16, v134
    v_mfma_f32_32x32x16_bf16 v[96:111], v[16:19], v[24:27], v[96:111]
    buffer_load_dwordx4 a[76:79], v3, s[40:43], s34 offen offset:3072 sc1
    ds_read_b128 v[56:59], v6 offset:27136
    ds_read_b64 v[60:61], v5 offset:0
    ds_read_b64 v[62:63], v5 offset:8
    v_and_b32 v126, 0xffff0000, v134
    v_lshlrev_b32_e64 v123, 16, v135
    v_mfma_f32_32x32x16_bf16 v[96:111], v[28:31], v[20:23], v[96:111]
    v_and_b32 v127, 0xffff0000, v135
    s_add_u32 s29, s101, 8421376
    s_add_u32 s34, s23, 4096
    buffer_load_dwordx4 a[16:19], v3, s[40:43], s34 offen offset:0 sc1
    s_waitcnt lgkmcnt(6)
    v_mfma_f32_32x32x16_bf16 v[80:95], v[32:35], v[36:39], v[80:95]
    ds_read_b64 v[16:17], v5 offset:2080
    ds_read_b64 v[18:19], v5 offset:2088
    ds_read_b128 v[20:23], v6 offset:24608
    v_lshlrev_b32 v216, 16, v228
    v_and_b32 v220, 0xffff0000, v228
    v_mfma_f32_32x32x16_bf16 v[96:111], v[32:35], v[40:43], v[96:111]
    ds_read_b128 v[24:27], v6 offset:27168
    buffer_load_dwordx4 a[20:23], v3, s[40:43], s34 offen offset:1024 sc1
    ds_read_b64 v[28:29], v5 offset:32
    ds_read_b64 v[30:31], v5 offset:40
    v_mfma_f32_32x32x16_bf16 v[96:111], v[44:47], v[36:39], v[96:111]
    v_lshlrev_b32_e64 v217, 16, v229
    v_and_b32 v221, 0xffff0000, v229
    v_lshlrev_b32 v218, 16, v230
    v_and_b32 v222, 0xffff0000, v230
    s_waitcnt lgkmcnt(6)
    v_mfma_f32_32x32x16_bf16 v[80:95], v[48:51], v[52:55], v[80:95]
    buffer_load_dwordx4 a[24:27], v3, s[40:43], s34 offen offset:2048 sc1
    ds_read_b64 v[32:33], v5 offset:37056
    ds_read_b64 v[34:35], v5 offset:37064
    ds_read_b128 v[36:39], v6 offset:32816
    v_lshlrev_b32_e64 v219, 16, v231
    v_and_b32 v223, 0xffff0000, v231
    v_mfma_f32_32x32x16_bf16 v[96:111], v[48:51], v[56:59], v[96:111]
    ds_read_b128 v[40:43], v6 offset:35376
    ds_read_b64 v[44:45], v5 offset:35008
    buffer_load_dwordx4 a[28:31], v3, s[40:43], s34 offen offset:3072 sc1
    ds_read_b64 v[46:47], v5 offset:35016
    v_mfma_f32_32x32x16_bf16 v[96:111], v[60:63], v[52:55], v[96:111]
    s_nop 0
    s_waitcnt lgkmcnt(6)
    v_mfma_f32_32x32x16_bf16 v[80:95], v[16:19], v[20:23], v[80:95]
    ds_read_b64 v[48:49], v5 offset:37088
    ds_read_b64 v[50:51], v5 offset:37096
    ds_read_b128 v[52:55], v6 offset:32848
    v_mfma_f32_32x32x16_bf16 v[96:111], v[16:19], v[24:27], v[96:111]
    ds_read_b128 v[56:59], v6 offset:35408
    s_add_u32 s34, s23, 32768
    buffer_load_dwordx4 a[128:131], v3, s[40:43], s34 offen offset:0 sc1
    ds_read_b64 v[60:61], v5 offset:35040
    ds_read_b64 v[62:63], v5 offset:35048
    v_mfma_f32_32x32x16_bf16 v[96:111], v[28:31], v[20:23], v[96:111]
    s_nop 0
    s_waitcnt lgkmcnt(6)
    v_mfma_f32_32x32x16_bf16 v[176:191], v[32:35], v[36:39], 0
    ds_read_b64 v[16:17], v5 offset:36992
    ds_read_b64 v[18:19], v5 offset:37000
    ds_read_b128 v[20:23], v6 offset:32736
    v_mfma_f32_32x32x16_bf16 v[192:207], v[32:35], v[40:43], 0
    buffer_load_dwordx4 a[132:135], v3, s[40:43], s34 offen offset:1024 sc1
    ds_read_b128 v[24:27], v6 offset:35296
    ds_read_b64 v[28:29], v5 offset:34944
    ds_read_b64 v[30:31], v5 offset:34952
    s_add_u32 m0, s25, 62400
    s_nop 0
    s_nop 0
    ds_write_addtid_b32 v80 offset:35904
    ds_write_addtid_b32 v81 offset:36160
    ds_write_addtid_b32 v82 offset:52352
    ds_write_addtid_b32 v83 offset:52608
    ds_write_addtid_b32 v84 offset:36416
    ds_write_addtid_b32 v85 offset:36672
    ds_write_addtid_b32 v86 offset:52864
    ds_write_addtid_b32 v87 offset:53120
    ds_write_addtid_b32 v88 offset:44128
    ds_write_addtid_b32 v89 offset:44384
    ds_write_addtid_b32 v90 offset:60576
    ds_write_addtid_b32 v91 offset:60832
    v_mfma_f32_32x32x16_bf16 v[192:207], v[44:47], v[36:39], v[192:207]
    ds_write_addtid_b32 v92 offset:44640
    ds_write_addtid_b32 v93 offset:44896
    ds_write_addtid_b32 v94 offset:61088
    ds_write_addtid_b32 v95 offset:61344
    ds_write_addtid_b32 v96 offset:40000
    ds_write_addtid_b32 v97 offset:40256
    ds_write_addtid_b32 v98 offset:56448
    ds_write_addtid_b32 v99 offset:56704
    ds_write_addtid_b32 v100 offset:40512
    ds_write_addtid_b32 v101 offset:40768
    ds_write_addtid_b32 v102 offset:56960
    ds_write_addtid_b32 v103 offset:57216
    ds_write_addtid_b32 v104 offset:48224
    ds_write_addtid_b32 v105 offset:48480
    ds_write_addtid_b32 v106 offset:64672
    s_nop 0
    s_waitcnt lgkmcnt(15)
    v_mfma_f32_32x32x16_bf16 v[176:191], v[48:51], v[52:55], v[176:191]
    ds_read_b64 v[32:33], v5 offset:37024
    ds_read_b64 v[34:35], v5 offset:37032
    ds_read_b128 v[36:39], v6 offset:32768
    ds_write_addtid_b32 v107 offset:64928
    ds_write_addtid_b32 v108 offset:48736
    ds_write_addtid_b32 v109 offset:48992
    ds_write_addtid_b32 v110 offset:65184
    ds_write_addtid_b32 v111 offset:65440
    s_waitcnt lgkmcnt(0)
    s_barrier
    ds_read_b128 v[80:83], v12 offset:0
    ds_read_b128 v[84:87], v12 offset:256
    ds_read_b128 v[88:91], v12 offset:1024
    ds_read_b128 v[92:95], v12 offset:1280
    ds_read_b128 v[96:99], v12 offset:2048
    ds_read_b128 v[100:103], v12 offset:2304
    ds_read_b128 v[104:107], v12 offset:3072
    ds_read_b128 v[108:111], v12 offset:3328
    v_mfma_f32_32x32x16_bf16 v[192:207], v[48:51], v[56:59], v[192:207]
    ds_read_b128 v[40:43], v6 offset:35328
    ds_read_b64 v[44:45], v5 offset:34976
    ds_read_b64 v[46:47], v5 offset:34984
    v_mfma_f32_32x32x16_bf16 v[192:207], v[60:63], v[52:55], v[192:207]
    v_mfma_f32_32x32x16_bf16 v[176:191], v[16:19], v[20:23], v[176:191]
    ds_read_b64 v[48:49], v5 offset:36928
    ds_read_b64 v[50:51], v5 offset:36936
    ds_read_b128 v[52:55], v6 offset:32656
    s_waitcnt lgkmcnt(10)
    v_pk_add_f32 v[80:81], v[80:81], v[88:89]
    v_pk_add_f32 v[82:83], v[82:83], v[90:91]
    v_pk_add_f32 v[84:85], v[84:85], v[92:93]
    v_pk_add_f32 v[86:87], v[86:87], v[94:95]
    s_waitcnt lgkmcnt(6)
    v_pk_add_f32 v[96:97], v[96:97], v[104:105]
    v_pk_add_f32 v[98:99], v[98:99], v[106:107]
    v_pk_add_f32 v[100:101], v[100:101], v[108:109]
    v_pk_add_f32 v[102:103], v[102:103], v[110:111]
    v_pk_add_f32 v[80:81], v[80:81], v[96:97]
    v_pk_add_f32 v[82:83], v[82:83], v[98:99]
    v_pk_add_f32 v[84:85], v[84:85], v[100:101]
    v_pk_add_f32 v[86:87], v[86:87], v[102:103]
    v_pk_fma_f32 v[80:81], v[80:81], s[52:53], v[120:121] op_sel:[0,0,0] op_sel_hi:[1,0,1]
    v_pk_fma_f32 v[82:83], v[82:83], s[52:53], v[122:123] op_sel:[0,0,0] op_sel_hi:[1,0,1]
    v_pk_fma_f32 v[84:85], v[84:85], s[52:53], v[124:125] op_sel:[0,0,0] op_sel_hi:[1,0,1]
    v_pk_fma_f32 v[86:87], v[86:87], s[52:53], v[126:127] op_sel:[0,0,0] op_sel_hi:[1,0,1]
    v_pk_mul_f32 v[96:97], v[80:81], s[54:55] op_sel:[0,0] op_sel_hi:[1,0]
    v_pk_mul_f32 v[98:99], v[82:83], s[54:55] op_sel:[0,0] op_sel_hi:[1,0]
    v_pk_mul_f32 v[100:101], v[84:85], s[54:55] op_sel:[0,0] op_sel_hi:[1,0]
    v_pk_mul_f32 v[102:103], v[86:87], s[54:55] op_sel:[0,0] op_sel_hi:[1,0]
    v_cvt_pk_bf16_f32 v92, v96, v97
    v_cvt_pk_bf16_f32 v93, v98, v99
    v_cvt_pk_bf16_f32 v94, v100, v101
    v_cvt_pk_bf16_f32 v95, v102, v103
    buffer_store_dwordx4 v[92:95], v14, s[16:19], s27 offen sc1
    v_mfma_f32_32x32x16_bf16 v[192:207], v[16:19], v[24:27], v[192:207]
    ds_read_b128 v[56:59], v6 offset:35216
    ds_read_b64 v[60:61], v5 offset:34880
    ds_read_b64 v[62:63], v5 offset:34888
    v_and_b32_e64 v7, 3, v0
    v_lshlrev_b32 v7, 3, v7
    v_bfe_u32 v1, v0, 4, 1
    v_mfma_f32_32x32x16_bf16 v[192:207], v[28:31], v[20:23], v[192:207]
    v_lshl_add_u32 v7, v1, 5, v7
    buffer_load_dwordx4 a[136:139], v3, s[40:43], s34 offen offset:2048 sc1
    v_bfe_u32 v1, v0, 2, 2
    v_lshl_add_u32 v7, v1, 7, v7
    s_waitcnt lgkmcnt(6)
    v_mfma_f32_32x32x16_bf16 v[176:191], v[32:35], v[36:39], v[176:191]
    ds_read_b64 v[16:17], v5 offset:36960
    ds_read_b64 v[18:19], v5 offset:36968
    buffer_load_dwordx4 a[140:143], v3, s[40:43], s34 offen offset:3072 sc1
    ds_read_b128 v[20:23], v6 offset:32688
    v_bfe_u32 v1, v0, 5, 1
    v_mfma_f32_32x32x16_bf16 v[192:207], v[32:35], v[40:43], v[192:207]
    ds_read_b128 v[24:27], v6 offset:35248
    ds_read_b64 v[28:29], v5 offset:34912
    s_add_u32 s34, s23, 36864
    buffer_load_dwordx4 a[144:147], v3, s[40:43], s34 offen offset:0 sc1
    ds_read_b64 v[30:31], v5 offset:34920
    v_mfma_f32_32x32x16_bf16 v[192:207], v[44:47], v[36:39], v[192:207]
    v_lshl_add_u32 v7, v1, 10, v7
    v_bfe_u32 v1, v0, 3, 1
    v_lshl_add_u32 v7, v1, 6, v7
    buffer_load_dwordx4 a[148:151], v3, s[40:43], s34 offen offset:1024 sc1
    s_nop 0
    s_waitcnt lgkmcnt(6)
    v_mfma_f32_32x32x16_bf16 v[176:191], v[48:51], v[52:55], v[176:191]
    ds_read_b64 v[32:33], v5 offset:36864
    ds_read_b64 v[34:35], v5 offset:36872
    ds_read_b128 v[36:39], v6 offset:32576
    v_mfma_f32_32x32x16_bf16 v[192:207], v[48:51], v[56:59], v[192:207]
    buffer_load_dwordx4 a[152:155], v3, s[40:43], s34 offen offset:2048 sc1
    ds_read_b128 v[40:43], v6 offset:35136
    ds_read_b64 v[44:45], v5 offset:34816
    ds_read_b64 v[46:47], v5 offset:34824
    v_mfma_f32_32x32x16_bf16 v[192:207], v[60:63], v[52:55], v[192:207]
    s_nop 0
    s_waitcnt lgkmcnt(6)
    v_mfma_f32_32x32x16_bf16 v[176:191], v[16:19], v[20:23], v[176:191]
    buffer_load_dwordx4 a[156:159], v3, s[40:43], s34 offen offset:3072 sc1
    ds_read_b64 v[48:49], v5 offset:36896
    ds_read_b64 v[50:51], v5 offset:36904
    ds_read_b128 v[52:55], v6 offset:32608
    v_mfma_f32_32x32x16_bf16 v[192:207], v[16:19], v[24:27], v[192:207]
    ds_read_b128 v[56:59], v6 offset:35168
    s_add_u32 s34, s23, 8192
    buffer_load_dwordx4 a[32:35], v3, s[40:43], s34 offen offset:0 sc1
    ds_read_b64 v[60:61], v5 offset:34848
    ds_read_b64 v[62:63], v5 offset:34856
    v_mfma_f32_32x32x16_bf16 v[192:207], v[28:31], v[20:23], v[192:207]
    s_nop 0
    s_waitcnt lgkmcnt(6)
    v_mfma_f32_32x32x16_bf16 v[176:191], v[32:35], v[36:39], v[176:191]
    ds_read_b64 v[16:17], v5 offset:36800
    buffer_load_dwordx4 a[36:39], v3, s[40:43], s34 offen offset:1024 sc1
    ds_read_b64 v[18:19], v5 offset:36808
    ds_read_b128 v[20:23], v6 offset:32496
    v_mfma_f32_32x32x16_bf16 v[192:207], v[32:35], v[40:43], v[192:207]
    ds_read_b128 v[24:27], v6 offset:35056
    ds_read_b64 v[28:29], v5 offset:34752
    buffer_load_dwordx4 a[40:43], v3, s[40:43], s34 offen offset:2048 sc1
    ds_read_b64 v[30:31], v5 offset:34760
    v_mfma_f32_32x32x16_bf16 v[192:207], v[44:47], v[36:39], v[192:207]
    s_nop 0
    s_waitcnt lgkmcnt(6)
    v_mfma_f32_32x32x16_bf16 v[176:191], v[48:51], v[52:55], v[176:191]
    ds_read_b64 v[32:33], v5 offset:36832
    ds_read_b64 v[34:35], v5 offset:36840
    buffer_load_dwordx4 a[44:47], v3, s[40:43], s34 offen offset:3072 sc1
    ds_read_b128 v[36:39], v6 offset:32528
    s_mov_b32 s7, 2228224
    buffer_load_dword v252, v4, s[16:19], s7 offen sc1
    v_mfma_f32_32x32x16_bf16 v[192:207], v[48:51], v[56:59], v[192:207]
    s_branch pg2_s
.p2align 12
pg2_h:
    s_branch wh_ret
pg2_l:
    s_endpgm
pg2_s:
    ds_read_b128 v[40:43], v6 offset:35088
    s_add_u32 s34, s23, 20480
    buffer_load_dwordx4 a[80:83], v3, s[40:43], s34 offen offset:0 sc1
    ds_read_b64 v[44:45], v5 offset:34784
    ds_read_b64 v[46:47], v5 offset:34792
    v_mfma_f32_32x32x16_bf16 v[192:207], v[60:63], v[52:55], v[192:207]
    s_nop 0
    s_waitcnt lgkmcnt(6)
    v_mfma_f32_32x32x16_bf16 v[176:191], v[16:19], v[20:23], v[176:191]
    ds_read_b64 v[48:49], v5 offset:36736
    buffer_load_dwordx4 a[84:87], v3, s[40:43], s34 offen offset:1024 sc1
    ds_read_b64 v[50:51], v5 offset:36744
    ds_read_b128 v[52:55], v6 offset:32416
    v_mfma_f32_32x32x16_bf16 v[192:207], v[16:19], v[24:27], v[192:207]
    ds_read_b128 v[56:59], v6 offset:34976
    ds_read_b64 v[60:61], v5 offset:34688
    buffer_load_dwordx4 a[88:91], v3, s[40:43], s34 offen offset:2048 sc1
    ds_read_b64 v[62:63], v5 offset:34696
    v_mfma_f32_32x32x16_bf16 v[192:207], v[28:31], v[20:23], v[192:207]
    s_nop 0
    s_waitcnt lgkmcnt(6)
    v_mfma_f32_32x32x16_bf16 v[176:191], v[32:35], v[36:39], v[176:191]
    ds_read_b64 v[16:17], v5 offset:36768
    ds_read_b64 v[18:19], v5 offset:36776
    buffer_load_dwordx4 a[92:95], v3, s[40:43], s34 offen offset:3072 sc1
    ds_read_b128 v[20:23], v6 offset:32448
    v_mfma_f32_32x32x16_bf16 v[192:207], v[32:35], v[40:43], v[192:207]
    ds_read_b128 v[24:27], v6 offset:35008
    ds_read_b64 v[28:29], v5 offset:34720
    ds_read_b64 v[30:31], v5 offset:34728
    s_add_u32 s34, s23, 12288
    buffer_load_dwordx4 a[48:51], v3, s[40:43], s34 offen offset:0 sc1
    v_mfma_f32_32x32x16_bf16 v[192:207], v[44:47], v[36:39], v[192:207]
    s_nop 0
    s_waitcnt lgkmcnt(6)
    v_mfma_f32_32x32x16_bf16 v[176:191], v[48:51], v[52:55], v[176:191]
    ds_read_b64 v[32:33], v5 offset:36672
    ds_read_b64 v[34:35], v5 offset:36680
    ds_read_b128 v[36:39], v6 offset:32336
    buffer_load_dwordx4 a[52:55], v3, s[40:43], s34 offen offset:1024 sc1
    v_mfma_f32_32x32x16_bf16 v[192:207], v[48:51], v[56:59], v[192:207]
    ds_read_b128 v[40:43], v6 offset:34896
    ds_read_b64 v[44:45], v5 offset:34624
    ds_read_b64 v[46:47], v5 offset:34632
    v_mfma_f32_32x32x16_bf16 v[192:207], v[60:63], v[52:55], v[192:207]
    buffer_load_dwordx4 a[56:59], v3, s[40:43], s34 offen offset:2048 sc1
    s_nop 0
    s_waitcnt lgkmcnt(6)
    v_mfma_f32_32x32x16_bf16 v[176:191], v[16:19], v[20:23], v[176:191]
    ds_read_b64 v[48:49], v5 offset:36704
    ds_read_b64 v[50:51], v5 offset:36712
    ds_read_b128 v[52:55], v6 offset:32368
    v_mfma_f32_32x32x16_bf16 v[192:207], v[16:19], v[24:27], v[192:207]
    buffer_load_dwordx4 a[60:63], v3, s[40:43], s34 offen offset:3072 sc1
    ds_read_b128 v[56:59], v6 offset:34928
    ds_read_b64 v[60:61], v5 offset:34656
    ds_read_b64 v[62:63], v5 offset:34664
    v_mfma_f32_32x32x16_bf16 v[192:207], v[28:31], v[20:23], v[192:207]
    s_waitcnt lgkmcnt(6)
    v_mfma_f32_32x32x16_bf16 v[176:191], v[32:35], v[36:39], v[176:191]
    ds_read_b64 v[16:17], v5 offset:36608
    ds_read_b64 v[18:19], v5 offset:36616
    ds_read_b128 v[20:23], v6 offset:32256
    v_mfma_f32_32x32x16_bf16 v[192:207], v[32:35], v[40:43], v[192:207]
    ds_read_b128 v[24:27], v6 offset:34816
    ds_read_b64 v[28:29], v5 offset:34560
    ds_read_b64 v[30:31], v5 offset:34568
    v_mfma_f32_32x32x16_bf16 v[192:207], v[44:47], v[36:39], v[192:207]
    s_waitcnt lgkmcnt(6)
    v_mfma_f32_32x32x16_bf16 v[176:191], v[48:51], v[52:55], v[176:191]
    ds_read_b64 v[32:33], v5 offset:36640
    ds_read_b64 v[34:35], v5 offset:36648
    ds_read_b128 v[36:39], v6 offset:32288
    v_mfma_f32_32x32x16_bf16 v[192:207], v[48:51], v[56:59], v[192:207]
    ds_read_b128 v[40:43], v6 offset:34848
    ds_read_b64 v[44:45], v5 offset:34592
    ds_read_b64 v[46:47], v5 offset:34600
    v_mfma_f32_32x32x16_bf16 v[192:207], v[60:63], v[52:55], v[192:207]
    s_waitcnt lgkmcnt(6)
    v_mfma_f32_32x32x16_bf16 v[176:191], v[16:19], v[20:23], v[176:191]
    v_mfma_f32_32x32x16_bf16 v[192:207], v[16:19], v[24:27], v[192:207]
    v_mfma_f32_32x32x16_bf16 v[192:207], v[28:31], v[20:23], v[192:207]
    s_waitcnt lgkmcnt(0)
    v_mfma_f32_32x32x16_bf16 v[176:191], v[32:35], v[36:39], v[176:191]
    s_waitcnt vmcnt(8)
    v_cmp_ne_u32 vcc, s59, v252
    s_cbranch_vccnz kf_rf_h
kf_rf_h_ret:
    v_mfma_f32_32x32x16_bf16 v[192:207], v[32:35], v[40:43], v[192:207]
    v_mfma_f32_32x32x16_bf16 v[192:207], v[44:47], v[36:39], v[192:207]
    s_add_u32 m0, s25, 62400
    s_load_dwordx2 s[36:37], s[0:1], 120
    s_nop 4
    ds_write_addtid_b32 v176 offset:35904
    ds_write_addtid_b32 v177 offset:36160
    ds_write_addtid_b32 v178 offset:52352
    ds_write_addtid_b32 v179 offset:52608
    ds_write_addtid_b32 v180 offset:36416
    ds_write_addtid_b32 v181 offset:36672
    ds_write_addtid_b32 v182 offset:52864
    ds_write_addtid_b32 v183 offset:53120
    ds_write_addtid_b32 v184 offset:44128
    ds_write_addtid_b32 v185 offset:44384
    ds_write_addtid_b32 v186 offset:60576
    ds_write_addtid_b32 v187 offset:60832
    ds_write_addtid_b32 v188 offset:44640
    ds_write_addtid_b32 v189 offset:44896
    ds_write_addtid_b32 v190 offset:61088
    ds_write_addtid_b32 v191 offset:61344
    ds_write_addtid_b32 v192 offset:40000
    ds_write_addtid_b32 v193 offset:40256
    ds_write_addtid_b32 v194 offset:56448
    ds_write_addtid_b32 v195 offset:56704
    ds_write_addtid_b32 v196 offset:40512
    ds_write_addtid_b32 v197 offset:40768
    ds_write_addtid_b32 v198 offset:56960
    ds_write_addtid_b32 v199 offset:57216
    ds_write_addtid_b32 v200 offset:48224
    ds_write_addtid_b32 v201 offset:48480
    ds_write_addtid_b32 v202 offset:64672
    ds_write_addtid_b32 v203 offset:64928
    ds_write_addtid_b32 v204 offset:48736
    ds_write_addtid_b32 v205 offset:48992
    ds_write_addtid_b32 v206 offset:65184
    ds_write_addtid_b32 v207 offset:65440
kf_tail0:
    s_waitcnt lgkmcnt(0)
    s_barrier
    ds_read_b128 v[176:179], v12 offset:0
    ds_read_b128 v[180:183], v12 offset:256
    ds_read_b128 v[184:187], v12 offset:1024
    ds_read_b128 v[188:191], v12 offset:1280
    ds_read_b128 v[192:195], v12 offset:2048
    ds_read_b128 v[196:199], v12 offset:2304
    ds_read_b128 v[200:203], v12 offset:3072
    ds_read_b128 v[204:207], v12 offset:3328
    s_add_u32 m0, s25, 0
    s_xor_b32 s15, s21, 0
    buffer_load_dwordx4 v3, s[16:19], s15 offen sc1 lds
    s_add_u32 m0, s25, 57344
    s_xor_b32 s15, s21, 65536
    buffer_load_dwordx4 v3, s[16:19], s15 offen sc1 lds
    s_add_u32 m0, s25, 4096
    s_xor_b32 s15, s21, 2048
    buffer_load_dwordx4 v3, s[16:19], s15 offen sc1 lds
    s_add_u32 m0, s25, 61440
    s_xor_b32 s15, s21, 67584
    buffer_load_dwordx4 v3, s[16:19], s15 offen sc1 lds
    s_add_u32 m0, s25, 8192
    s_xor_b32 s15, s21, 4096
    buffer_load_dwordx4 v3, s[16:19], s15 offen sc1 lds
    s_add_u32 m0, s25, 65536
    s_xor_b32 s15, s21, 69632
    buffer_load_dwordx4 v3, s[16:19], s15 offen sc1 lds
    s_add_u32 m0, s25, 12288
    s_xor_b32 s15, s21, 6144
    buffer_load_dwordx4 v3, s[16:19], s15 offen sc1 lds
    s_add_u32 m0, s25, 69632
    s_xor_b32 s15, s21, 71680
    buffer_load_dwordx4 v3, s[16:19], s15 offen sc1 lds
    s_waitcnt lgkmcnt(4)
    v_pk_add_f32 v[176:177], v[176:177], v[184:185]
    v_pk_add_f32 v[178:179], v[178:179], v[186:187]
    v_pk_add_f32 v[180:181], v[180:181], v[188:189]
    v_pk_add_f32 v[182:183], v[182:183], v[190:191]
    s_waitcnt lgkmcnt(0)
    v_pk_add_f32 v[192:193], v[192:193], v[200:201]
    v_pk_add_f32 v[194:195], v[194:195], v[202:203]
    v_pk_add_f32 v[196:197], v[196:197], v[204:205]
    v_pk_add_f32 v[198:199], v[198:199], v[206:207]
    v_pk_add_f32 v[176:177], v[176:177], v[192:193]
    v_pk_add_f32 v[178:179], v[178:179], v[194:195]
    v_pk_add_f32 v[180:181], v[180:181], v[196:197]
    v_pk_add_f32 v[182:183], v[182:183], v[198:199]
    v_pk_fma_f32 v[176:177], v[176:177], s[52:53], v[216:217] op_sel:[0,1,0] op_sel_hi:[1,1,1]
    v_pk_fma_f32 v[178:179], v[178:179], s[52:53], v[218:219] op_sel:[0,1,0] op_sel_hi:[1,1,1]
    v_pk_fma_f32 v[180:181], v[180:181], s[52:53], v[220:221] op_sel:[0,1,0] op_sel_hi:[1,1,1]
    v_pk_fma_f32 v[182:183], v[182:183], s[52:53], v[222:223] op_sel:[0,1,0] op_sel_hi:[1,1,1]
    v_pk_mul_f32 v[192:193], v[176:177], s[54:55] op_sel:[0,1] op_sel_hi:[1,1]
    v_pk_mul_f32 v[194:195], v[178:179], s[54:55] op_sel:[0,1] op_sel_hi:[1,1]
    v_pk_mul_f32 v[196:197], v[180:181], s[54:55] op_sel:[0,1] op_sel_hi:[1,1]
    v_pk_mul_f32 v[198:199], v[182:183], s[54:55] op_sel:[0,1] op_sel_hi:[1,1]
    v_cvt_pk_bf16_f32 v188, v192, v193
    v_cvt_pk_bf16_f32 v189, v194, v195
    v_cvt_pk_bf16_f32 v190, v196, v197
    v_cvt_pk_bf16_f32 v191, v198, v199
    buffer_store_dwordx4 v[188:191], v14, s[16:19], s29 offen sc1
    s_add_u32 m0, s25, 16384
    s_xor_b32 s15, s21, 16384
    buffer_load_dwordx4 v3, s[16:19], s15 offen sc1 lds
    s_add_u32 m0, s25, 73728
    s_xor_b32 s15, s21, 81920
    buffer_load_dwordx4 v3, s[16:19], s15 offen sc1 lds
    s_add_u32 m0, s25, 20480
    s_xor_b32 s15, s21, 18432
    buffer_load_dwordx4 v3, s[16:19], s15 offen sc1 lds
    s_add_u32 m0, s25, 77824
    s_xor_b32 s15, s21, 83968
    buffer_load_dwordx4 v3, s[16:19], s15 offen sc1 lds
    s_branch pg3_s
pg3_l:
    s_branch pg9_l
pg3_s:
kf_tail:
    v_add_u32 v10, 57344, v15
    v_xor_b32 v5, 64, v7
    v_add_u32 v6, 57344, v7
    v_add_u32 v8, 57344, v5
    s_waitcnt vmcnt(9)
    ds_read2st64_b32 v[118:119], v15 offset0:0 offset1:16
    ds_read2st64_b32 v[120:121], v10 offset0:0 offset1:16
    s_waitcnt lgkmcnt(0)
    v_max_u32 v118, v118, v119
    v_max3_u32 v118, v118, v120, v121
    v_cmp_eq_u32_e64 vcc, -1, v118
    s_cbranch_vccnz kf_rx0
kf_rx0_ret:
    s_barrier
    ds_read_b64_tr_b16 v[16:17], v7 offset:0
    ds_read_b64_tr_b16 v[18:19], v7 offset:512
    ds_read_b64_tr_b16 v[20:21], v5 offset:0
    ds_read_b64_tr_b16 v[22:23], v5 offset:512
    ds_read_b64_tr_b16 v[24:25], v6 offset:0
    ds_read_b64_tr_b16 v[26:27], v6 offset:512
    ds_read_b64_tr_b16 v[28:29], v8 offset:0
    ds_read_b64_tr_b16 v[30:31], v8 offset:512
    s_waitcnt lgkmcnt(4)
    v_mfma_f32_32x32x16_bf16 v[128:143], a[0:3], v[16:19], 0
    ds_read_b64_tr_b16 v[32:33], v7 offset:2048
    ds_read_b64_tr_b16 v[34:35], v7 offset:2560
    v_bfe_u32 v56, v0, 5, 1
    v_and_b32_e64 v61, 31, v0
    s_lshl_b32 s3, s14, 9
    v_lshl_add_u32 v9, v61, 3, s3
    v_mfma_f32_32x32x16_bf16 v[144:159], a[4:7], v[16:19], 0
    ds_read_b64_tr_b16 v[36:37], v5 offset:2048
    ds_read_b64_tr_b16 v[38:39], v5 offset:2560
    v_xor_b32 v104, 512, v9
    s_lshl_b32 s6, s12, 13
    s_lshl_b32 s7, s20, 11
    s_add_u32 s6, s6, s7
    v_mfma_f32_32x32x16_bf16 v[160:175], a[0:3], v[20:23], 0
    s_add_u32 s34, s23, 40960
    buffer_load_dwordx4 a[160:163], v3, s[16:19], s34 offen offset:0 sc1
    v_mul_u32_u24 v11, 0x600, v56
    v_xor_b32 v11, v11, v7
    v_xor_b32 v11, s6, v11
    v_xor_b32 v13, 64, v11
    v_mfma_f32_32x32x16_bf16 v[176:191], a[4:7], v[20:23], 0
    buffer_load_dwordx4 a[164:167], v3, s[16:19], s34 offen offset:1024 sc1
    v_add_u32_e64 v14, s7, v3
    s_lshl_b32 s6, s13, 7
    s_lshl4_add_u32 s6, s14, s6
    s_xor_b32 s6, s6, 16
    s_waitcnt lgkmcnt(4)
    v_mfma_f32_32x32x16_bf16 v[192:207], a[0:3], v[24:27], 0
    ds_read_b64_tr_b16 v[16:17], v6 offset:2048
    ds_read_b64_tr_b16 v[18:19], v6 offset:2560
    v_and_b32 v63, 3, v0
    v_bfe_u32 v62, v0, 2, 3
    v_lshl_add_u32 v12, v63, 5, s6
    v_add_u32 v12, v12, v62
    v_mfma_f32_32x32x16_bf16 v[208:223], a[4:7], v[24:27], 0
    ds_read_b64_tr_b16 v[20:21], v8 offset:2048
    ds_read_b64_tr_b16 v[22:23], v8 offset:2560
    v_mul_u32_u24 v12, 896, v12
    v_lshl_add_u32 v12, v56, 4, v12
    s_lshl_b32 s6, s12, 7
    s_lshl_b32 s7, s20, 5
    v_mfma_f32_32x32x16_bf16 v[224:239], a[0:3], v[28:31], 0
    buffer_load_dwordx4 a[168:171], v3, s[16:19], s34 offen offset:2048 sc1
    s_add_u32 s6, s6, s7
    v_add_u32 v12, s6, v12
    s_mul_i32 s27, s12, 229376
    s_add_u32 s27, s27, 10485760
    v_mfma_f32_32x32x16_bf16 v[240:255], a[4:7], v[28:31], 0
    buffer_load_dwordx4 a[172:175], v3, s[16:19], s34 offen offset:3072 sc1
    s_lshr_b32 s6, s20, 1
    s_lshl_b32 s6, s6, 13
    s_add_u32 s27, s27, s6
    s_mul_i32 s3, s14, 114688
    s_waitcnt lgkmcnt(4)
    v_mfma_f32_32x32x16_bf16 v[128:143], a[8:11], v[32:35], v[128:143]
    ds_read_b64_tr_b16 v[24:25], v7 offset:4096
    ds_read_b64_tr_b16 v[26:27], v7 offset:4608
    s_lshl_b32 s38, s20, 11
    s_add_u32 s38, s38, s3
    s_lshl_b32 s3, s3, 1
    s_sub_u32 s3, 114688, s3
    v_mfma_f32_32x32x16_bf16 v[144:159], a[12:15], v[32:35], v[144:159]
    ds_read_b64_tr_b16 v[28:29], v5 offset:4096
    ds_read_b64_tr_b16 v[30:31], v5 offset:4608
    s_add_u32 s27, s27, s38
    s_xor_b32 s28, s27, 8192
    s_and_b32 s6, s20, 1
    s_lshl_b32 s6, s6, 8
    v_mfma_f32_32x32x16_bf16 v[160:175], a[8:11], v[36:39], v[160:175]
    s_add_u32 s34, s23, 45056
    buffer_load_dwordx4 a[176:179], v3, s[16:19], s34 offen offset:0 sc1
    v_xor_b32 v113, s6, v3
    s_and_b32 s6, s13, 7
    s_lshr_b32 s7, s13, 3
    s_xor_b32 s7, s7, s6
    v_mfma_f32_32x32x16_bf16 v[176:191], a[12:15], v[36:39], v[176:191]
    buffer_load_dwordx4 a[180:183], v3, s[16:19], s34 offen offset:1024 sc1
    s_and_b32 s7, s7, 1
    s_lshl_b32 s7, s7, 13
    s_xor_b32 s7, s7, s93
    s_lshl_b32 s6, s6, 21
    s_waitcnt lgkmcnt(4)
    v_mfma_f32_32x32x16_bf16 v[192:207], a[8:11], v[16:19], v[192:207]
    ds_read_b64_tr_b16 v[32:33], v6 offset:4096
    ds_read_b64_tr_b16 v[34:35], v6 offset:4608
    s_add_u32 s7, s7, s6
    s_add_u32 s29, s7, 12582912
    s_add_u32 s29, s29, s38
    s_add_u32 s42, s29, 229376
    v_mfma_f32_32x32x16_bf16 v[208:223], a[12:15], v[16:19], v[208:223]
    ds_read_b64_tr_b16 v[36:37], v8 offset:4096
    ds_read_b64_tr_b16 v[38:39], v8 offset:4608
    s_add_u32 s43, s42, 458752
    s_lshl_b32 s49, s12, 14
    s_add_u32 s35, s29, s49
    s_add_u32 s58, s35, 229376
    v_mfma_f32_32x32x16_bf16 v[224:239], a[8:11], v[20:23], v[224:239]
    buffer_load_dwordx4 a[184:187], v3, s[16:19], s34 offen offset:2048 sc1
    s_add_u32 s32, s35, s3
    s_and_b32 s6, s13, 7
    s_mul_i32 s100, s6, 229376
    s_lshr_b32 s6, s13, 3
    v_mfma_f32_32x32x16_bf16 v[240:255], a[12:15], v[20:23], v[240:255]
    buffer_load_dwordx4 a[188:191], v3, s[16:19], s34 offen offset:3072 sc1
    s_lshl_b32 s6, s6, 13
    s_xor_b32 s6, s6, s93
    s_add_u32 s100, s100, s6
    s_add_u32 s100, s100, s38
    s_waitcnt lgkmcnt(4)
    v_mfma_f32_32x32x16_bf16 v[128:143], a[16:19], v[24:27], v[128:143]
    ds_read_b64_tr_b16 v[16:17], v7 offset:6144
    ds_read_b64_tr_b16 v[18:19], v7 offset:6656
    s_add_u32 s100, s100, s49
    s_add_u32 s101, s100, s3
    s_add_u32 s50, s49, 16384
    s_cmp_eq_u32 s50, 114688
    s_cselect_b32 s50, 0, s50
    v_mfma_f32_32x32x16_bf16 v[144:159], a[20:23], v[24:27], v[144:159]
    ds_read_b64_tr_b16 v[20:21], v5 offset:6144
    ds_read_b64_tr_b16 v[22:23], v5 offset:6656
    s_add_u32 s51, s50, 16384
    s_cmp_eq_u32 s51, 114688
    s_cselect_b32 s51, 0, s51
    s_add_u32 s52, s51, 16384
    s_cmp_eq_u32 s52, 114688
    s_cselect_b32 s52, 0, s52
    v_mfma_f32_32x32x16_bf16 v[160:175], a[16:19], v[28:31], v[160:175]
    s_add_u32 s34, s23, 49152
    buffer_load_dwordx4 a[192:195], v3, s[16:19], s34 offen offset:0 sc1
    s_add_u32 s53, s52, 16384
    s_cmp_eq_u32 s53, 114688
    s_cselect_b32 s53, 0, s53
    s_add_u32 s54, s53, 16384
    s_cmp_eq_u32 s54, 114688
    s_cselect_b32 s54, 0, s54
    v_mfma_f32_32x32x16_bf16 v[176:191], a[20:23], v[28:31], v[176:191]
    buffer_load_dwordx4 a[196:199], v3, s[16:19], s34 offen offset:1024 sc1
    s_add_u32 s55, s54, 16384
    s_cmp_eq_u32 s55, 114688
    s_nop 0
    s_cselect_b32 s55, 0, s55
    s_add_u32 s30, s29, 458752
    s_lshl_b32 s31, s13, 10
    s_waitcnt lgkmcnt(4)
    v_mfma_f32_32x32x16_bf16 v[192:207], a[16:19], v[32:35], v[192:207]
    ds_read_b64_tr_b16 v[24:25], v6 offset:6144
    ds_read_b64_tr_b16 v[26:27], v6 offset:6656
    s_add_u32 s31, s31, 2195456
    s_mov_b32 s44, s36
    s_mov_b32 s45, s37
    s_mov_b32 s46, 1835008
    v_mfma_f32_32x32x16_bf16 v[208:223], a[20:23], v[32:35], v[208:223]
    ds_read_b64_tr_b16 v[28:29], v8 offset:6144
    ds_read_b64_tr_b16 v[30:31], v8 offset:6656
    s_mov_b32 s47, 0x20000
    v_accvgpr_write_b32 a226, 0
    v_accvgpr_write_b32 a227, 0
    v_accvgpr_write_b32 a230, 0
    v_mfma_f32_32x32x16_bf16 v[224:239], a[16:19], v[36:39], v[224:239]
    s_waitcnt vmcnt(10)
    ds_read2st64_b32 v[118:119], v15 offset0:32 offset1:48
    ds_read2st64_b32 v[120:121], v15 offset0:64 offset1:80
    ds_read2st64_b32 v[122:123], v10 offset0:32 offset1:48
    ds_read2st64_b32 v[124:125], v10 offset0:64 offset1:80
    buffer_load_dwordx4 a[200:203], v3, s[16:19], s34 offen offset:2048 sc1
    v_accvgpr_write_b32 a231, 0
    s_lshl_b32 s24, s22, 11
    v_mfma_f32_32x32x16_bf16 v[240:255], a[20:23], v[36:39], v[240:255]
    buffer_load_dwordx4 a[204:207], v3, s[16:19], s34 offen offset:3072 sc1
    s_add_u32 s24, s24, 3014656
    s_mov_b32 s40, 2211840
    s_lshl_b32 s33, s13, 13
    s_add_u32 s33, s33, 2293760
    s_waitcnt lgkmcnt(8)
    v_mfma_f32_32x32x16_bf16 v[128:143], a[24:27], v[16:19], v[128:143]
    s_waitcnt lgkmcnt(0)
    v_max_u32 v118, v118, v119
    v_max3_u32 v118, v118, v120, v121
    v_max3_u32 v118, v118, v122, v123
    v_max3_u32 v118, v118, v124, v125
    v_cmp_eq_u32_e64 vcc, -1, v118
    s_cbranch_vccnz kf_rx1
kf_rx1_ret:
    s_barrier
    ds_read_b64_tr_b16 v[32:33], v7 offset:8192
    ds_read_b64_tr_b16 v[34:35], v7 offset:8704
    v_mfma_f32_32x32x16_bf16 v[144:159], a[28:31], v[16:19], v[144:159]
    ds_read_b64_tr_b16 v[36:37], v5 offset:8192
    ds_read_b64_tr_b16 v[38:39], v5 offset:8704
    s_lshl_b32 s41, s22, 7
    s_add_u32 s41, s41, s33
    s_lshl2_add_u32 s6, s14, s20
    s_lshl_b32 s6, s6, 7
    v_mfma_f32_32x32x16_bf16 v[160:175], a[24:27], v[20:23], v[160:175]
    s_add_u32 s34, s23, 53248
    buffer_load_dwordx4 a[208:211], v3, s[16:19], s34 offen offset:0 sc1
    s_add_u32 s6, s6, 7168
    v_mov_b32 v112, s6
    s_mul_i32 s6, s14, 28
    s_add_u32 s6, s6, s20
    v_mfma_f32_32x32x16_bf16 v[176:191], a[28:31], v[20:23], v[176:191]
    buffer_load_dwordx4 a[212:215], v3, s[16:19], s34 offen offset:1024 sc1
    s_lshl_b32 s6, s6, 7
    v_lshl_add_u32 v109, v3, 5, s6
    v_cmp_gt_u32 vcc, 112, v3
    s_nop 1
    v_cndmask_b32 v109, v112, v109, vcc
    v_mov_b32_e64 v72, -1
    v_mfma_f32_32x32x16_bf16 v[192:207], a[24:27], v[24:27], v[192:207]
    ds_read_b64_tr_b16 v[16:17], v6 offset:8192
    ds_read_b64_tr_b16 v[18:19], v6 offset:8704
    v_mov_b32 v73, -1
    v_mov_b32 v74, -1
    v_mov_b32 v75, -1
    v_mov_b32 v95, s59
    v_mfma_f32_32x32x16_bf16 v[208:223], a[28:31], v[24:27], v[208:223]
    ds_read_b64_tr_b16 v[20:21], v8 offset:8192
    ds_read_b64_tr_b16 v[22:23], v8 offset:8704
    v_add_u32 v110, 159744, v4
    v_mul_u32_u24 v105, 0x202, v56
    v_lshl_or_b32 v105, v105, 16, v105
    v_add_u32 v105, 0x01000100, v105
    v_mfma_f32_32x32x16_bf16 v[224:239], a[24:27], v[28:31], v[224:239]
    buffer_load_dwordx4 a[216:219], v3, s[16:19], s34 offen offset:2048 sc1
    s_lshl_b32 s6, s20, 7
    s_lshl_b32 s7, s12, 9
    s_add_u32 s6, s6, s7
    s_add_u32 s6, s6, 159744
    v_mfma_f32_32x32x16_bf16 v[240:255], a[28:31], v[28:31], v[240:255]
    buffer_load_dwordx4 a[220:223], v3, s[16:19], s34 offen offset:3072 sc1
    v_lshl_add_u32 v108, v56, 5, s6
    v_mov_b32 v42, 0
    v_mov_b32_e64 v43, 0
    v_mov_b32 v46, 0
    s_waitcnt lgkmcnt(4)
    v_mfma_f32_32x32x16_bf16 v[128:143], a[32:35], v[32:35], v[128:143]
    ds_read_b64_tr_b16 v[24:25], v7 offset:10240
    ds_read_b64_tr_b16 v[26:27], v7 offset:10752
    v_mov_b32 v47, 0
    v_mov_b32 v50, 0
    v_mov_b32 v51, 0
    v_mov_b32 v54, 0
    v_mfma_f32_32x32x16_bf16 v[144:159], a[36:39], v[32:35], v[144:159]
    ds_read_b64_tr_b16 v[28:29], v5 offset:10240
    ds_read_b64_tr_b16 v[30:31], v5 offset:10752
    v_mov_b32 v55, 0
    v_mfma_f32_32x32x16_bf16 v[160:175], a[32:35], v[36:39], v[160:175]
    v_mfma_f32_32x32x16_bf16 v[176:191], a[36:39], v[36:39], v[176:191]
    s_waitcnt lgkmcnt(4)
    v_mfma_f32_32x32x16_bf16 v[192:207], a[32:35], v[16:19], v[192:207]
    ds_read_b64_tr_b16 v[32:33], v6 offset:10240
    ds_read_b64_tr_b16 v[34:35], v6 offset:10752
    v_mfma_f32_32x32x16_bf16 v[208:223], a[36:39], v[16:19], v[208:223]
    ds_read_b64_tr_b16 v[36:37], v8 offset:10240
    ds_read_b64_tr_b16 v[38:39], v8 offset:10752
    v_mfma_f32_32x32x16_bf16 v[224:239], a[32:35], v[20:23], v[224:239]
    s_add_u32 m0, s25, 24576
    s_xor_b32 s15, s21, 20480
    buffer_load_dwordx4 v3, s[16:19], s15 offen sc1 lds
    v_mfma_f32_32x32x16_bf16 v[240:255], a[36:39], v[20:23], v[240:255]
    s_add_u32 m0, s25, 28672
    s_xor_b32 s15, s21, 22528
    buffer_load_dwordx4 v3, s[16:19], s15 offen sc1 lds
    s_nop 0
    s_waitcnt lgkmcnt(4)
    v_mfma_f32_32x32x16_bf16 v[128:143], a[40:43], v[24:27], v[128:143]
    ds_read_b64_tr_b16 v[16:17], v7 offset:12288
    ds_read_b64_tr_b16 v[18:19], v7 offset:12800
    v_mfma_f32_32x32x16_bf16 v[144:159], a[44:47], v[24:27], v[144:159]
    ds_read_b64_tr_b16 v[20:21], v5 offset:12288
    ds_read_b64_tr_b16 v[22:23], v5 offset:12800
    v_mfma_f32_32x32x16_bf16 v[160:175], a[40:43], v[28:31], v[160:175]
    s_add_u32 m0, s25, 32768
    s_xor_b32 s15, s21, 32768
    buffer_load_dwordx4 v3, s[16:19], s15 offen sc1 lds
    v_mfma_f32_32x32x16_bf16 v[176:191], a[44:47], v[28:31], v[176:191]
    s_add_u32 m0, s25, 36864
    s_xor_b32 s15, s21, 34816
    buffer_load_dwordx4 v3, s[16:19], s15 offen sc1 lds
    s_nop 0
    s_waitcnt lgkmcnt(4)
    v_mfma_f32_32x32x16_bf16 v[192:207], a[40:43], v[32:35], v[192:207]
    ds_read_b64_tr_b16 v[24:25], v6 offset:12288
    ds_read_b64_tr_b16 v[26:27], v6 offset:12800
    v_mfma_f32_32x32x16_bf16 v[208:223], a[44:47], v[32:35], v[208:223]
    ds_read_b64_tr_b16 v[28:29], v8 offset:12288
    ds_read_b64_tr_b16 v[30:31], v8 offset:12800
    v_mfma_f32_32x32x16_bf16 v[224:239], a[40:43], v[36:39], v[224:239]
    s_add_u32 m0, s25, 40960
    s_xor_b32 s15, s21, 36864
    buffer_load_dwordx4 v3, s[16:19], s15 offen sc1 lds
    v_mfma_f32_32x32x16_bf16 v[240:255], a[44:47], v[36:39], v[240:255]
    s_add_u32 m0, s25, 45056
    s_xor_b32 s15, s21, 38912
    buffer_load_dwordx4 v3, s[16:19], s15 offen sc1 lds
    s_nop 0
    s_waitcnt lgkmcnt(4)
    v_mfma_f32_32x32x16_bf16 v[128:143], a[48:51], v[16:19], v[128:143]
    ds_read_b64_tr_b16 v[32:33], v7 offset:14336
    ds_read_b64_tr_b16 v[34:35], v7 offset:14848
    v_mfma_f32_32x32x16_bf16 v[144:159], a[52:55], v[16:19], v[144:159]
    ds_read_b64_tr_b16 v[36:37], v5 offset:14336
    ds_read_b64_tr_b16 v[38:39], v5 offset:14848
    v_mfma_f32_32x32x16_bf16 v[160:175], a[48:51], v[20:23], v[160:175]
    s_add_u32 m0, s25, 49152
    s_xor_b32 s15, s21, 49152
    buffer_load_dwordx4 v3, s[16:19], s15 offen sc1 lds
    v_mfma_f32_32x32x16_bf16 v[176:191], a[52:55], v[20:23], v[176:191]
    s_add_u32 m0, s25, 53248
    s_xor_b32 s15, s21, 51200
    buffer_load_dwordx4 v3, s[16:19], s15 offen sc1 lds
    s_nop 0
    s_waitcnt lgkmcnt(4)
    v_mfma_f32_32x32x16_bf16 v[192:207], a[48:51], v[24:27], v[192:207]
    ds_read_b64_tr_b16 v[16:17], v6 offset:14336
    ds_read_b64_tr_b16 v[18:19], v6 offset:14848
    v_mfma_f32_32x32x16_bf16 v[208:223], a[52:55], v[24:27], v[208:223]
    ds_read_b64_tr_b16 v[20:21], v8 offset:14336
    ds_read_b64_tr_b16 v[22:23], v8 offset:14848
    v_mfma_f32_32x32x16_bf16 v[224:239], a[48:51], v[28:31], v[224:239]
    s_add_u32 m0, s25, 81920
    s_xor_b32 s15, s21, 86016
    buffer_load_dwordx4 v3, s[16:19], s15 offen sc1 lds
    v_mfma_f32_32x32x16_bf16 v[240:255], a[52:55], v[28:31], v[240:255]
    s_add_u32 m0, s25, 86016
    s_xor_b32 s15, s21, 88064
    buffer_load_dwordx4 v3, s[16:19], s15 offen sc1 lds
    s_nop 0
    s_waitcnt lgkmcnt(4)
    v_mfma_f32_32x32x16_bf16 v[128:143], a[56:59], v[32:35], v[128:143]
    ds_read_b64_tr_b16 v[24:25], v7 offset:16384
    ds_read_b64_tr_b16 v[26:27], v7 offset:16896
    v_mfma_f32_32x32x16_bf16 v[144:159], a[60:63], v[32:35], v[144:159]
    ds_read_b64_tr_b16 v[28:29], v5 offset:16384
    ds_read_b64_tr_b16 v[30:31], v5 offset:16896
    v_mfma_f32_32x32x16_bf16 v[160:175], a[56:59], v[36:39], v[160:175]
    s_add_u32 m0, s25, 90112
    s_xor_b32 s15, s21, 98304
    buffer_load_dwordx4 v3, s[16:19], s15 offen sc1 lds
    s_add_u32 m0, s25, 94208
    s_xor_b32 s15, s21, 100352
    buffer_load_dwordx4 v3, s[16:19], s15 offen sc1 lds
    v_mfma_f32_32x32x16_bf16 v[176:191], a[60:63], v[36:39], v[176:191]
    buffer_load_dwordx4 v[114:117], v4, s[16:19], s40 offen sc1
    s_nop 0
    s_waitcnt lgkmcnt(4)
    v_mfma_f32_32x32x16_bf16 v[192:207], a[56:59], v[16:19], v[192:207]
    ds_read_b64_tr_b16 v[32:33], v6 offset:16384
    ds_read_b64_tr_b16 v[34:35], v6 offset:16896
    v_mfma_f32_32x32x16_bf16 v[208:223], a[60:63], v[16:19], v[208:223]
    ds_read_b64_tr_b16 v[36:37], v8 offset:16384
    ds_read_b64_tr_b16 v[38:39], v8 offset:16896
    v_mfma_f32_32x32x16_bf16 v[224:239], a[56:59], v[20:23], v[224:239]
    s_add_u32 m0, s25, 98304
    s_xor_b32 s15, s21, 102400
    buffer_load_dwordx4 v3, s[16:19], s15 offen sc1 lds
    v_mfma_f32_32x32x16_bf16 v[240:255], a[60:63], v[20:23], v[240:255]
    s_branch pg4_s
.p2align 12
pg4_h:
    s_branch wh_ret
pg4_l:
    s_branch wl_ret
pg4_s:
    s_add_u32 m0, s25, 102400
    s_xor_b32 s15, s21, 104448
    buffer_load_dwordx4 v3, s[16:19], s15 offen sc1 lds
    s_nop 0
    s_waitcnt lgkmcnt(4)
    v_mfma_f32_32x32x16_bf16 v[128:143], a[64:67], v[24:27], v[128:143]
    ds_read_b64_tr_b16 v[16:17], v7 offset:18432
    ds_read_b64_tr_b16 v[18:19], v7 offset:18944
    v_mfma_f32_32x32x16_bf16 v[144:159], a[68:71], v[24:27], v[144:159]
    ds_read_b64_tr_b16 v[20:21], v5 offset:18432
    ds_read_b64_tr_b16 v[22:23], v5 offset:18944
    v_mfma_f32_32x32x16_bf16 v[160:175], a[64:67], v[28:31], v[160:175]
    s_add_u32 m0, s25, 106496
    s_xor_b32 s15, s21, 114688
    buffer_load_dwordx4 v3, s[16:19], s15 offen sc1 lds
    v_mfma_f32_32x32x16_bf16 v[176:191], a[68:71], v[28:31], v[176:191]
    s_add_u32 m0, s25, 110592
    s_xor_b32 s15, s21, 116736
    buffer_load_dwordx4 v3, s[16:19], s15 offen sc1 lds
    s_nop 0
    s_waitcnt lgkmcnt(4)
    v_mfma_f32_32x32x16_bf16 v[192:207], a[64:67], v[32:35], v[192:207]
    ds_read_b64_tr_b16 v[24:25], v6 offset:18432
    ds_read_b64_tr_b16 v[26:27], v6 offset:18944
    v_mfma_f32_32x32x16_bf16 v[208:223], a[68:71], v[32:35], v[208:223]
    ds_read_b64_tr_b16 v[28:29], v8 offset:18432
    ds_read_b64_tr_b16 v[30:31], v8 offset:18944
    v_mfma_f32_32x32x16_bf16 v[224:239], a[64:67], v[36:39], v[224:239]
    s_add_u32 s8, s27, s49
    buffer_load_dwordx4 a[0:3], v113, s[16:19], s8 offen offset:0 sc1
    v_mfma_f32_32x32x16_bf16 v[240:255], a[68:71], v[36:39], v[240:255]
    s_waitcnt lgkmcnt(4)
    v_mfma_f32_32x32x16_bf16 v[128:143], a[72:75], v[16:19], v[128:143]
    ds_read_b64_tr_b16 v[32:33], v7 offset:20480
    ds_read_b64_tr_b16 v[34:35], v7 offset:20992
    v_mfma_f32_32x32x16_bf16 v[144:159], a[76:79], v[16:19], v[144:159]
    ds_read_b64_tr_b16 v[36:37], v5 offset:20480
    ds_read_b64_tr_b16 v[38:39], v5 offset:20992
    v_mfma_f32_32x32x16_bf16 v[160:175], a[72:75], v[20:23], v[160:175]
    s_add_u32 s9, s28, s49
    buffer_load_dwordx4 a[4:7], v113, s[16:19], s9 offen offset:0 sc1
    v_mfma_f32_32x32x16_bf16 v[176:191], a[76:79], v[20:23], v[176:191]
    s_waitcnt lgkmcnt(4)
    v_mfma_f32_32x32x16_bf16 v[192:207], a[72:75], v[24:27], v[192:207]
    ds_read_b64_tr_b16 v[16:17], v6 offset:20480
    ds_read_b64_tr_b16 v[18:19], v6 offset:20992
    v_mfma_f32_32x32x16_bf16 v[208:223], a[76:79], v[24:27], v[208:223]
    ds_read_b64_tr_b16 v[20:21], v8 offset:20480
    ds_read_b64_tr_b16 v[22:23], v8 offset:20992
    v_mfma_f32_32x32x16_bf16 v[224:239], a[72:75], v[28:31], v[224:239]
    buffer_load_dwordx4 a[8:11], v113, s[16:19], s8 offen offset:1024 sc1
    v_mfma_f32_32x32x16_bf16 v[240:255], a[76:79], v[28:31], v[240:255]
    s_nop 0
    s_waitcnt lgkmcnt(4)
    v_mfma_f32_32x32x16_bf16 v[128:143], a[80:83], v[32:35], v[128:143]
    ds_read_b64_tr_b16 v[24:25], v7 offset:22528
    ds_read_b64_tr_b16 v[26:27], v7 offset:23040
    v_mfma_f32_32x32x16_bf16 v[144:159], a[84:87], v[32:35], v[144:159]
    ds_read_b64_tr_b16 v[28:29], v5 offset:22528
    ds_read_b64_tr_b16 v[30:31], v5 offset:23040
    v_mfma_f32_32x32x16_bf16 v[160:175], a[80:83], v[36:39], v[160:175]
    buffer_load_dwordx4 a[12:15], v113, s[16:19], s9 offen offset:1024 sc1
    v_mfma_f32_32x32x16_bf16 v[176:191], a[84:87], v[36:39], v[176:191]
    s_add_u32 s38, s35, 0
    buffer_store_dwordx4 v[72:75], v3, s[16:19], s38 offen offset:0  sc1
    s_waitcnt lgkmcnt(4)
    v_mfma_f32_32x32x16_bf16 v[192:207], a[80:83], v[16:19], v[192:207]
    ds_read_b64_tr_b16 v[32:33], v6 offset:22528
    ds_read_b64_tr_b16 v[34:35], v6 offset:23040
    v_mfma_f32_32x32x16_bf16 v[208:223], a[84:87], v[16:19], v[208:223]
    ds_read_b64_tr_b16 v[36:37], v8 offset:22528
    ds_read_b64_tr_b16 v[38:39], v8 offset:23040
    v_mfma_f32_32x32x16_bf16 v[224:239], a[80:83], v[20:23], v[224:239]
    s_waitcnt vmcnt(20)
    ds_read2st64_b32 v[118:119], v15 offset0:96 offset1:112
    s_add_u32 s8, s27, s50
    buffer_load_dwordx4 a[16:19], v113, s[16:19], s8 offen offset:0 sc1
    v_mfma_f32_32x32x16_bf16 v[240:255], a[84:87], v[20:23], v[240:255]
    s_waitcnt lgkmcnt(5)
    v_mfma_f32_32x32x16_bf16 v[128:143], a[88:91], v[24:27], v[128:143]
    s_waitcnt lgkmcnt(0)
    v_max_u32_e64 v118, v118, v119
    v_cmp_eq_u32 vcc, -1, v118
    s_cbranch_vccnz kf_rx2
kf_rx2_ret:
    s_barrier
    ds_read_b64_tr_b16 v[16:17], v7 offset:24576
    ds_read_b64_tr_b16 v[18:19], v7 offset:25088
    v_mfma_f32_32x32x16_bf16 v[144:159], a[92:95], v[24:27], v[144:159]
    ds_read_b64_tr_b16 v[20:21], v5 offset:24576
    ds_read_b64_tr_b16 v[22:23], v5 offset:25088
    v_mfma_f32_32x32x16_bf16 v[160:175], a[88:91], v[28:31], v[160:175]
    s_add_u32 s9, s28, s50
    buffer_load_dwordx4 a[20:23], v113, s[16:19], s9 offen offset:0 sc1
    v_mfma_f32_32x32x16_bf16 v[176:191], a[92:95], v[28:31], v[176:191]
    buffer_store_dwordx4 v[72:75], v3, s[16:19], s38 offen offset:1024  sc1
    v_mfma_f32_32x32x16_bf16 v[192:207], a[88:91], v[32:35], v[192:207]
    ds_read_b64_tr_b16 v[24:25], v7 offset:26624
    ds_read_b64_tr_b16 v[26:27], v7 offset:27136
    v_mfma_f32_32x32x16_bf16 v[208:223], a[92:95], v[32:35], v[208:223]
    ds_read_b64_tr_b16 v[28:29], v5 offset:26624
    ds_read_b64_tr_b16 v[30:31], v5 offset:27136
    v_mfma_f32_32x32x16_bf16 v[224:239], a[88:91], v[36:39], v[224:239]
    buffer_load_dwordx4 a[24:27], v113, s[16:19], s8 offen offset:1024 sc1
    v_mfma_f32_32x32x16_bf16 v[240:255], a[92:95], v[36:39], v[240:255]
    s_nop 0
    s_waitcnt lgkmcnt(4)
    v_mfma_f32_32x32x16_bf16 v[128:143], a[96:99], v[16:19], v[128:143]
    ds_read_b64_tr_b16 v[32:33], v7 offset:28672
    ds_read_b64_tr_b16 v[34:35], v7 offset:29184
    v_mfma_f32_32x32x16_bf16 v[144:159], a[100:103], v[16:19], v[144:159]
    ds_read_b64_tr_b16 v[36:37], v5 offset:28672
    ds_read_b64_tr_b16 v[38:39], v5 offset:29184
    v_mfma_f32_32x32x16_bf16 v[160:175], a[96:99], v[20:23], v[160:175]
    buffer_load_dwordx4 a[28:31], v113, s[16:19], s9 offen offset:1024 sc1
    v_mfma_f32_32x32x16_bf16 v[176:191], a[100:103], v[20:23], v[176:191]
    s_add_u32 s38, s58, 0
    buffer_store_dwordx4 v[72:75], v3, s[16:19], s38 offen offset:0  sc1
    s_waitcnt lgkmcnt(4)
    v_mfma_f32_32x32x16_bf16 v[128:143], a[104:107], v[24:27], v[128:143]
    ds_read_b64_tr_b16 v[16:17], v7 offset:30720
    ds_read_b64_tr_b16 v[18:19], v7 offset:31232
    v_mfma_f32_32x32x16_bf16 v[144:159], a[108:111], v[24:27], v[144:159]
    ds_read_b64_tr_b16 v[20:21], v5 offset:30720
    ds_read_b64_tr_b16 v[22:23], v5 offset:31232
    v_mfma_f32_32x32x16_bf16 v[160:175], a[104:107], v[28:31], v[160:175]
    s_waitcnt vmcnt(22)
    ds_read2st64_b32 v[118:119], v15 offset0:128 offset1:144
    ds_read2st64_b32 v[120:121], v15 offset0:160 offset1:176
    s_add_u32 s8, s27, s51
    buffer_load_dwordx4 a[32:35], v113, s[16:19], s8 offen offset:0 sc1
    v_mfma_f32_32x32x16_bf16 v[176:191], a[108:111], v[28:31], v[176:191]
    s_waitcnt lgkmcnt(6)
    v_mfma_f32_32x32x16_bf16 v[128:143], a[112:115], v[32:35], v[128:143]
    s_waitcnt lgkmcnt(0)
    v_max_u32_e64 v118, v118, v119
    v_max3_u32 v118, v118, v120, v121
    v_cmp_eq_u32 vcc, -1, v118
    s_cbranch_vccnz kf_rx3
kf_rx3_ret:
    s_barrier
    ds_read_b64_tr_b16 v[24:25], v7 offset:32768
    ds_read_b64_tr_b16 v[26:27], v7 offset:33280
    v_mfma_f32_32x32x16_bf16 v[144:159], a[116:119], v[32:35], v[144:159]
    ds_read_b64_tr_b16 v[28:29], v5 offset:32768
    ds_read_b64_tr_b16 v[30:31], v5 offset:33280
    v_mfma_f32_32x32x16_bf16 v[160:175], a[112:115], v[36:39], v[160:175]
    s_add_u32 s9, s28, s51
    buffer_load_dwordx4 a[36:39], v113, s[16:19], s9 offen offset:0 sc1
    v_mfma_f32_32x32x16_bf16 v[176:191], a[116:119], v[36:39], v[176:191]
    buffer_store_dwordx4 v[72:75], v3, s[16:19], s38 offen offset:1024  sc1
    v_mfma_f32_32x32x16_bf16 v[128:143], a[120:123], v[16:19], v[128:143]
    ds_read_b64_tr_b16 v[32:33], v7 offset:34816
    ds_read_b64_tr_b16 v[34:35], v7 offset:35328
    v_mfma_f32_32x32x16_bf16 v[144:159], a[124:127], v[16:19], v[144:159]
    ds_read_b64_tr_b16 v[36:37], v5 offset:34816
    ds_read_b64_tr_b16 v[38:39], v5 offset:35328
    v_mfma_f32_32x32x16_bf16 v[160:175], a[120:123], v[20:23], v[160:175]
    buffer_load_dwordx4 a[40:43], v113, s[16:19], s8 offen offset:1024 sc1
    v_mfma_f32_32x32x16_bf16 v[176:191], a[124:127], v[20:23], v[176:191]
    s_nop 0
    s_waitcnt lgkmcnt(4)
    v_mfma_f32_32x32x16_bf16 v[128:143], a[128:131], v[24:27], v[128:143]
    ds_read_b64_tr_b16 v[16:17], v7 offset:36864
    ds_read_b64_tr_b16 v[18:19], v7 offset:37376
    v_mfma_f32_32x32x16_bf16 v[144:159], a[132:135], v[24:27], v[144:159]
    ds_read_b64_tr_b16 v[20:21], v5 offset:36864
    ds_read_b64_tr_b16 v[22:23], v5 offset:37376
    v_mfma_f32_32x32x16_bf16 v[160:175], a[128:131], v[28:31], v[160:175]
    buffer_load_dwordx4 a[44:47], v113, s[16:19], s9 offen offset:1024 sc1
    buffer_load_dwordx3 v[76:78], v3, s[16:19], s24 offen offset:0 sc1
    v_mfma_f32_32x32x16_bf16 v[176:191], a[132:135], v[28:31], v[176:191]
    buffer_load_dwordx3 v[80:82], v3, s[16:19], s24 offen offset:1024 sc1
    s_nop 0
    s_waitcnt lgkmcnt(4)
    v_mfma_f32_32x32x16_bf16 v[128:143], a[136:139], v[32:35], v[128:143]
    ds_read_b64_tr_b16 v[24:25], v7 offset:38912
    ds_read_b64_tr_b16 v[26:27], v7 offset:39424
    v_mfma_f32_32x32x16_bf16 v[144:159], a[140:143], v[32:35], v[144:159]
    ds_read_b64_tr_b16 v[28:29], v5 offset:38912
    ds_read_b64_tr_b16 v[30:31], v5 offset:39424
    v_mfma_f32_32x32x16_bf16 v[160:175], a[136:139], v[36:39], v[160:175]
    s_add_u32 s8, s27, s52
    buffer_load_dwordx4 a[48:51], v113, s[16:19], s8 offen offset:0 sc1
    v_mfma_f32_32x32x16_bf16 v[176:191], a[140:143], v[36:39], v[176:191]
    s_waitcnt lgkmcnt(4)
    v_mfma_f32_32x32x16_bf16 v[128:143], a[144:147], v[16:19], v[128:143]
    ds_read_b64_tr_b16 v[32:33], v7 offset:40960
    ds_read_b64_tr_b16 v[34:35], v7 offset:41472
    v_mfma_f32_32x32x16_bf16 v[144:159], a[148:151], v[16:19], v[144:159]
    ds_read_b64_tr_b16 v[36:37], v5 offset:40960
    ds_read_b64_tr_b16 v[38:39], v5 offset:41472
    v_mfma_f32_32x32x16_bf16 v[160:175], a[144:147], v[20:23], v[160:175]
    s_add_u32 s9, s28, s52
    buffer_load_dwordx4 a[52:55], v113, s[16:19], s9 offen offset:0 sc1
    v_mfma_f32_32x32x16_bf16 v[176:191], a[148:151], v[20:23], v[176:191]
    s_waitcnt lgkmcnt(4)
    v_mfma_f32_32x32x16_bf16 v[128:143], a[152:155], v[24:27], v[128:143]
    ds_read_b64_tr_b16 v[16:17], v7 offset:43008
    ds_read_b64_tr_b16 v[18:19], v7 offset:43520
    v_mfma_f32_32x32x16_bf16 v[144:159], a[156:159], v[24:27], v[144:159]
    ds_read_b64_tr_b16 v[20:21], v5 offset:43008
    ds_read_b64_tr_b16 v[22:23], v5 offset:43520
    v_mfma_f32_32x32x16_bf16 v[160:175], a[152:155], v[28:31], v[160:175]
    buffer_load_dwordx4 a[56:59], v113, s[16:19], s8 offen offset:1024 sc1
    v_mfma_f32_32x32x16_bf16 v[176:191], a[156:159], v[28:31], v[176:191]
    s_waitcnt vmcnt(25)
    v_cmp_ne_u32 vcc, s59, v114
    s_cbranch_vccnz kf_rg
kf_rg_ret:
    ds_write_b128 v110, v[114:117]
    s_waitcnt lgkmcnt(5)
    v_mfma_f32_32x32x16_bf16 v[128:143], a[160:163], v[32:35], v[128:143]
    ds_read_b64_tr_b16 v[24:25], v7 offset:45056
    ds_read_b64_tr_b16 v[26:27], v7 offset:45568
    v_mfma_f32_32x32x16_bf16 v[144:159], a[164:167], v[32:35], v[144:159]
    ds_read_b64_tr_b16 v[28:29], v5 offset:45056
    ds_read_b64_tr_b16 v[30:31], v5 offset:45568
    v_mfma_f32_32x32x16_bf16 v[160:175], a[160:163], v[36:39], v[160:175]
    buffer_load_dwordx4 a[60:63], v113, s[16:19], s9 offen offset:1024 sc1
    v_mfma_f32_32x32x16_bf16 v[176:191], a[164:167], v[36:39], v[176:191]
    s_waitcnt lgkmcnt(5)
    v_mfma_f32_32x32x16_bf16 v[128:143], a[168:171], v[16:19], v[128:143]
    ds_read_b64_tr_b16 v[32:33], v7 offset:47104
    ds_read_b64_tr_b16 v[34:35], v7 offset:47616
    v_mfma_f32_32x32x16_bf16 v[144:159], a[172:175], v[16:19], v[144:159]
    ds_read_b64_tr_b16 v[36:37], v5 offset:47104
    ds_read_b64_tr_b16 v[38:39], v5 offset:47616
    v_mfma_f32_32x32x16_bf16 v[160:175], a[168:171], v[20:23], v[160:175]
    s_waitcnt vmcnt(22)
    ds_read2st64_b32 v[118:119], v15 offset0:192 offset1:208
    ds_read2st64_b32 v[120:121], v10 offset0:96 offset1:112
    ds_read2st64_b32 v[122:123], v10 offset0:128 offset1:144
    ds_read2st64_b32 v[124:125], v10 offset0:160 offset1:176
    ds_read2st64_b32 v[126:127], v10 offset0:192 offset1:208
    s_add_u32 s9, s28, s55
    buffer_load_dwordx4 a[232:235], v113, s[16:19], s9 offen offset:1024 sc1
    v_mfma_f32_32x32x16_bf16 v[176:191], a[172:175], v[20:23], v[176:191]
    s_waitcnt lgkmcnt(9)
    v_mfma_f32_32x32x16_bf16 v[128:143], a[176:179], v[24:27], v[128:143]
    s_waitcnt lgkmcnt(0)
    v_max_u32 v118, v118, v119
    v_max3_u32 v118, v118, v120, v121
    v_max3_u32 v118, v118, v122, v123
    v_max3_u32 v118, v118, v124, v125
    v_max3_u32 v118, v118, v126, v127
    v_cmp_eq_u32 vcc, -1, v118
    s_cbranch_vccnz kf_rx4
kf_rx4_ret:
    s_barrier
    ds_read_b64_tr_b16 v[16:17], v7 offset:49152
    ds_read_b64_tr_b16 v[18:19], v7 offset:49664
    v_mfma_f32_32x32x16_bf16 v[144:159], a[180:183], v[24:27], v[144:159]
    ds_read_b64_tr_b16 v[20:21], v5 offset:49152
    ds_read_b64_tr_b16 v[22:23], v5 offset:49664
    s_add_u32 s8, s27, s55
    buffer_load_dwordx4 a[236:239], v113, s[16:19], s8 offen offset:1024 sc1
    buffer_load_dwordx2 v[96:97], v9, s[16:19], s31 offen offset:0 sc1
    v_mfma_f32_32x32x16_bf16 v[160:175], a[176:179], v[28:31], v[160:175]
    buffer_load_dwordx2 v[98:99], v9, s[16:19], s31 offen offset:256 sc1
    buffer_load_dwordx2 v[100:101], v104, s[16:19], s31 offen offset:0 sc1
    v_mfma_f32_32x32x16_bf16 v[176:191], a[180:183], v[28:31], v[176:191]
    buffer_load_dwordx2 v[102:103], v104, s[16:19], s31 offen offset:256 sc1
    v_mfma_f32_32x32x16_bf16 v[128:143], a[184:187], v[32:35], v[128:143]
    ds_read_b64_tr_b16 v[24:25], v7 offset:51200
    ds_read_b64_tr_b16 v[26:27], v7 offset:51712
    v_mfma_f32_32x32x16_bf16 v[144:159], a[188:191], v[32:35], v[144:159]
    ds_read_b64_tr_b16 v[28:29], v5 offset:51200
    ds_read_b64_tr_b16 v[30:31], v5 offset:51712
    v_mfma_f32_32x32x16_bf16 v[160:175], a[184:187], v[36:39], v[160:175]
    buffer_load_dwordx4 a[240:243], v113, s[16:19], s9 offen offset:0 sc1
    v_mfma_f32_32x32x16_bf16 v[176:191], a[188:191], v[36:39], v[176:191]
    s_waitcnt vmcnt(15)
    v_mov_b32 v72, s59
    s_mov_b64 exec, 255
    buffer_store_dwordx4 v[72:75], v3, s[16:19], s41 offen sc1
    s_mov_b64 exec, -1
    s_waitcnt lgkmcnt(4)
    v_mfma_f32_32x32x16_bf16 v[128:143], a[192:195], v[16:19], v[128:143]
    ds_read_b64_tr_b16 v[32:33], v7 offset:53248
    ds_read_b64_tr_b16 v[34:35], v7 offset:53760
    v_mfma_f32_32x32x16_bf16 v[144:159], a[196:199], v[16:19], v[144:159]
    ds_read_b64_tr_b16 v[36:37], v5 offset:53248
    ds_read_b64_tr_b16 v[38:39], v5 offset:53760
    v_mfma_f32_32x32x16_bf16 v[160:175], a[192:195], v[20:23], v[160:175]
    buffer_load_dwordx4 a[244:247], v113, s[16:19], s8 offen offset:0 sc1
    v_mfma_f32_32x32x16_bf16 v[176:191], a[196:199], v[20:23], v[176:191]
    s_nop 0
    s_waitcnt lgkmcnt(4)
    v_mfma_f32_32x32x16_bf16 v[128:143], a[200:203], v[24:27], v[128:143]
    ds_read_b64_tr_b16 v[16:17], v7 offset:55296
    ds_read_b64_tr_b16 v[18:19], v7 offset:55808
    v_mfma_f32_32x32x16_bf16 v[144:159], a[204:207], v[24:27], v[144:159]
    ds_read_b64_tr_b16 v[20:21], v5 offset:55296
    ds_read_b64_tr_b16 v[22:23], v5 offset:55808
    v_mfma_f32_32x32x16_bf16 v[160:175], a[200:203], v[28:31], v[160:175]
    s_waitcnt vmcnt(13)
    v_xor_b32 v90, s59, v76
    v_xor_b32 v91, s59, v80
    v_or_b32 v90, v90, v91
    v_cmp_ne_u32 vcc, 0, v90
    s_cbranch_vccnz kf_rb
kf_rb_ret:
    v_accvgpr_write_b32 a224, v77
    v_accvgpr_write_b32 a228, v78
    v_accvgpr_write_b32 a225, v81
    v_accvgpr_write_b32 a229, v82
    s_add_u32 s8, s27, s53
    buffer_load_dwordx4 a[64:67], v113, s[16:19], s8 offen offset:0 sc1
    v_mfma_f32_32x32x16_bf16 v[176:191], a[204:207], v[28:31], v[176:191]
    s_waitcnt lgkmcnt(4)
    v_mfma_f32_32x32x16_bf16 v[128:143], a[208:211], v[32:35], v[128:143]
    ds_read_b64_tr_b16 v[24:25], v6 offset:24576
    ds_read_b64_tr_b16 v[26:27], v6 offset:25088
    v_mfma_f32_32x32x16_bf16 v[144:159], a[212:215], v[32:35], v[144:159]
    ds_read_b64_tr_b16 v[28:29], v6 offset:26624
    ds_read_b64_tr_b16 v[30:31], v6 offset:27136
    v_mfma_f32_32x32x16_bf16 v[160:175], a[208:211], v[36:39], v[160:175]
    s_add_u32 s9, s28, s53
    buffer_load_dwordx4 a[68:71], v113, s[16:19], s9 offen offset:0 sc1
    v_mfma_f32_32x32x16_bf16 v[176:191], a[212:215], v[36:39], v[176:191]
    s_waitcnt lgkmcnt(4)
    v_mfma_f32_32x32x16_bf16 v[128:143], a[216:219], v[16:19], v[128:143]
    ds_read_b64_tr_b16 v[32:33], v6 offset:28672
    ds_read_b64_tr_b16 v[34:35], v6 offset:29184
    v_mfma_f32_32x32x16_bf16 v[144:159], a[220:223], v[16:19], v[144:159]
    ds_read_b64_tr_b16 v[36:37], v6 offset:30720
    ds_read_b64_tr_b16 v[38:39], v6 offset:31232
    v_mfma_f32_32x32x16_bf16 v[160:175], a[216:219], v[20:23], v[160:175]
    buffer_load_dwordx4 a[72:75], v113, s[16:19], s8 offen offset:1024 sc1
    v_mfma_f32_32x32x16_bf16 v[176:191], a[220:223], v[20:23], v[176:191]
    s_waitcnt vmcnt(6)
    v_xor_b32 v90, s59, v96
    v_xor_b32 v91, s59, v98
    v_xor_b32 v92, s59, v100
    v_xor_b32 v93, s59, v102
    v_or3_b32 v90, v90, v91, v92
    v_or_b32 v90, v90, v93
    v_cmp_ne_u32 vcc, 0, v90
    s_cbranch_vccnz kf_rs
kf_rs_ret:
    v_perm_b32 v40, v97, v97, v105
    v_perm_b32 v41, v97, v97, v105
    v_perm_b32 v44, v99, v99, v105
    v_perm_b32 v45, v99, v99, v105
    v_mfma_f32_32x32x16_bf16 v[128:143], a[224:227], v[40:43], v[128:143]
    v_perm_b32 v48, v101, v101, v105
    v_perm_b32 v49, v101, v101, v105
    v_perm_b32 v52, v103, v103, v105
    v_perm_b32 v53, v103, v103, v105
    v_mfma_f32_32x32x16_bf16 v[144:159], a[228:231], v[40:43], v[144:159]
    v_mfma_f32_32x32x16_bf16 v[160:175], a[224:227], v[44:47], v[160:175]
    v_mfma_f32_32x32x16_bf16 v[176:191], a[228:231], v[44:47], v[176:191]
    v_max_f32 v128, 0, v128
    v_max_f32 v129, 0, v129
    v_max_f32 v130, 0, v130
    v_max_f32 v131, 0, v131
    v_mul_f32_e64 v128, v128, v144
    v_mul_f32 v129, v129, v145
    s_waitcnt lgkmcnt(4)
    v_mfma_f32_32x32x16_bf16 v[192:207], a[96:99], v[24:27], v[192:207]
    ds_read_b64_tr_b16 v[16:17], v6 offset:32768
    ds_read_b64_tr_b16 v[18:19], v6 offset:33280
    v_mul_f32 v130, v130, v146
    v_mul_f32 v131, v131, v147
    v_cvt_pk_bf16_f32 v128, v128, v129
    v_cvt_pk_bf16_f32 v129, v130, v131
    v_mfma_f32_32x32x16_bf16 v[208:223], a[100:103], v[24:27], v[208:223]
    ds_read_b64_tr_b16 v[20:21], v6 offset:34816
    ds_read_b64_tr_b16 v[22:23], v6 offset:35328
    v_max_f32 v132, 0, v132
    v_max_f32 v133, 0, v133
    v_max_f32 v134, 0, v134
    v_max_f32 v135, 0, v135
    v_mfma_f32_32x32x16_bf16 v[192:207], a[104:107], v[28:31], v[192:207]
    buffer_load_dwordx4 a[76:79], v113, s[16:19], s9 offen offset:1024 sc1
    v_mul_f32 v132, v132, v148
    v_mul_f32 v133, v133, v149
    v_mul_f32 v134, v134, v150
    v_mul_f32 v135, v135, v151
    v_mfma_f32_32x32x16_bf16 v[208:223], a[108:111], v[28:31], v[208:223]
    v_cvt_pk_bf16_f32 v130, v132, v133
    v_cvt_pk_bf16_f32 v131, v134, v135
    s_add_u32 s38, s35, 0
    buffer_store_dwordx4 v[128:131], v3, s[16:19], s38 offen offset:0 sc1
    v_max_f32 v136, 0, v136
    v_max_f32 v137, 0, v137
    v_max_f32 v138, 0, v138
    v_mfma_f32_32x32x16_bf16 v[192:207], a[224:227], v[48:51], v[192:207]
    v_max_f32 v139, 0, v139
    v_mul_f32 v136, v136, v152
    v_mul_f32 v137, v137, v153
    v_mul_f32 v138, v138, v154
    v_mul_f32_e64 v139, v139, v155
    v_cvt_pk_bf16_f32 v132, v136, v137
    v_mfma_f32_32x32x16_bf16 v[208:223], a[228:231], v[48:51], v[208:223]
    v_cvt_pk_bf16_f32 v133, v138, v139
    v_max_f32 v140, 0, v140
    v_max_f32 v141, 0, v141
    v_max_f32 v142, 0, v142
    v_max_f32 v143, 0, v143
    v_mul_f32 v140, v140, v156
    v_mfma_f32_32x32x16_bf16 v[224:239], a[224:227], v[52:55], v[224:239]
    v_mul_f32 v141, v141, v157
    v_mul_f32 v142, v142, v158
    v_mul_f32 v143, v143, v159
    v_cvt_pk_bf16_f32 v134, v140, v141
    v_cvt_pk_bf16_f32 v135, v142, v143
    buffer_store_dwordx4 v[132:135], v3, s[16:19], s38 offen offset:1024 sc1
    v_mfma_f32_32x32x16_bf16 v[240:255], a[228:231], v[52:55], v[240:255]
    v_max_f32 v160, 0, v160
    v_max_f32 v161, 0, v161
    v_max_f32 v162, 0, v162
    v_max_f32 v163, 0, v163
    v_mul_f32 v160, v160, v176
    s_waitcnt lgkmcnt(4)
    v_mfma_f32_32x32x16_bf16 v[192:207], a[112:115], v[32:35], v[192:207]
    ds_read_b64_tr_b16 v[24:25], v6 offset:36864
    ds_read_b64_tr_b16 v[26:27], v6 offset:37376
    v_mul_f32 v161, v161, v177
    v_mul_f32 v162, v162, v178
    v_mul_f32_e64 v163, v163, v179
    v_cvt_pk_bf16_f32 v160, v160, v161
    v_mfma_f32_32x32x16_bf16 v[208:223], a[116:119], v[32:35], v[208:223]
    ds_read_b64_tr_b16 v[28:29], v6 offset:38912
    ds_read_b64_tr_b16 v[30:31], v6 offset:39424
    v_cvt_pk_bf16_f32 v161, v162, v163
    v_max_f32 v164, 0, v164
    v_max_f32 v165, 0, v165
    v_max_f32 v166, 0, v166
    v_mfma_f32_32x32x16_bf16 v[192:207], a[120:123], v[36:39], v[192:207]
    s_add_u32 s8, s27, s54
    buffer_load_dwordx4 a[80:83], v113, s[16:19], s8 offen offset:0 sc1
    v_max_f32 v167, 0, v167
    v_mul_f32 v164, v164, v180
    v_mul_f32 v165, v165, v181
    v_mul_f32 v166, v166, v182
    v_mfma_f32_32x32x16_bf16 v[208:223], a[124:127], v[36:39], v[208:223]
    v_mul_f32_e64 v167, v167, v183
    v_cvt_pk_bf16_f32 v162, v164, v165
    v_cvt_pk_bf16_f32 v163, v166, v167
    s_add_u32 s38, s58, 0
    buffer_store_dwordx4 v[160:163], v3, s[16:19], s38 offen offset:0 sc1
    v_max_f32 v168, 0, v168
    v_max_f32 v169, 0, v169
    s_waitcnt lgkmcnt(4)
    v_mfma_f32_32x32x16_bf16 v[192:207], a[128:131], v[16:19], v[192:207]
    ds_read_b64_tr_b16 v[32:33], v6 offset:40960
    ds_read_b64_tr_b16 v[34:35], v6 offset:41472
    v_max_f32 v170, 0, v170
    v_max_f32 v171, 0, v171
    v_mul_f32 v168, v168, v184
    v_mul_f32 v169, v169, v185
    v_mfma_f32_32x32x16_bf16 v[208:223], a[132:135], v[16:19], v[208:223]
    ds_read_b64_tr_b16 v[36:37], v6 offset:43008
    ds_read_b64_tr_b16 v[38:39], v6 offset:43520
    v_mul_f32 v170, v170, v186
    v_mul_f32 v171, v171, v187
    v_cvt_pk_bf16_f32 v164, v168, v169
    v_cvt_pk_bf16_f32 v165, v170, v171
    v_mfma_f32_32x32x16_bf16 v[192:207], a[136:139], v[20:23], v[192:207]
    s_add_u32 s9, s28, s54
    buffer_load_dwordx4 a[84:87], v113, s[16:19], s9 offen offset:0 sc1
    buffer_load_dwordx4 a[88:91], v113, s[16:19], s8 offen offset:1024 sc1
    v_max_f32 v172, 0, v172
    v_max_f32 v173, 0, v173
    v_mfma_f32_32x32x16_bf16 v[208:223], a[140:143], v[20:23], v[208:223]
    buffer_load_dword v89, v109, s[16:19], s33 offen sc1
    v_max_f32 v174, 0, v174
    v_max_f32 v175, 0, v175
    v_mul_f32 v172, v172, v188
    v_mul_f32 v173, v173, v189
    s_waitcnt lgkmcnt(4)
    v_mfma_f32_32x32x16_bf16 v[192:207], a[144:147], v[24:27], v[192:207]
    ds_read_b64_tr_b16 v[16:17], v6 offset:45056
    ds_read_b64_tr_b16 v[18:19], v6 offset:45568
    v_mul_f32 v174, v174, v190
    v_mul_f32 v175, v175, v191
    v_cvt_pk_bf16_f32 v166, v172, v173
    v_cvt_pk_bf16_f32 v167, v174, v175
    v_mfma_f32_32x32x16_bf16 v[208:223], a[148:151], v[24:27], v[208:223]
    ds_read_b64_tr_b16 v[20:21], v6 offset:47104
    ds_read_b64_tr_b16 v[22:23], v6 offset:47616
    buffer_store_dwordx4 v[164:167], v3, s[16:19], s38 offen offset:1024 sc1
    ds_read_b64_tr_b16 v[64:65], v11 offset:57344
    ds_read_b64_tr_b16 v[66:67], v11 offset:58368
    v_mfma_f32_32x32x16_bf16 v[192:207], a[152:155], v[28:31], v[192:207]
    buffer_load_dwordx4 a[92:95], v113, s[16:19], s9 offen offset:1024 sc1
    ds_read_b64_tr_b16 v[68:69], v13 offset:57344
    ds_read_b64_tr_b16 v[70:71], v13 offset:58368
    ds_read2_b32 v[80:81], v108 offset0:1 offset1:5
    ds_read2_b32 v[82:83], v108 offset0:17 offset1:21
    v_mfma_f32_32x32x16_bf16 v[208:223], a[156:159], v[28:31], v[208:223]
    ds_read2_b64 v[114:117], v108 offset0:1 offset1:3
    ds_read2_b64 v[118:121], v108 offset0:9 offset1:11
    v_and_b32 v92, 0xffff0000, v101
    v_and_b32 v93, 0xffff0000, v103
    v_rcp_f32_e64 v92, v92
    v_rcp_f32 v93, v93
    s_waitcnt lgkmcnt(12)
    v_mfma_f32_32x32x16_bf16 v[192:207], a[160:163], v[32:35], v[192:207]
    ds_read_b64_tr_b16 v[24:25], v6 offset:49152
    ds_read_b64_tr_b16 v[26:27], v6 offset:49664
    v_mul_f32 v92, v92, v92
    v_mul_f32 v93, v93, v93
    s_mov_b32 s56, 0x07060501
    s_mov_b32 s57, 0x07060502
    v_mfma_f32_32x32x16_bf16 v[208:223], a[164:167], v[32:35], v[208:223]
    ds_read_b64_tr_b16 v[28:29], v6 offset:51200
    ds_read_b64_tr_b16 v[30:31], v6 offset:51712
    s_mov_b32 s39, 0x07060503
    s_mov_b32 s40, 0x0c04000c
    s_waitcnt lgkmcnt(4)
    v_lshlrev_b32 v56, 16, v80
    v_mfma_f32_32x32x16_bf16 v[192:207], a[168:171], v[36:39], v[192:207]
    v_and_b32 v57, 0xffff0000, v80
    v_lshlrev_b32 v58, 16, v81
    v_and_b32 v59, 0xffff0000, v81
    v_lshlrev_b32 v60, 16, v82
    v_and_b32 v61, 0xffff0000, v82
    v_lshlrev_b32 v62, 16, v83
    v_mfma_f32_32x32x16_bf16 v[208:223], a[172:175], v[36:39], v[208:223]
    v_and_b32 v63, 0xffff0000, v83
    v_lshlrev_b32 v72, 16, v64
    v_and_b32 v73, 0xffff0000, v64
    v_lshlrev_b32 v74, 16, v65
    v_and_b32 v75, 0xffff0000, v65
    v_lshlrev_b32 v76, 16, v66
    v_mfma_f32_32x32x16_bf16 v[192:207], a[176:179], v[16:19], v[192:207]
    ds_read_b64_tr_b16 v[32:33], v6 offset:53248
    ds_read_b64_tr_b16 v[34:35], v6 offset:53760
    v_and_b32 v77, 0xffff0000, v66
    v_lshlrev_b32 v78, 16, v67
    v_and_b32 v79, 0xffff0000, v67
    v_mul_f32 v72, v72, v114
    v_mfma_f32_32x32x16_bf16 v[208:223], a[180:183], v[16:19], v[208:223]
    ds_read_b64_tr_b16 v[36:37], v6 offset:55296
    ds_read_b64_tr_b16 v[38:39], v6 offset:55808
    v_mul_f32 v73, v73, v115
    v_mul_f32 v74, v74, v116
    v_mul_f32 v75, v75, v117
    v_mul_f32 v76, v76, v118
    v_mfma_f32_32x32x16_bf16 v[192:207], a[184:187], v[20:23], v[192:207]
    v_mul_f32 v77, v77, v119
    v_mul_f32 v78, v78, v120
    v_mul_f32 v79, v79, v121
    v_lshlrev_b32 v80, 16, v68
    v_and_b32 v81, 0xffff0000, v68
    v_lshlrev_b32_e64 v82, 16, v69
    v_mfma_f32_32x32x16_bf16 v[208:223], a[188:191], v[20:23], v[208:223]
    v_and_b32 v83, 0xffff0000, v69
    v_lshlrev_b32 v84, 16, v70
    v_and_b32 v85, 0xffff0000, v70
    v_lshlrev_b32 v86, 16, v71
    v_and_b32 v87, 0xffff0000, v71
    v_mul_f32 v80, v80, v114
    s_waitcnt lgkmcnt(4)
    v_mfma_f32_32x32x16_bf16 v[192:207], a[192:195], v[24:27], v[192:207]
    ds_read_b64_tr_b16 v[16:17], v8 offset:24576
    ds_read_b64_tr_b16 v[18:19], v8 offset:25088
    v_mul_f32 v81, v81, v115
    v_mul_f32 v82, v82, v116
    v_mul_f32 v83, v83, v117
    v_mul_f32 v84, v84, v118
    v_mfma_f32_32x32x16_bf16 v[208:223], a[196:199], v[24:27], v[208:223]
    ds_read_b64_tr_b16 v[20:21], v8 offset:26624
    ds_read_b64_tr_b16 v[22:23], v8 offset:27136
    v_mul_f32 v85, v85, v119
    v_mul_f32 v86, v86, v120
    v_mul_f32 v87, v87, v121
    v_mul_f32 v48, v56, v92
    v_mfma_f32_32x32x16_bf16 v[192:207], a[200:203], v[28:31], v[192:207]
    v_mul_f32 v49, v57, v92
    v_mul_f32 v50, v58, v92
    v_mul_f32 v51, v59, v92
    v_mul_f32 v52, v60, v92
    v_mul_f32 v53, v61, v92
    v_mul_f32 v54, v62, v92
    v_mfma_f32_32x32x16_bf16 v[208:223], a[204:207], v[28:31], v[208:223]
    v_mul_f32 v55, v63, v92
    v_mul_f32 v56, v56, v93
    v_mul_f32 v57, v57, v93
    v_mul_f32 v58, v58, v93
    v_mul_f32 v59, v59, v93
    v_mul_f32 v60, v60, v93
    s_waitcnt lgkmcnt(4)
    v_mfma_f32_32x32x16_bf16 v[192:207], a[208:211], v[32:35], v[192:207]
    ds_read_b64_tr_b16 v[24:25], v8 offset:28672
    ds_read_b64_tr_b16 v[26:27], v8 offset:29184
    v_mul_f32 v61, v61, v93
    v_mul_f32 v62, v62, v93
    v_mul_f32 v63, v63, v93
    v_mfma_f32_32x32x16_bf16 v[208:223], a[212:215], v[32:35], v[208:223]
    ds_read_b64_tr_b16 v[28:29], v8 offset:30720
    ds_read_b64_tr_b16 v[30:31], v8 offset:31232
    v_mfma_f32_32x32x16_bf16 v[192:207], a[216:219], v[36:39], v[192:207]
    v_mfma_f32_32x32x16_bf16 v[208:223], a[220:223], v[36:39], v[208:223]
    s_waitcnt lgkmcnt(4)
    v_mfma_f32_32x32x16_bf16 v[224:239], a[96:99], v[16:19], v[224:239]
    ds_read_b64_tr_b16 v[32:33], v8 offset:32768
    ds_read_b64_tr_b16 v[34:35], v8 offset:33280
    v_max_f32 v192, 0, v192
    v_max_f32 v193, 0, v193
    v_max_f32 v194, 0, v194
    v_max_f32_e64 v195, 0, v195
    v_mfma_f32_32x32x16_bf16 v[240:255], a[100:103], v[16:19], v[240:255]
    ds_read_b64_tr_b16 v[36:37], v8 offset:34816
    ds_read_b64_tr_b16 v[38:39], v8 offset:35328
    v_mul_f32 v192, v192, v208
    v_mul_f32 v193, v193, v209
    v_mul_f32 v194, v194, v210
    v_mul_f32 v195, v195, v211
    v_mfma_f32_32x32x16_bf16 v[224:239], a[104:107], v[20:23], v[224:239]
    v_cvt_pk_bf16_f32 v192, v192, v193
    v_cvt_pk_bf16_f32 v193, v194, v195
    v_max_f32 v196, 0, v196
    v_max_f32 v197, 0, v197
    v_max_f32 v198, 0, v198
    v_max_f32 v199, 0, v199
    v_mfma_f32_32x32x16_bf16 v[240:255], a[108:111], v[20:23], v[240:255]
    s_branch pg5_s
.p2align 12
pg5_h:
    s_branch wh_ret
pg5_l:
    s_branch wl_ret
pg5_s:
    v_mul_f32 v196, v196, v212
    v_mul_f32 v197, v197, v213
    v_mul_f32_e64 v198, v198, v214
    v_mul_f32 v199, v199, v215
    v_cvt_pk_bf16_f32 v194, v196, v197
    v_cvt_pk_bf16_f32 v195, v198, v199
    s_waitcnt lgkmcnt(4)
    v_mfma_f32_32x32x16_bf16 v[224:239], a[112:115], v[24:27], v[224:239]
    ds_read_b64_tr_b16 v[16:17], v8 offset:36864
    ds_read_b64_tr_b16 v[18:19], v8 offset:37376
    s_waitcnt vmcnt(2)
    v_cmp_ne_u32_e64 vcc, s59, v89
    s_cbranch_vccnz kf_rq
kf_rq_ret:
    s_add_u32 s38, s35, 458752
    buffer_store_dwordx4 v[192:195], v3, s[16:19], s38 offen offset:0 sc1
    v_max_f32 v200, 0, v200
    v_max_f32 v201, 0, v201
    v_mfma_f32_32x32x16_bf16 v[240:255], a[116:119], v[24:27], v[240:255]
    ds_read_b64_tr_b16 v[20:21], v8 offset:38912
    ds_read_b64_tr_b16 v[22:23], v8 offset:39424
    v_max_f32 v202, 0, v202
    v_max_f32 v203, 0, v203
    v_mul_f32 v200, v200, v216
    v_mul_f32 v201, v201, v217
    v_mfma_f32_32x32x16_bf16 v[224:239], a[120:123], v[28:31], v[224:239]
    v_mul_f32 v202, v202, v218
    v_mul_f32 v203, v203, v219
    v_cvt_pk_bf16_f32 v196, v200, v201
    v_cvt_pk_bf16_f32 v197, v202, v203
    v_max_f32 v204, 0, v204
    v_max_f32 v205, 0, v205
    v_mfma_f32_32x32x16_bf16 v[240:255], a[124:127], v[28:31], v[240:255]
    v_max_f32 v206, 0, v206
    v_max_f32 v207, 0, v207
    v_mul_f32 v204, v204, v220
    v_mul_f32 v205, v205, v221
    v_mul_f32 v206, v206, v222
    v_mul_f32 v207, v207, v223
    s_waitcnt lgkmcnt(4)
    v_mfma_f32_32x32x16_bf16 v[224:239], a[128:131], v[32:35], v[224:239]
    v_add_u32 v10, s29, v3
    buffer_load_dwordx4 v[136:139], v10, s[16:19], s50 offen offset:0 sc1
    ds_read_b64_tr_b16 v[24:25], v8 offset:40960
    ds_read_b64_tr_b16 v[26:27], v8 offset:41472
    v_cvt_pk_bf16_f32 v198, v204, v205
    v_cvt_pk_bf16_f32 v199, v206, v207
    buffer_store_dwordx4 v[196:199], v3, s[16:19], s38 offen offset:1024 sc1
    v_mfma_f32_32x32x16_bf16 v[240:255], a[132:135], v[32:35], v[240:255]
    ds_read_b64_tr_b16 v[28:29], v8 offset:43008
    ds_read_b64_tr_b16 v[30:31], v8 offset:43520
    v_mfma_f32_32x32x16_bf16 v[224:239], a[136:139], v[36:39], v[224:239]
    v_mfma_f32_32x32x16_bf16 v[240:255], a[140:143], v[36:39], v[240:255]
    buffer_load_dwordx4 v[140:143], v10, s[16:19], s50 offen offset:1024 sc1
    s_nop 0
    s_waitcnt lgkmcnt(4)
    v_mfma_f32_32x32x16_bf16 v[224:239], a[144:147], v[16:19], v[224:239]
    ds_read_b64_tr_b16 v[32:33], v8 offset:45056
    ds_read_b64_tr_b16 v[34:35], v8 offset:45568
    v_mfma_f32_32x32x16_bf16 v[240:255], a[148:151], v[16:19], v[240:255]
    buffer_load_dwordx4 v[144:147], v10, s[16:19], s51 offen offset:0 sc1
    ds_read_b64_tr_b16 v[36:37], v8 offset:47104
    ds_read_b64_tr_b16 v[38:39], v8 offset:47616
    v_mfma_f32_32x32x16_bf16 v[224:239], a[152:155], v[20:23], v[224:239]
    v_mfma_f32_32x32x16_bf16 v[240:255], a[156:159], v[20:23], v[240:255]
    buffer_load_dwordx4 v[148:151], v10, s[16:19], s51 offen offset:1024 sc1
    s_nop 0
    s_waitcnt lgkmcnt(4)
    v_mfma_f32_32x32x16_bf16 v[224:239], a[160:163], v[24:27], v[224:239]
    ds_read_b64_tr_b16 v[16:17], v8 offset:49152
    ds_read_b64_tr_b16 v[18:19], v8 offset:49664
    v_mfma_f32_32x32x16_bf16 v[240:255], a[164:167], v[24:27], v[240:255]
    buffer_load_dwordx4 v[152:155], v10, s[16:19], s52 offen offset:0 sc1
    ds_read_b64_tr_b16 v[20:21], v8 offset:51200
    ds_read_b64_tr_b16 v[22:23], v8 offset:51712
    v_mfma_f32_32x32x16_bf16 v[224:239], a[168:171], v[28:31], v[224:239]
    buffer_load_dword v90, v112, s[16:19], s33 offen offset:4 sc1
    v_mfma_f32_32x32x16_bf16 v[240:255], a[172:175], v[28:31], v[240:255]
    s_nop 0
    s_waitcnt lgkmcnt(4)
    v_mfma_f32_32x32x16_bf16 v[224:239], a[176:179], v[32:35], v[224:239]
    buffer_load_dwordx4 v[156:159], v10, s[16:19], s52 offen offset:1024 sc1
    ds_read_b64_tr_b16 v[24:25], v8 offset:53248
    ds_read_b64_tr_b16 v[26:27], v8 offset:53760
    v_mfma_f32_32x32x16_bf16 v[240:255], a[180:183], v[32:35], v[240:255]
    ds_read_b64_tr_b16 v[28:29], v8 offset:55296
    ds_read_b64_tr_b16 v[30:31], v8 offset:55808
    v_mfma_f32_32x32x16_bf16 v[224:239], a[184:187], v[36:39], v[224:239]
    buffer_load_dwordx4 v[168:171], v10, s[16:19], s53 offen offset:0 sc1
    v_mfma_f32_32x32x16_bf16 v[240:255], a[188:191], v[36:39], v[240:255]
    s_waitcnt lgkmcnt(4)
    v_mfma_f32_32x32x16_bf16 v[224:239], a[192:195], v[16:19], v[224:239]
    buffer_load_dwordx4 v[172:175], v10, s[16:19], s53 offen offset:1024 sc1
    v_mfma_f32_32x32x16_bf16 v[240:255], a[196:199], v[16:19], v[240:255]
    v_mfma_f32_32x32x16_bf16 v[224:239], a[200:203], v[20:23], v[224:239]
    buffer_load_dwordx4 v[176:179], v10, s[16:19], s54 offen offset:0 sc1
    v_mfma_f32_32x32x16_bf16 v[240:255], a[204:207], v[20:23], v[240:255]
    s_waitcnt lgkmcnt(0)
    v_mfma_f32_32x32x16_bf16 v[224:239], a[208:211], v[24:27], v[224:239]
    buffer_load_dwordx4 v[180:183], v10, s[16:19], s54 offen offset:1024 sc1
    v_mfma_f32_32x32x16_bf16 v[240:255], a[212:215], v[24:27], v[240:255]
    v_mfma_f32_32x32x16_bf16 v[224:239], a[216:219], v[28:31], v[224:239]
    buffer_load_dwordx4 v[184:187], v10, s[16:19], s55 offen offset:0 sc1
    v_mfma_f32_32x32x16_bf16 v[240:255], a[220:223], v[28:31], v[240:255]
    v_mfma_f32_32x32x16_bf16 v[16:31], a[0:3], v[128:131], 0
    buffer_load_dwordx4 v[188:191], v10, s[16:19], s55 offen offset:1024 sc1
    s_nop 0
    v_max_f32 v224, 0, v224
    v_max_f32 v225, 0, v225
    v_max_f32 v226, 0, v226
    v_max_f32 v227, 0, v227
    v_mfma_f32_32x32x16_bf16 v[32:47], a[4:7], v[128:131], 0
    v_mul_f32 v224, v224, v240
    v_mul_f32 v225, v225, v241
    v_mul_f32 v226, v226, v242
    v_mul_f32 v227, v227, v243
    v_cvt_pk_bf16_f32 v224, v224, v225
    v_mfma_f32_32x32x16_bf16 v[16:31], a[8:11], v[132:135], v[16:31]
    s_waitcnt vmcnt(11)
    v_max_u32 v94, v136, v140
    v_cmp_eq_u32 vcc, -1, v94
    v_add_u32 v10, 229376, v10
    buffer_load_dwordx4 v[200:203], v10, s[16:19], s50 offen offset:0 sc1
    v_mfma_f32_32x32x16_bf16 v[32:47], a[12:15], v[132:135], v[32:47]
    s_cbranch_vccnz kf_rh0_0
kf_rh0_0_ret:
    v_cvt_pk_bf16_f32 v225, v226, v227
    v_max_f32 v228, 0, v228
    v_max_f32 v229, 0, v229
    v_max_f32 v230, 0, v230
    v_mfma_f32_32x32x16_bf16 v[16:31], a[16:19], v[136:139], v[16:31]
    buffer_load_dwordx4 v[204:207], v10, s[16:19], s50 offen offset:1024 sc1
    v_max_f32 v231, 0, v231
    v_mul_f32 v228, v228, v244
    v_mul_f32 v229, v229, v245
    v_mul_f32 v230, v230, v246
    v_mfma_f32_32x32x16_bf16 v[32:47], a[20:23], v[136:139], v[32:47]
    v_mul_f32 v231, v231, v247
    v_cvt_pk_bf16_f32 v226, v228, v229
    v_cvt_pk_bf16_f32 v227, v230, v231
    s_waitcnt vmcnt(9)
    v_cmp_ne_u32 vcc, s59, v90
    s_cbranch_vccnz kf_rt2
kf_rt2_ret:
    v_mfma_f32_32x32x16_bf16 v[16:31], a[24:27], v[140:143], v[16:31]
    v_max_u32 v94, v144, v148
    v_cmp_eq_u32 vcc, -1, v94
    buffer_load_dwordx4 v[208:211], v10, s[16:19], s51 offen offset:0 sc1
    s_add_u32 s38, s58, 458752
    buffer_store_dwordx4 v[224:227], v3, s[16:19], s38 offen offset:0 sc1
    v_mfma_f32_32x32x16_bf16 v[32:47], a[28:31], v[140:143], v[32:47]
    s_cbranch_vccnz kf_rh0_2
kf_rh0_2_ret:
    v_max_f32 v232, 0, v232
    v_max_f32 v233, 0, v233
    v_max_f32 v234, 0, v234
    v_max_f32_e64 v235, 0, v235
    v_mfma_f32_32x32x16_bf16 v[16:31], a[32:35], v[144:147], v[16:31]
    v_mul_f32 v232, v232, v248
    v_mul_f32 v233, v233, v249
    v_mul_f32 v234, v234, v250
    v_mul_f32 v235, v235, v251
    v_cvt_pk_bf16_f32 v228, v232, v233
    v_mfma_f32_32x32x16_bf16 v[32:47], a[36:39], v[144:147], v[32:47]
    buffer_load_dwordx4 v[212:215], v10, s[16:19], s51 offen offset:1024 sc1
    v_cvt_pk_bf16_f32 v229, v234, v235
    v_max_f32 v236, 0, v236
    v_max_f32 v237, 0, v237
    v_max_f32 v238, 0, v238
    v_mfma_f32_32x32x16_bf16 v[16:31], a[40:43], v[148:151], v[16:31]
    s_waitcnt vmcnt(11)
    v_max_u32 v94, v152, v156
    v_cmp_eq_u32 vcc, -1, v94
    v_max_f32 v239, 0, v239
    v_mul_f32 v236, v236, v252
    v_mfma_f32_32x32x16_bf16 v[32:47], a[44:47], v[148:151], v[32:47]
    s_cbranch_vccnz kf_rh0_4
kf_rh0_4_ret:
    buffer_load_dwordx4 v[216:219], v10, s[16:19], s52 offen offset:0 sc1
    v_mul_f32 v237, v237, v253
    v_mul_f32 v238, v238, v254
    v_mul_f32 v239, v239, v255
    v_mfma_f32_32x32x16_bf16 v[32:47], a[52:55], v[152:155], v[32:47]
    s_waitcnt vmcnt(10)
    v_max_u32 v94, v168, v172
    v_cmp_eq_u32 vcc, -1, v94
    v_cvt_pk_bf16_f32 v230, v236, v237
    v_cvt_pk_bf16_f32 v231, v238, v239
    v_mfma_f32_32x32x16_bf16 v[32:47], a[60:63], v[156:159], v[32:47]
    s_cbranch_vccnz kf_rh0_6
kf_rh0_6_ret:
    buffer_load_dwordx4 v[220:223], v10, s[16:19], s52 offen offset:1024 sc1
    buffer_store_dwordx4 v[228:231], v3, s[16:19], s38 offen offset:1024 sc1
    v_xor_b32 v5, 2048, v14
    v_xor_b32 v6, 4096, v14
    v_mfma_f32_32x32x16_bf16 v[32:47], a[68:71], v[168:171], v[32:47]
    s_waitcnt vmcnt(10)
    v_max_u32 v94, v176, v180
    v_cmp_eq_u32_e64 vcc, -1, v94
    v_xor_b32 v7, 6144, v14
    v_mfma_f32_32x32x16_bf16 v[32:47], a[76:79], v[172:175], v[32:47]
    s_cbranch_vccnz kf_rh0_8
kf_rh0_8_ret:
    v_mfma_f32_32x32x16_bf16 v[32:47], a[84:87], v[176:179], v[32:47]
    s_waitcnt vmcnt(8)
    v_max_u32 v94, v184, v188
    v_cmp_eq_u32 vcc, -1, v94
    buffer_load_dwordx4 v[128:131], v10, s[16:19], s53 offen offset:0 sc1
    v_mfma_f32_32x32x16_bf16 v[32:47], a[92:95], v[180:183], v[32:47]
    s_cbranch_vccnz kf_rh0_10
kf_rh0_10_ret:
    v_mfma_f32_32x32x16_bf16 v[32:47], a[240:243], v[184:187], v[32:47]
    buffer_load_dwordx4 v[132:135], v10, s[16:19], s53 offen offset:1024 sc1
    v_mfma_f32_32x32x16_bf16 v[32:47], a[232:235], v[188:191], v[32:47]
    v_mfma_f32_32x32x16_bf16 v[16:31], a[48:51], v[152:155], v[16:31]
    buffer_load_dwordx4 v[136:139], v10, s[16:19], s54 offen offset:0 sc1
    v_mfma_f32_32x32x16_bf16 v[16:31], a[56:59], v[156:159], v[16:31]
    s_nop 1
    ds_write_b128 v6, v[32:35] offset:8192
    v_mfma_f32_32x32x16_bf16 v[16:31], a[64:67], v[168:171], v[16:31]
    buffer_load_dwordx4 v[140:143], v10, s[16:19], s54 offen offset:1024 sc1
    ds_write_b128 v6, v[36:39] offset:9216
    v_mfma_f32_32x32x16_bf16 v[16:31], a[72:75], v[172:175], v[16:31]
    ds_write_b128 v7, v[40:43] offset:16384
    v_mfma_f32_32x32x16_bf16 v[16:31], a[80:83], v[176:179], v[16:31]
    buffer_load_dwordx4 v[144:147], v10, s[16:19], s55 offen offset:0 sc1
    ds_write_b128 v7, v[44:47] offset:17408
    v_mfma_f32_32x32x16_bf16 v[16:31], a[88:91], v[180:183], v[16:31]
    v_mfma_f32_32x32x16_bf16 v[16:31], a[244:247], v[184:187], v[16:31]
    buffer_load_dwordx4 v[148:151], v10, s[16:19], s55 offen offset:1024 sc1
    v_mfma_f32_32x32x16_bf16 v[16:31], a[236:239], v[188:191], v[16:31]
    v_mfma_f32_32x32x16_bf16 v[96:111], a[0:3], v[160:163], 0
    v_add_u32 v10, 229376, v10
    buffer_load_dwordx4 v[232:235], v10, s[16:19], s50 offen offset:0 sc1
    v_mfma_f32_32x32x16_bf16 v[112:127], a[4:7], v[160:163], 0
    s_nop 0
    ds_write_b128 v5, v[24:27] offset:0
    v_mfma_f32_32x32x16_bf16 v[96:111], a[8:11], v[164:167], v[96:111]
    buffer_load_dwordx4 v[236:239], v10, s[16:19], s50 offen offset:1024 sc1
    ds_write_b128 v5, v[28:31] offset:1024
    v_mfma_f32_32x32x16_bf16 v[112:127], a[12:15], v[164:167], v[112:127]
    s_waitcnt vmcnt(14)
    v_mfma_f32_32x32x16_bf16 v[96:111], a[16:19], v[200:203], v[96:111]
    buffer_load_dwordx4 v[240:243], v10, s[16:19], s51 offen offset:0 sc1
    s_waitcnt lgkmcnt(0)
    s_barrier
    ds_read_b128 v[32:35], v14 offset:8192
    ds_read_b128 v[36:39], v14 offset:9216
    v_mfma_f32_32x32x16_bf16 v[112:127], a[20:23], v[200:203], v[112:127]
    ds_read_b128 v[40:43], v14 offset:16384
    ds_read_b128 v[44:47], v14 offset:17408
    ds_read_b128 v[24:27], v14 offset:0
    ds_read_b128 v[28:31], v14 offset:1024
    v_mfma_f32_32x32x16_bf16 v[96:111], a[24:27], v[204:207], v[96:111]
    buffer_load_dwordx4 v[244:247], v10, s[16:19], s51 offen offset:1024 sc1
    s_waitcnt lgkmcnt(4)
    v_add_f32 v16, v16, v32
    v_add_f32 v17, v17, v33
    v_add_f32 v18, v18, v34
    v_mfma_f32_32x32x16_bf16 v[112:127], a[28:31], v[204:207], v[112:127]
    v_add_f32 v19, v19, v35
    v_add_f32 v20, v20, v36
    v_add_f32 v21, v21, v37
    v_add_f32 v22, v22, v38
    s_waitcnt vmcnt(13)
    v_mfma_f32_32x32x16_bf16 v[96:111], a[32:35], v[208:211], v[96:111]
    buffer_load_dwordx4 v[248:251], v10, s[16:19], s52 offen offset:0 sc1
    v_add_f32 v23, v23, v39
    s_waitcnt lgkmcnt(0)
    v_add_f32 v24, v24, v40
    v_add_f32 v25, v25, v41
    v_mfma_f32_32x32x16_bf16 v[112:127], a[36:39], v[208:211], v[112:127]
    v_add_f32 v26, v26, v42
    v_add_f32 v27, v27, v43
    v_add_f32 v28, v28, v44
    v_add_f32 v29, v29, v45
    v_add_f32 v30, v30, v46
    v_mfma_f32_32x32x16_bf16 v[96:111], a[40:43], v[212:215], v[96:111]
    buffer_load_dwordx4 v[252:255], v10, s[16:19], s52 offen offset:1024 sc1
    v_add_f32 v31, v31, v47
    v_add_f32 v16, v16, v24
    v_add_f32 v17, v17, v25
    v_add_f32 v18, v18, v26
    v_mfma_f32_32x32x16_bf16 v[112:127], a[44:47], v[212:215], v[112:127]
    v_add_f32 v19, v19, v27
    v_add_f32 v20, v20, v28
    v_add_f32 v21, v21, v29
    v_add_f32 v22, v22, v30
    s_waitcnt vmcnt(13)
    v_mfma_f32_32x32x16_bf16 v[112:127], a[52:55], v[216:219], v[112:127]
    buffer_load_dwordx4 v[152:155], v10, s[16:19], s53 offen offset:0 sc1
    v_add_f32 v23, v23, v31
    s_add_u32 s38, s35, 917504
    v_perm_b32 v16, v16, v19, s56
    v_perm_b32 v17, v17, v19, s57
    v_mfma_f32_32x32x16_bf16 v[112:127], a[60:63], v[220:223], v[112:127]
    v_perm_b32 v18, v18, v19, s39
    v_mov_b32 v19, s59
    buffer_store_dwordx4 v[16:19], v3, s[16:19], s38 offen offset:0 sc1
    v_perm_b32 v20, v20, v23, s56
    s_waitcnt vmcnt(12)
    v_mfma_f32_32x32x16_bf16 v[112:127], a[68:71], v[128:131], v[112:127]
    v_perm_b32 v21, v21, v23, s57
    v_perm_b32 v22, v22, v23, s39
    v_mov_b32_e64 v23, s59
    buffer_store_dwordx4 v[20:23], v3, s[16:19], s38 offen offset:1024 sc1
    v_mfma_f32_32x32x16_bf16 v[112:127], a[76:79], v[132:135], v[112:127]
    s_waitcnt vmcnt(11)
    v_mfma_f32_32x32x16_bf16 v[112:127], a[84:87], v[136:139], v[112:127]
    v_mfma_f32_32x32x16_bf16 v[112:127], a[92:95], v[140:143], v[112:127]
    buffer_load_dwordx4 v[156:159], v10, s[16:19], s53 offen offset:1024 sc1
    s_waitcnt vmcnt(10)
    v_mfma_f32_32x32x16_bf16 v[112:127], a[240:243], v[144:147], v[112:127]
    v_mfma_f32_32x32x16_bf16 v[112:127], a[232:235], v[148:151], v[112:127]
    buffer_load_dwordx4 v[168:171], v10, s[16:19], s54 offen offset:0 sc1
    v_mfma_f32_32x32x16_bf16 v[96:111], a[48:51], v[216:219], v[96:111]
    buffer_load_dwordx4 v[172:175], v10, s[16:19], s54 offen offset:1024 sc1
    v_mfma_f32_32x32x16_bf16 v[96:111], a[56:59], v[220:223], v[96:111]
    s_nop 0
    v_cmp_u_f32_e64 vcc, v112, v112
    v_mfma_f32_32x32x16_bf16 v[96:111], a[64:67], v[128:131], v[96:111]
    buffer_load_dwordx4 v[176:179], v10, s[16:19], s55 offen offset:0 sc1
    s_cbranch_vccnz kf_rh1_0n
kf_rh1_0n_ret:
    ds_write_b128 v6, v[112:115] offset:32768
    v_mfma_f32_32x32x16_bf16 v[96:111], a[72:75], v[132:135], v[96:111]
    buffer_load_dwordx4 v[180:183], v10, s[16:19], s55 offen offset:1024 sc1
    ds_write_b128 v6, v[116:119] offset:33792
    v_mfma_f32_32x32x16_bf16 v[96:111], a[80:83], v[136:139], v[96:111]
    ds_write_b128 v7, v[120:123] offset:40960
    v_mfma_f32_32x32x16_bf16 v[96:111], a[88:91], v[140:143], v[96:111]
    v_add_u32 v10, 229376, v10
    buffer_load_dwordx4 v[184:187], v10, s[16:19], s50 offen offset:0 sc1
    ds_write_b128 v7, v[124:127] offset:41984
    v_mfma_f32_32x32x16_bf16 v[96:111], a[244:247], v[144:147], v[96:111]
    buffer_load_dwordx4 v[188:191], v10, s[16:19], s50 offen offset:1024 sc1
    v_mfma_f32_32x32x16_bf16 v[96:111], a[236:239], v[148:151], v[96:111]
    v_mfma_f32_32x32x16_bf16 v[16:31], a[0:3], v[192:195], 0
    buffer_load_dwordx4 v[160:163], v10, s[16:19], s51 offen offset:0 sc1
    v_mfma_f32_32x32x16_bf16 v[32:47], a[4:7], v[192:195], 0
    buffer_load_dwordx4 v[164:167], v10, s[16:19], s51 offen offset:1024 sc1
    s_nop 0
    ds_write_b128 v5, v[104:107] offset:24576
    v_mfma_f32_32x32x16_bf16 v[16:31], a[8:11], v[196:199], v[16:31]
    ds_write_b128 v5, v[108:111] offset:25600
    v_mfma_f32_32x32x16_bf16 v[32:47], a[12:15], v[196:199], v[32:47]
    buffer_load_dwordx4 v[200:203], v10, s[16:19], s52 offen offset:0 sc1
    s_waitcnt vmcnt(17)
    v_mfma_f32_32x32x16_bf16 v[16:31], a[16:19], v[232:235], v[16:31]
    buffer_load_dwordx4 v[204:207], v10, s[16:19], s52 offen offset:1024 sc1
    s_waitcnt lgkmcnt(0)
    s_barrier
    ds_read_b128 v[112:115], v14 offset:32768
    ds_read_b128 v[116:119], v14 offset:33792
    v_mfma_f32_32x32x16_bf16 v[32:47], a[20:23], v[232:235], v[32:47]
    ds_read_b128 v[120:123], v14 offset:40960
    ds_read_b128 v[124:127], v14 offset:41984
    ds_read_b128 v[104:107], v14 offset:24576
    ds_read_b128 v[108:111], v14 offset:25600
    v_mfma_f32_32x32x16_bf16 v[16:31], a[24:27], v[236:239], v[16:31]
    buffer_load_dwordx4 v[208:211], v10, s[16:19], s53 offen offset:0 sc1
    s_waitcnt lgkmcnt(4)
    v_add_f32 v96, v96, v112
    v_add_f32 v97, v97, v113
    v_add_f32 v98, v98, v114
    v_mfma_f32_32x32x16_bf16 v[32:47], a[28:31], v[236:239], v[32:47]
    buffer_load_dwordx4 v[212:215], v10, s[16:19], s53 offen offset:1024 sc1
    v_add_f32 v99, v99, v115
    v_add_f32 v100, v100, v116
    v_add_f32 v101, v101, v117
    s_waitcnt vmcnt(18)
    v_mfma_f32_32x32x16_bf16 v[16:31], a[32:35], v[240:243], v[16:31]
    v_add_f32 v102, v102, v118
    v_add_f32 v103, v103, v119
    s_waitcnt lgkmcnt(0)
    v_add_f32 v104, v104, v120
    v_add_f32_e64 v105, v105, v121
    v_mfma_f32_32x32x16_bf16 v[32:47], a[36:39], v[240:243], v[32:47]
    buffer_load_dwordx4 v[216:219], v10, s[16:19], s54 offen offset:0 sc1
    v_add_f32 v106, v106, v122
    v_add_f32 v107, v107, v123
    v_add_f32 v108, v108, v124
    v_add_f32 v109, v109, v125
    v_mfma_f32_32x32x16_bf16 v[16:31], a[40:43], v[244:247], v[16:31]
    buffer_load_dwordx4 v[220:223], v10, s[16:19], s54 offen offset:1024 sc1
    v_add_f32 v110, v110, v126
    v_add_f32 v111, v111, v127
    v_add_f32 v96, v96, v104
    v_add_f32 v97, v97, v105
    v_mfma_f32_32x32x16_bf16 v[32:47], a[44:47], v[244:247], v[32:47]
    v_add_f32 v98, v98, v106
    v_add_f32 v99, v99, v107
    v_add_f32_e64 v100, v100, v108
    v_add_f32 v101, v101, v109
    s_waitcnt vmcnt(18)
    v_mfma_f32_32x32x16_bf16 v[32:47], a[52:55], v[248:251], v[32:47]
    buffer_load_dwordx4 v[128:131], v10, s[16:19], s55 offen offset:0 sc1
    v_add_f32 v102, v102, v110
    v_add_f32 v103, v103, v111
    v_perm_b32 v96, v96, v99, s56
    v_perm_b32 v97, v97, v99, s57
    v_mfma_f32_32x32x16_bf16 v[32:47], a[60:63], v[252:255], v[32:47]
    buffer_load_dwordx4 v[132:135], v10, s[16:19], s55 offen offset:1024 sc1
    v_perm_b32 v98, v98, v99, s39
    v_mov_b32 v99, s59
    buffer_store_dwordx4 v[96:99], v3, s[84:87], s100 offen offset:0 sc1
    s_waitcnt vmcnt(17)
    v_mfma_f32_32x32x16_bf16 v[32:47], a[68:71], v[152:155], v[32:47]
    v_perm_b32 v100, v100, v103, s56
    v_perm_b32 v101, v101, v103, s57
    v_perm_b32 v102, v102, v103, s39
    v_mov_b32_e64 v103, s59
    buffer_store_dwordx4 v[100:103], v3, s[84:87], s100 offen offset:1024 sc1
    v_mfma_f32_32x32x16_bf16 v[32:47], a[76:79], v[156:159], v[32:47]
    s_waitcnt vmcnt(16)
    v_mfma_f32_32x32x16_bf16 v[32:47], a[84:87], v[168:171], v[32:47]
    v_mfma_f32_32x32x16_bf16 v[32:47], a[92:95], v[172:175], v[32:47]
    s_waitcnt vmcnt(14)
    v_mfma_f32_32x32x16_bf16 v[32:47], a[240:243], v[176:179], v[32:47]
    v_mfma_f32_32x32x16_bf16 v[32:47], a[232:235], v[180:183], v[32:47]
    v_mfma_f32_32x32x16_bf16 v[16:31], a[48:51], v[248:251], v[16:31]
    v_mfma_f32_32x32x16_bf16 v[16:31], a[56:59], v[252:255], v[16:31]
    s_nop 2
    v_cmp_u_f32_e64 vcc, v32, v32
    v_mfma_f32_32x32x16_bf16 v[16:31], a[64:67], v[152:155], v[16:31]
    s_cbranch_vccnz kf_rh1x
kf_rh1x_ret:
    ds_write_b128 v6, v[32:35] offset:8192
    v_mfma_f32_32x32x16_bf16 v[16:31], a[72:75], v[156:159], v[16:31]
    ds_write_b128 v6, v[36:39] offset:9216
    v_mfma_f32_32x32x16_bf16 v[16:31], a[80:83], v[168:171], v[16:31]
    ds_write_b128 v7, v[40:43] offset:16384
    v_mfma_f32_32x32x16_bf16 v[16:31], a[88:91], v[172:175], v[16:31]
    ds_write_b128 v7, v[44:47] offset:17408
    v_mfma_f32_32x32x16_bf16 v[16:31], a[244:247], v[176:179], v[16:31]
    v_mfma_f32_32x32x16_bf16 v[16:31], a[236:239], v[180:183], v[16:31]
    v_mfma_f32_32x32x16_bf16 v[112:127], a[4:7], v[224:227], 0
    v_mfma_f32_32x32x16_bf16 v[112:127], a[12:15], v[228:231], v[112:127]
    s_nop 2
    ds_write_b128 v5, v[24:27] offset:0
    s_waitcnt vmcnt(12)
    v_mfma_f32_32x32x16_bf16 v[112:127], a[20:23], v[184:187], v[112:127]
    ds_write_b128 v5, v[28:31] offset:1024
    v_mfma_f32_32x32x16_bf16 v[112:127], a[28:31], v[188:191], v[112:127]
    s_nop 0
    s_waitcnt vmcnt(10)
    v_mfma_f32_32x32x16_bf16 v[112:127], a[36:39], v[160:163], v[112:127]
    s_waitcnt lgkmcnt(0)
    s_barrier
    ds_read_b128 v[32:35], v14 offset:8192
    ds_read_b128 v[36:39], v14 offset:9216
    ds_read_b128 v[40:43], v14 offset:16384
    v_mfma_f32_32x32x16_bf16 v[112:127], a[44:47], v[164:167], v[112:127]
    ds_read_b128 v[44:47], v14 offset:17408
    ds_read_b128 v[24:27], v14 offset:0
    ds_read_b128 v[28:31], v14 offset:1024
    s_waitcnt vmcnt(8)
    v_mfma_f32_32x32x16_bf16 v[112:127], a[52:55], v[200:203], v[112:127]
    s_waitcnt lgkmcnt(4)
    v_add_f32 v16, v16, v32
    v_add_f32 v17, v17, v33
    v_add_f32 v18, v18, v34
    v_add_f32 v19, v19, v35
    v_mfma_f32_32x32x16_bf16 v[112:127], a[60:63], v[204:207], v[112:127]
    v_add_f32 v20, v20, v36
    v_add_f32 v21, v21, v37
    v_add_f32 v22, v22, v38
    v_add_f32 v23, v23, v39
    s_waitcnt vmcnt(6)
    v_mfma_f32_32x32x16_bf16 v[112:127], a[68:71], v[208:211], v[112:127]
    s_waitcnt lgkmcnt(0)
    v_add_f32 v24, v24, v40
    v_add_f32 v25, v25, v41
    v_add_f32 v26, v26, v42
    v_add_f32 v27, v27, v43
    v_mfma_f32_32x32x16_bf16 v[112:127], a[76:79], v[212:215], v[112:127]
    v_add_f32 v28, v28, v44
    v_add_f32 v29, v29, v45
    v_add_f32_e64 v30, v30, v46
    v_add_f32 v31, v31, v47
    s_waitcnt vmcnt(4)
    v_mfma_f32_32x32x16_bf16 v[112:127], a[84:87], v[216:219], v[112:127]
    s_add_u32 s11, s32, 917504
    buffer_load_dwordx4 v[136:139], v3, s[16:19], s11 offen offset:0 sc0 sc1
    buffer_load_dwordx4 v[140:143], v3, s[16:19], s11 offen offset:1024 sc0 sc1
    v_add_f32 v16, v16, v24
    v_add_f32 v17, v17, v25
    v_mfma_f32_32x32x16_bf16 v[112:127], a[92:95], v[220:223], v[112:127]
    v_add_f32 v18, v18, v26
    v_add_f32 v19, v19, v27
    v_add_f32_e64 v20, v20, v28
    v_add_f32 v21, v21, v29
    s_waitcnt vmcnt(4)
    v_mfma_f32_32x32x16_bf16 v[112:127], a[240:243], v[128:131], v[112:127]
    v_add_f32 v22, v22, v30
    v_add_f32 v23, v23, v31
    v_fma_f32 v72, v16, v48, v72
    v_fma_f32 v73, v17, v49, v73
    v_fma_f32 v74, v18, v50, v74
    v_mfma_f32_32x32x16_bf16 v[112:127], a[232:235], v[132:135], v[112:127]
    v_fma_f32 v75, v19, v51, v75
    v_fma_f32 v76, v20, v52, v76
    v_fma_f32 v77, v21, v53, v77
    v_fma_f32 v78, v22, v54, v78
    v_fma_f32 v79, v23, v55, v79
    v_mfma_f32_32x32x16_bf16 v[96:111], a[0:3], v[224:227], 0
    buffer_load_dwordx4 v[144:147], v3, s[84:87], s101 offen offset:0 sc0 sc1
    buffer_load_dwordx4 v[148:151], v3, s[84:87], s101 offen offset:1024 sc0 sc1
    v_mfma_f32_32x32x16_bf16 v[96:111], a[8:11], v[228:231], v[96:111]
    v_cmp_u_f32 vcc, v112, v112
    v_mfma_f32_32x32x16_bf16 v[96:111], a[16:19], v[184:187], v[96:111]
    s_cbranch_vccnz kf_rh1y
kf_rh1y_ret:
    ds_write_b128 v6, v[112:115] offset:32768
    v_mfma_f32_32x32x16_bf16 v[96:111], a[24:27], v[188:191], v[96:111]
    ds_write_b128 v6, v[116:119] offset:33792
    v_mfma_f32_32x32x16_bf16 v[96:111], a[32:35], v[160:163], v[96:111]
    ds_write_b128 v7, v[120:123] offset:40960
    v_mfma_f32_32x32x16_bf16 v[96:111], a[40:43], v[164:167], v[96:111]
    ds_write_b128 v7, v[124:127] offset:41984
    v_mfma_f32_32x32x16_bf16 v[96:111], a[48:51], v[200:203], v[96:111]
    v_mfma_f32_32x32x16_bf16 v[96:111], a[56:59], v[204:207], v[96:111]
    s_waitcnt lgkmcnt(0)
    s_barrier
    ds_read_b128 v[112:115], v14 offset:32768
    ds_read_b128 v[116:119], v14 offset:33792
    ds_read_b128 v[120:123], v14 offset:40960
    v_mfma_f32_32x32x16_bf16 v[96:111], a[64:67], v[208:211], v[96:111]
    ds_read_b128 v[124:127], v14 offset:41984
    v_mfma_f32_32x32x16_bf16 v[96:111], a[72:75], v[212:215], v[96:111]
    v_mfma_f32_32x32x16_bf16 v[96:111], a[80:83], v[216:219], v[96:111]
    s_waitcnt lgkmcnt(0)
    v_add_f32 v112, v112, v120
    v_add_f32 v113, v113, v121
    v_add_f32 v114, v114, v122
    v_add_f32_e64 v115, v115, v123
    v_mfma_f32_32x32x16_bf16 v[96:111], a[88:91], v[220:223], v[96:111]
    buffer_load_dwordx4 v[192:195], v3, s[84:87], s101 offen offset:0 sc0 sc1
    buffer_load_dwordx4 v[196:199], v3, s[84:87], s101 offen offset:1024 sc0 sc1
    v_add_f32 v116, v116, v124
    v_add_f32 v117, v117, v125
    v_add_f32 v118, v118, v126
    v_mfma_f32_32x32x16_bf16 v[96:111], a[244:247], v[128:131], v[96:111]
    v_add_f32 v119, v119, v127
    v_fma_f32 v80, v112, v56, v80
    v_fma_f32 v81, v113, v57, v81
    v_fma_f32 v82, v114, v58, v82
    v_fma_f32 v83, v115, v59, v83
    v_mfma_f32_32x32x16_bf16 v[96:111], a[236:239], v[132:135], v[96:111]
    v_fma_f32 v84, v116, v60, v84
    v_fma_f32 v85, v117, v61, v85
    v_fma_f32 v86, v118, v62, v86
    v_fma_f32 v87, v119, v63, v87
    s_waitcnt vmcnt(4)
    v_xor_b32 v68, s59, v139
    v_xor_b32 v69, s59, v143
    v_or_b32 v68, v68, v69
    v_cmp_ne_u32 vcc, 0, v68
    s_cbranch_vccnz kf_rx0p
kf_rx0p_ret:
    v_perm_b32 v139, v137, v136, s40
    v_perm_b32 v143, v141, v140, s40
    v_pk_fma_f32 v[72:73], v[136:137], v[48:49], v[72:73]
    v_pk_fma_f32 v[76:77], v[140:141], v[52:53], v[76:77]
    v_lshl_or_b32 v139, v138, 24, v139
    v_lshl_or_b32 v143, v142, 24, v143
    ds_write_b128 v5, v[104:107] offset:24576
    ds_write_b128 v5, v[108:111] offset:25600
    v_pk_fma_f32 v[74:75], v[138:139], v[50:51], v[74:75]
    v_pk_fma_f32 v[78:79], v[142:143], v[54:55], v[78:79]
    v_cvt_pk_bf16_f32 v64, v72, v73
    v_cvt_pk_bf16_f32 v65, v74, v75
    v_cvt_pk_bf16_f32 v66, v76, v77
    v_cvt_pk_bf16_f32 v67, v78, v79
    s_nop 0
    v_permlane32_swap_b32 v64, v66
    v_permlane32_swap_b32 v65, v67
    s_mov_b32 s38, 0
    buffer_store_dwordx4 v[64:67], v12, s[44:47], s38 offen
    s_waitcnt lgkmcnt(0)
    s_barrier
    ds_read_b128 v[104:107], v14 offset:24576
    ds_read_b128 v[108:111], v14 offset:25600
    s_waitcnt vmcnt(3)
    v_xor_b32 v68, s59, v147
    v_xor_b32 v69, s59, v151
    v_or_b32 v68, v68, v69
    v_cmp_ne_u32 vcc, 0, v68
    s_cbranch_vccnz kf_rx1p
kf_rx1p_ret:
    v_perm_b32 v147, v145, v144, s40
    v_perm_b32 v151, v149, v148, s40
    v_pk_fma_f32 v[80:81], v[144:145], v[56:57], v[80:81]
    v_pk_fma_f32 v[84:85], v[148:149], v[60:61], v[84:85]
    v_lshl_or_b32 v147, v146, 24, v147
    v_lshl_or_b32 v151, v150, 24, v151
    v_pk_fma_f32 v[82:83], v[146:147], v[58:59], v[82:83]
    v_pk_fma_f32 v[86:87], v[150:151], v[62:63], v[86:87]
    v_pk_fma_f32 v[80:81], v[96:97], v[56:57], v[80:81]
    v_pk_fma_f32 v[82:83], v[98:99], v[58:59], v[82:83]
    v_pk_fma_f32 v[84:85], v[100:101], v[60:61], v[84:85]
    v_pk_fma_f32 v[86:87], v[102:103], v[62:63], v[86:87]
    s_waitcnt lgkmcnt(1)
    v_pk_fma_f32 v[96:97], v[104:105], v[56:57], v[80:81]
    v_pk_fma_f32 v[98:99], v[106:107], v[58:59], v[82:83]
    s_waitcnt lgkmcnt(0)
    v_pk_fma_f32 v[100:101], v[108:109], v[60:61], v[84:85]
    v_pk_fma_f32 v[102:103], v[110:111], v[62:63], v[86:87]
    v_cvt_pk_bf16_f32 v64, v96, v97
    v_cvt_pk_bf16_f32 v65, v98, v99
    v_cvt_pk_bf16_f32 v66, v100, v101
    v_cvt_pk_bf16_f32 v67, v102, v103
    s_nop 0
    v_permlane32_swap_b32 v64, v66
    v_permlane32_swap_b32 v65, v67
    s_mov_b32 s38, 7168
    buffer_store_dwordx4 v[64:67], v12, s[44:47], s38 offen
    s_endpgm
.p2align 12
kf_light:
    s_load_dwordx2 s[40:41], s[0:1], 96
    s_mov_b32 s91, s90
    s_lshl_b32 s3, s91, 9
    v_lshl_add_u32 v168, v0, 1, s3
    s_lshl_b32 s3, s91, 1
    v_mov_b32 v169, s3
    global_load_ushort v160, v168, s[24:25] nt
    global_load_ushort v161, v168, s[26:27] nt
    global_load_ushort v162, v168, s[28:29] nt
    global_load_ushort v163, v168, s[30:31] nt
    global_load_ushort v164, v168, s[32:33] nt
    global_load_ushort v165, v168, s[34:35] nt
    global_load_ushort v166, v169, s[36:37]
    global_load_ushort v167, v169, s[38:39]
    v_mul_u32_u24 v94, 960, v56
    v_lshl_add_u32 v94, v57, 4, v94
    v_add_u32 v94, 122880, v94
    v_bfe_u32 v96, v0, 5, 1
    s_mul_i32 s6, s20, 7168
    s_add_u32 s6, s6, 122880
    v_bfe_u32 v1, v0, 5, 1
    v_bfe_u32 v2, v0, 2, 2
    v_lshl_add_u32 v1, v1, 3, v2
    v_bfe_u32 v2, v0, 4, 1
    v_lshl_add_u32 v1, v1, 1, v2
    v_and_b32 v2, 3, v0
    v_lshl_add_u32 v1, v1, 2, v2
    v_lshl_add_u32 v56, v1, 3, s6
    v_mov_b32 v29, 0
    s_lshr_b32 s8, s20, 1
    s_and_b32 s9, s20, 1
    s_mov_b32 s42, 1605632
    s_mov_b32 s43, 0x20000
    v_bfe_u32 v57, v0, 2, 2
    v_bfe_u32 v58, v0, 4, 1
    v_lshl_or_b32 v57, v58, 3, v57
    v_lshl_or_b32 v57, v96, 2, v57
    v_mul_u32_u24 v24, 896, v57
    s_lshl_b32 s6, s2, 1
    s_add_u32 s6, s6, s9
    s_mul_i32 s44, s6, 14336
    s_mul_i32 s7, s8, 448
    s_add_u32 s44, s44, s7
    s_mov_b32 s45, 64
    s_mul_i32 s46, s8, 696320
    s_lshl_b32 s6, s6, 10
    s_add_u32 s46, s46, s6
    s_and_b32 s6, s6, -8192
    s_add_u32 s46, s46, s6
    s_add_u32 s46, s46, 10485760
    s_mul_i32 s47, s8, 212992
    s_add_u32 s47, s47, 8192
    v_and_b32 v2, 3, v0
    v_lshl_add_u32 v24, v2, 4, v24
    v_bfe_u32 v1, v0, 2, 2
    v_lshl_add_u32 v1, v96, 3, v1
    v_mul_u32_u24 v1, 960, v1
    v_and_b32 v2, 63, v56
    s_mul_i32 s3, s8, 15360
    s_mul_i32 s10, s9, 448
    s_add_u32 s3, s3, s10
    s_add_u32 s3, s3, 122880
    v_add3_u32 v98, v1, v2, s3
    v_and_b32 v99, 31, v0
    v_lshlrev_b32 v99, 5, v99
    v_lshl_add_u32 v99, v96, 4, v99
    s_lshl_b32 s3, s2, 1
    s_add_u32 s3, s3, s8
    s_mul_i32 s48, s3, 14336
    s_mul_i32 s7, s9, 7168
    s_add_u32 s48, s48, s7
    v_bfe_u32 v100, v0, 4, 2
    s_lshl_b32 s3, s20, 4
    v_lshl_add_u32 v100, v100, 6, s3
    v_bfe_u32 v1, v0, 3, 1
    v_lshl_add_u32 v100, v1, 8, v100
    v_add_u32 v100, 155648, v100
    v_and_b32 v102, 0xf0, v4
    v_add_u32 v103, 155648, v102
    s_mov_b32 s10, 0x3f803f80
    s_lshl_b32 s49, s2, 8
    s_add_u32 s49, s49, 2490368
    s_waitcnt lgkmcnt(0)
    s_mov_b32 s84, s4
    s_mov_b32 s85, s5
    s_mov_b32 s86, 0x1c0000
    s_mov_b32 s87, 0x20000
    s_mov_b32 s18, 0x1c00000
    s_mov_b32 s19, 0x20000
    s_lshl_b32 s51, s20, 13
    s_lshl_b32 s6, s2, 7
    s_add_u32 s51, s51, s6
    s_add_u32 s51, s51, 0x1e0000
    v_mov_b32 v92, 0
    s_lshl_b32 s52, s2, 2
    s_add_u32 s52, s52, s20
    s_lshl_b32 s52, s52, 2
    s_add_u32 s52, s52, 2220032
    v_sub_u32 v36, 4080, v4
    v_lshrrev_b32 v57, 5, v0
    v_add_u32 v58, 1, v0
    v_lshrrev_b32 v58, 5, v58
    v_cmp_le_u32_e64 s[24:25], 8, v58
    v_cmp_le_u32_e64 s[26:27], 7, v57
    v_cmp_le_u32_e64 s[28:29], 7, v58
    v_cmp_le_u32_e64 s[30:31], 6, v57
    v_cmp_le_u32_e64 s[32:33], 6, v58
    v_cmp_le_u32_e64 s[34:35], 4, v57
    v_cmp_le_u32_e64 s[36:37], 4, v58
    v_mov_b32 v40, 0x1000504
    v_mov_b32 v41, 0x1000100
    v_mov_b32 v42, 0x1000706
    v_mov_b32 v43, 0x5040504
    v_mov_b32 v44, 0x5040706
    v_mov_b32 v45, 0x1000302
    v_mov_b32 v46, 0xc0c0c0c
    v_and_b32 v59, 1, v0
    v_mul_u32_u24 v59, 0x202, v59
    v_lshlrev_b32 v59, 16, v59
    v_sub_u32 v47, 0x07060706, v59
    v_add_u32_e64 v48, v44, v59
    s_lshl_b32 s94, s20, 8
    s_add_u32 s94, s94, 55808
    s_waitcnt vmcnt(14)
    ds_write_b128 v94, v[64:67] offset:0
    s_waitcnt vmcnt(13)
    ds_write_b128 v94, v[68:71] offset:128
    s_waitcnt vmcnt(12)
    ds_write_b128 v94, v[72:75] offset:256
    s_waitcnt vmcnt(11)
    ds_write_b128 v94, v[76:79] offset:384
    s_waitcnt vmcnt(10)
    ds_write_b128 v94, v[80:83] offset:512
    s_waitcnt vmcnt(9)
    ds_write_b128 v94, v[84:87] offset:640
    s_waitcnt vmcnt(8)
    ds_write_b128 v94, v[88:91] offset:768
    global_load_dword v30, v29, s[56:57] sc1
    v_dot2_f32_bf16 v104, v64, s10, 0
    v_dot2_f32_bf16 v108, v64, v64, 0
    v_dot2_f32_bf16 v105, v65, s10, 0
    v_dot2_f32_bf16 v109, v65, v65, 0
    v_dot2_f32_bf16 v106, v66, s10, 0
    v_dot2_f32_bf16 v110, v66, v66, 0
    v_dot2_f32_bf16 v107, v67, s10, 0
    v_dot2_f32_bf16 v111, v67, v67, 0
    v_dot2_f32_bf16 v104, v68, s10, v104
    v_dot2_f32_bf16 v108, v68, v68, v108
    v_dot2_f32_bf16 v105, v69, s10, v105
    v_dot2_f32_bf16 v109, v69, v69, v109
    v_dot2_f32_bf16 v106, v70, s10, v106
    v_dot2_f32_bf16 v110, v70, v70, v110
    v_dot2_f32_bf16 v107, v71, s10, v107
    v_dot2_f32_bf16 v111, v71, v71, v111
    s_waitcnt lgkmcnt(0)
    s_barrier
    ds_read_b64_tr_b16 v[112:113], v98 offset:0
    ds_read_b64_tr_b16 v[114:115], v98 offset:3840
    ds_read_b64_tr_b16 v[116:117], v98 offset:64
    ds_read_b64_tr_b16 v[118:119], v98 offset:3904
    ds_read_b64_tr_b16 v[120:121], v98 offset:128
    ds_read_b64_tr_b16 v[122:123], v98 offset:3968
    ds_read_b64_tr_b16 v[124:125], v98 offset:192
    ds_read_b64_tr_b16 v[126:127], v98 offset:4032
    ds_read_b64_tr_b16 v[128:129], v98 offset:256
    ds_read_b64_tr_b16 v[130:131], v98 offset:4096
    ds_read_b64_tr_b16 v[132:133], v98 offset:320
    ds_read_b64_tr_b16 v[134:135], v98 offset:4160
    ds_read_b64_tr_b16 v[136:137], v98 offset:384
    ds_read_b64_tr_b16 v[138:139], v98 offset:4224
    v_dot2_f32_bf16 v104, v72, s10, v104
    v_dot2_f32_bf16 v108, v72, v72, v108
    v_dot2_f32_bf16 v105, v73, s10, v105
    v_dot2_f32_bf16 v109, v73, v73, v109
    v_dot2_f32_bf16 v106, v74, s10, v106
    v_dot2_f32_bf16 v110, v74, v74, v110
    v_dot2_f32_bf16 v107, v75, s10, v107
    v_dot2_f32_bf16 v111, v75, v75, v111
    s_waitcnt lgkmcnt(12)
    buffer_store_dwordx4 v[112:115], v99, s[84:87], s48 offen offset:0 sc1
    s_waitcnt lgkmcnt(10)
    buffer_store_dwordx4 v[116:119], v99, s[84:87], s48 offen offset:1024 sc1
    s_waitcnt lgkmcnt(8)
    buffer_store_dwordx4 v[120:123], v99, s[84:87], s48 offen offset:2048 sc1
    s_waitcnt lgkmcnt(6)
    buffer_store_dwordx4 v[124:127], v99, s[84:87], s48 offen offset:3072 sc1
    s_nop 0
    s_waitcnt lgkmcnt(4)
    s_add_u32 s48, s48, 4096
    buffer_store_dwordx4 v[128:131], v99, s[84:87], s48 offen offset:0 sc1
    s_waitcnt lgkmcnt(2)
    buffer_store_dwordx4 v[132:135], v99, s[84:87], s48 offen offset:1024 sc1
    s_waitcnt lgkmcnt(0)
    buffer_store_dwordx4 v[136:139], v99, s[84:87], s48 offen offset:2048 sc1
    v_dot2_f32_bf16 v104, v76, s10, v104
    v_dot2_f32_bf16 v108, v76, v76, v108
    v_dot2_f32_bf16 v105, v77, s10, v105
    v_dot2_f32_bf16 v109, v77, v77, v109
    v_dot2_f32_bf16 v106, v78, s10, v106
    v_dot2_f32_bf16 v110, v78, v78, v110
    v_dot2_f32_bf16 v107, v79, s10, v107
    v_dot2_f32_bf16 v111, v79, v79, v111
    v_dot2_f32_bf16 v104, v80, s10, v104
    v_dot2_f32_bf16 v108, v80, v80, v108
    v_dot2_f32_bf16 v105, v81, s10, v105
    v_dot2_f32_bf16 v109, v81, v81, v109
    v_dot2_f32_bf16 v106, v82, s10, v106
    v_dot2_f32_bf16 v110, v82, v82, v110
    v_dot2_f32_bf16 v107, v83, s10, v107
    v_dot2_f32_bf16 v111, v83, v83, v111
    v_dot2_f32_bf16 v104, v84, s10, v104
    v_dot2_f32_bf16 v108, v84, v84, v108
    v_dot2_f32_bf16 v105, v85, s10, v105
    v_dot2_f32_bf16 v109, v85, v85, v109
    v_dot2_f32_bf16 v106, v86, s10, v106
    v_dot2_f32_bf16 v110, v86, v86, v110
    v_dot2_f32_bf16 v107, v87, s10, v107
    v_dot2_f32_bf16 v111, v87, v87, v111
    v_dot2_f32_bf16 v104, v88, s10, v104
    v_dot2_f32_bf16 v108, v88, v88, v108
    v_dot2_f32_bf16 v105, v89, s10, v105
    v_dot2_f32_bf16 v109, v89, v89, v109
    v_dot2_f32_bf16 v106, v90, s10, v106
    v_dot2_f32_bf16 v110, v90, v90, v110
    v_dot2_f32_bf16 v107, v91, s10, v107
    v_dot2_f32_bf16 v111, v91, v91, v111
    v_add_f32 v104, v104, v105
    s_nop 0
    v_add_f32 v106, v106, v107
    v_add_f32 v108, v108, v109
    v_add_f32 v110, v110, v111
    v_add_f32 v104, v104, v106
    v_add_f32 v108, v108, v110
    s_nop 0
    v_add_f32_dpp v104, v104, v104 quad_perm:[1,0,3,2] row_mask:0xf bank_mask:0xf
    v_add_f32_dpp v108, v108, v108 quad_perm:[1,0,3,2] row_mask:0xf bank_mask:0xf
    s_nop 0
    v_add_f32_dpp v104, v104, v104 quad_perm:[2,3,0,1] row_mask:0xf bank_mask:0xf
    v_add_f32_dpp v108, v108, v108 quad_perm:[2,3,0,1] row_mask:0xf bank_mask:0xf
    s_nop 0
    v_add_f32_dpp v104, v104, v104 row_half_mirror row_mask:0xf bank_mask:0xf
    v_add_f32_dpp v108, v108, v108 row_half_mirror row_mask:0xf bank_mask:0xf
    v_mul_f32 v104, 0x3b124925, v104
    v_mul_f32 v108, 0x3b124925, v108
    v_fma_f32 v108, -v104, v104, v108
    v_max_f32_e64 v108, 0, v108
    v_cvt_pk_bf16_f32 v108, 0, v108
    v_add_f32 v108, 0x3727c5ac, v108
    v_cvt_pk_bf16_f32 v108, 0, v108
    v_sqrt_f32_e64 v108, v108
    v_mov_b32_dpp v105, v104 row_ror:8 row_mask:0xf bank_mask:0xf
    v_cvt_pk_bf16_f32 v108, 0, v108
    v_rcp_f32 v110, v108
    v_cvt_pk_bf16_f32 v109, v104, v105
    s_waitcnt vmcnt(7)
    v_readfirstlane_b32 s59, v30
    s_nop 0
    s_cmp_eq_u32 s59, 0
    s_cbranch_scc1 kf_rn_l
kf_rn_l_ret:
    s_and_b32 s6, s59, 0xffff
    s_mul_i32 s6, s6, 9
    s_lshr_b32 s6, s6, 16
    s_mul_i32 s6, s6, 0x1c00000
    s_add_u32 s16, s4, s6
    s_addc_u32 s17, s5, 0
    v_mov_b32_dpp v111, v110 row_ror:8 row_mask:0xf bank_mask:0xf
    v_mov_b32 v108, s59
    ds_write_b128 v100, v[108:111]
    s_cmp_eq_u32 s20, 0
    s_cbranch_scc1 pg6_l
    s_cmp_eq_u32 s20, 1
    s_cbranch_scc1 pg7_l
    s_cmp_eq_u32 s20, 2
    s_cbranch_scc1 pg3_l
    s_branch pg4_l
    s_nop 0
wl_ret:
    s_cmp_eq_u32 s20, 0
    s_cselect_b32 s6, 0xffff, 0
    s_waitcnt vmcnt(0) lgkmcnt(0)
    s_barrier
    ds_read_b128 v[84:87], v103
    s_mov_b32 exec_hi, 0
    s_mov_b32 exec_lo, s6
    s_waitcnt lgkmcnt(0)
    buffer_store_dwordx4 v[84:87], v102, s[16:19], s49 offen sc1
    s_mov_b64 exec, -1
    s_load_dword s50, s[4:5], s51
    s_mul_i32 s6, s20, 7168
    s_add_u32 m0, s6, 122880
    s_nop 0
    buffer_load_dwordx4 v24, s[40:43], s44 offen lds
    s_add_u32 m0, s6, 123904
    s_add_u32 s44, s44, s45
    buffer_load_dwordx4 v24, s[40:43], s44 offen lds
    s_mov_b32 s6, 1
    s_and_b32 s7, s20, 1
    v_cndmask_b32_e64 v46, v45, v46, s[24:25]
    v_cndmask_b32_e64 v16, v40, v45, s[26:27]
    v_cndmask_b32_e64 v17, v41, v45, s[26:27]
    v_cndmask_b32_e64 v18, v42, v45, s[26:27]
    v_cndmask_b32_e64 v19, v41, v45, s[26:27]
    v_cndmask_b32_e64 v20, v40, v46, s[28:29]
    v_cndmask_b32_e64 v21, v41, v46, s[28:29]
    v_cndmask_b32_e64 v16, v43, v16, s[30:31]
    v_cndmask_b32_e64 v18, v44, v18, s[30:31]
    v_cndmask_b32_e64 v20, v43, v20, s[32:33]
    v_cndmask_b32_e64 v17, v47, v17, s[34:35]
    v_cndmask_b32_e64 v18, v43, v18, s[34:35]
    v_cndmask_b32_e64 v21, v48, v21, s[36:37]
    v_and_b32_e64 v61, 15, v0
    v_bfe_u32 v62, v0, 4, 2
    v_mul_u32_u24 v57, 2080, v61
    v_lshl_add_u32 v57, v62, 4, v57
    s_lshl_b32 s3, s6, 10
    s_add_u32 s3, s3, 76288
    v_add_u32 v26, s3, v57
    s_mul_i32 s15, s7, 33280
    s_sub_u32 s15, s15, 66560
    s_getreg_b32 s53, hwreg(HW_REG_IB_STS, 8, 4)
    v_add_u32 v92, s53, v92
    v_add_u32 v25, s15, v26
    s_mul_i32 s3, s6, 4608
    s_lshl_b32 s7, s7, 8
    s_add_u32 s3, s3, s7
    s_add_u32 s3, s3, 16
    v_lshl_add_u32 v62, v62, 6, s3
    v_lshlrev_b32 v57, 1, v61
    v_subrev_u32 v57, 8, v57
    v_lshlrev_b32 v60, 2, v61
    v_subrev_u32 v60, 32, v60
    v_max3_i32 v57, v61, v57, v60
    v_and_b32 v60, 7, v57
    s_getreg_b32 s53, hwreg(HW_REG_IB_STS, 8, 4)
    v_add_u32 v92, s53, v92
    v_lshrrev_b32 v57, 3, v57
    v_lshl_add_u32 v57, v57, 8, v60
    v_lshl_add_u32 v28, v57, 1, v62
    v_lshlrev_b32 v57, 9, v61
    v_min_u32 v57, 2050, v57
    s_movk_i32 s3, 2048
    v_add3_u32 v27, v57, v62, s3
    s_bitcmp1_b32 s20, 1
    s_cselect_b64 vcc, -1, 0
    s_cselect_b32 s3, 33280, 0
    v_cndmask_b32 v28, v28, v27, vcc
    v_add_u32 v26, s3, v26
    s_getreg_b32 s53, hwreg(HW_REG_IB_STS, 8, 4)
    v_add_u32 v92, s53, v92
    v_and_b32 v58, 31, v0
    v_bfe_u32 v59, v0, 5, 1
    v_lshrrev_b32 v61, 3, v0
    v_bfe_u32 v57, v0, 3, 2
    v_cmp_eq_u32 vcc, 3, v57
    s_nop 1
    v_addc_co_u32 v60, vcc, 0, v57, vcc
    v_mul_u32_u24 v60, 3584, v60
    v_and_b32 v63, 3, v0
    v_mul_u32_u24 v63, 21504, v63
    v_add_u32 v31, v60, v63
    v_lshrrev_b32 v63, 4, v0
    v_and_b32 v57, 15, v0
    s_getreg_b32 s53, hwreg(HW_REG_IB_STS, 8, 4)
    v_add_u32 v92, s53, v92
    v_lshrrev_b32 v60, 2, v0
    v_and_b32 v33, 0x30, v4
    v_lshl_add_u32 v32, v60, 8, v33
    v_lshrrev_b32 v60, 1, v0
    v_and_b32 v33, 16, v4
    v_mul_u32_u24 v60, 14336, v60
    v_add_u32 v33, v33, v60
    v_mul_u32_u24 v250, 320, v63
    v_lshl_add_u32 v250, v57, 2, v250
    s_lshl_b32 s6, s90, 5
    s_and_b32 s6, s6, 64
    v_and_b32 v14, 0x70, v4
    s_getreg_b32 s53, hwreg(HW_REG_IB_STS, 8, 4)
    v_add_u32 v92, s53, v92
    v_xor_b32 v14, s6, v14
    v_lshl_add_u32 v14, v61, 16, v14
    v_and_b32 v60, 3, v0
    v_mul_u32_u24 v60, 4160, v60
    v_add_u32 v60, 47104, v60
    v_bfe_u32 v57, v0, 2, 3
    v_lshl_add_u32 v37, v57, 4, v60
    v_lshlrev_b32 v63, 1, v59
    v_sub_u32 v57, v63, v57
    v_lshl_add_u32 v5, v57, 3, v60
    s_lshl_b32 s6, s20, 9
    s_sub_u32 s6, 1592, s6
    s_getreg_b32 s53, hwreg(HW_REG_IB_STS, 8, 4)
    v_add_u32 v92, s53, v92
    v_add_u32 v5, s6, v5
    s_lshl_b32 s6, s20, 3
    s_sub_u32 s6, 25, s6
    v_add_u32_e64 v6, s6, v58
    v_mul_u32_u24 v6, 80, v6
    v_lshl_add_u32 v6, v59, 4, v6
    v_add_u32 v249, 47104, v4
    v_and_b32 v57, 1, v0
    v_and_b32 v60, 1, v61
    v_lshl_or_b32 v57, v57, 1, v60
    v_mul_u32_u24 v57, 8224, v57
    v_and_b32 v60, 0x70, v0
    s_getreg_b32 s53, hwreg(HW_REG_IB_STS, 8, 4)
    v_add_u32 v92, s53, v92
    v_and_b32 v63, 6, v0
    v_and_b32 v62, 4, v0
    v_add_lshl_u32 v63, v63, v62, 6
    s_lshr_b32 s6, s20, 1
    s_lshl_b32 s6, s6, 12
    s_add_u32 s6, s6, 98304
    v_add3_u32 v12, v57, v60, v63
    v_add_u32 v12, s6, v12
    v_bfe_u32 v57, v0, 3, 2
    v_lshl_add_u32 v15, v57, 2, v4
    v_mov_b32 v252, -1
    v_mov_b32 v253, -1
    s_getreg_b32 s53, hwreg(HW_REG_IB_STS, 8, 4)
    v_add_u32 v92, s53, v92
    v_mov_b32 v254, -1
    v_mov_b32 v255, -1
    s_sub_u32 s3, s2, 32
    s_and_b32 s3, s3, 255
    s_and_b32 s6, s3, 7
    s_lshr_b32 s7, s3, 3
    s_mul_i32 s15, s7, 37
    s_lshr_b32 s15, s15, 8
    s_mul_i32 s12, s15, 7
    s_sub_u32 s12, s7, s12
    s_lshr_b32 s13, s6, 1
    s_lshl_b32 s13, s13, 2
    s_getreg_b32 s53, hwreg(HW_REG_IB_STS, 8, 4)
    v_add_u32 v92, s53, v92
    s_add_u32 s13, s13, s15
    s_and_b32 s14, s6, 1
    s_mul_i32 s15, s14, 7
    s_add_u32 s15, s15, s12
    s_lshl1_add_u32 s21, s13, s14
    s_lshl_b32 s21, s21, 16
    s_mul_i32 s6, s20, 0x1400
    s_and_b32 s6, s6, 0x2400
    s_add_u32 s21, s21, s6
    s_add_u32 s21, s21, 8388608
    s_lshl_b32 s22, s15, 2
    s_add_u32 s22, s22, s20
    s_getreg_b32 s53, hwreg(HW_REG_IB_STS, 8, 4)
    v_add_u32 v92, s53, v92
    s_min_u32 s6, s2, 27
    s_and_b32 s7, s6, 1
    s_mul_i32 s7, s7, 28
    s_andn2_b32 s6, s6, 1
    s_add_u32 s6, s6, s7
    s_lshr_b32 s7, s20, 1
    s_add_u32 s6, s6, s7
    s_and_b32 s7, s20, 1
    s_lshl_b32 s7, s7, 12
    s_lshl_b32 s3, s7, 1
    s_cmp_lt_u32 s2, 32
    s_cselect_b32 s22, s6, s22
    s_getreg_b32 s53, hwreg(HW_REG_IB_STS, 8, 4)
    v_add_u32_e64 v92, s53, v92
    s_cselect_b32 s98, s3, 0
    s_cselect_b32 s99, s7, 0
    s_cselect_b32 s58, 0, 0x1c00000
    s_lshl_b32 s100, s98, 1
    s_mul_i32 s23, s22, 57344
    s_add_u32 s23, s23, 4194304
    s_lshl_b32 s25, s20, 10
    s_lshl_b32 s30, s91, 5
    s_lshl_b32 s39, s91, 3
    s_add_u32 s39, s39, 2621440
    s_mov_b32 s8, 2490368
    s_and_b32 s101, s90, 0x8f
    s_getreg_b32 s53, hwreg(HW_REG_IB_STS, 8, 4)
    v_add_u32 v92, s53, v92
    v_min_u32 v92, 31, v92
    v_xor_b32 v92, s59, v92
    s_mov_b64 exec, 1
    buffer_store_dword v92, off, s[16:19], s52 sc1
    s_mov_b64 exec, -1
    s_mul_i32 s53, s20, 7168
    s_add_u32 m0, s53, 124928
    s_add_u32 s44, s44, s45
    buffer_load_dwordx4 v24, s[40:43], s44 offen lds
    s_add_u32 m0, s53, 125952
    s_add_u32 s44, s44, s45
    buffer_load_dwordx4 v24, s[40:43], s44 offen lds
    s_add_u32 m0, s53, 126976
    s_add_u32 s44, s44, s45
    buffer_load_dwordx4 v24, s[40:43], s44 offen lds
    s_add_u32 m0, s53, 128000
    s_add_u32 s44, s44, s45
    buffer_load_dwordx4 v24, s[40:43], s44 offen lds
    s_add_u32 m0, s53, 129024
    s_add_u32 s44, s44, s45
    buffer_load_dwordx4 v24, s[40:43], s44 offen lds
    s_lshl_b32 s101, s101, 7
    s_and_b32 s6, s90, 0x60
    s_lshl_b32 s6, s6, 6
    s_add_u32 s101, s101, s6
    s_and_b32 s6, s90, 16
    s_lshl_b32 s6, s6, 9
    s_add_u32 s101, s101, s6
    v_mov_b32 v60, 0
    v_mov_b32 v61, 0
    v_mov_b32 v62, 0
    v_mov_b32 v63, 0
    v_lshrrev_b32 v111, 2, v4
    v_add_u32 v111, 157696, v111
    ds_write_b32 v111, v60 offset:5120
    s_mov_b32 s9, 0x3fb8aa3b
    s_mov_b32 s10, 0x32a57060
    s_mov_b32 s11, 0x3f317218
    s_lshr_b32 s3, s22, 1
    s_mul_i32 s3, s3, 3072
    s_and_b32 s6, s22, 1
    s_lshl_b32 s6, s6, 7
    s_add_u32 s3, s3, s6
    s_add_u32 s3, s3, 2916352
    v_min_u32 v245, 176, v3
    v_lshl_add_u32 v245, v245, 4, s3
    s_mov_b32 m0, s94
    s_mov_b64 s[40:41], s[16:17]
    s_cmp_lt_u32 s2, 56
    s_cselect_b32 s42, 0x1c00000, 0
    v_lshlrev_b32 v160, 16, v160
    v_lshlrev_b32 v161, 16, v161
    v_lshlrev_b32 v162, 16, v162
    v_lshlrev_b32 v163, 16, v163
    v_lshlrev_b32 v164, 16, v164
    v_lshlrev_b32 v165, 16, v165
    v_lshlrev_b32 v166, 16, v166
    v_readfirstlane_b32 s89, v167
    v_mul_f32 v168, s9, v166
    v_fma_f32 v169, v166, s9, -v168
    v_fma_f32 v169, v166, s10, v169
    v_exp_f32 v168, v168
    v_mul_f32 v169, s11, v169
    v_fma_f32 v166, v168, v169, v168
    v_cvt_pk_bf16_f32 v166, 0, v166
    s_lshl_b32 s89, s89, 16
    v_pk_mul_f32 v[160:161], v[166:167], v[160:161] op_sel:[0,0] op_sel_hi:[0,1]
    v_pk_mul_f32 v[162:163], v[166:167], v[162:163] op_sel:[0,0] op_sel_hi:[0,1]
    v_mul_f32 v160, s9, v160
    v_mul_f32 v161, 0.15915494309189532, v161
    v_exp_f32 v168, v160
    v_fract_f32 v169, v161
    v_cos_f32 v170, v169
    v_sin_f32 v171, v169
    s_nop 0
    v_pk_mul_f32 v[202:203], v[168:169], v[170:171] op_sel:[0,0] op_sel_hi:[0,1] neg_hi:[1,0]
    v_pk_mul_f32 v[176:177], v[164:165], v[162:163] op_sel:[0,0] op_sel_hi:[0,1] neg_hi:[1,0]
    v_pk_fma_f32 v[176:177], v[164:165], v[162:163], v[176:177] op_sel:[1,1,0] op_sel_hi:[1,0,1] neg_lo:[1,0,0] neg_hi:[1,0,0]
    v_pk_mul_f32 v[194:195], v[202:203], v[202:203] op_sel:[0,0] op_sel_hi:[1,0]
    v_pk_fma_f32 v[206:207], v[202:203], v[202:203], v[194:195] op_sel:[1,1,0] op_sel_hi:[0,1,1] neg_lo:[1,0,0]
    v_pk_mul_f32 v[196:197], v[176:177], v[202:203] op_sel:[0,0] op_sel_hi:[1,0]
    v_pk_fma_f32 v[178:179], v[176:177], v[202:203], v[196:197] op_sel:[1,1,0] op_sel_hi:[0,1,1] neg_lo:[1,0,0]
    v_cvt_pk_bf16_f32 v172, v176, v177
    ds_write_addtid_b32 v172 offset:21504
    v_mul_f32 v168, 0x43800000, v160
    v_mul_f32 v169, 0x43800000, v161
    v_exp_f32 v168, v168
    v_fract_f32 v169, v169
    v_cos_f32_e64 v170, v169
    v_sin_f32 v171, v169
    s_nop 0
    v_pk_mul_f32 v[204:205], v[168:169], v[170:171] op_sel:[0,0] op_sel_hi:[0,1] neg_hi:[1,0]
    v_pk_mul_f32 v[198:199], v[176:177], v[206:207] op_sel:[0,0] op_sel_hi:[1,0]
    v_pk_fma_f32 v[180:181], v[176:177], v[206:207], v[198:199] op_sel:[1,1,0] op_sel_hi:[0,1,1] neg_lo:[1,0,0]
    v_cvt_pk_bf16_f32 v173, v178, v179
    ds_write_addtid_b32 v173 offset:23584
    v_pk_mul_f32 v[200:201], v[178:179], v[206:207] op_sel:[0,0] op_sel_hi:[1,0]
    v_pk_fma_f32 v[182:183], v[178:179], v[206:207], v[200:201] op_sel:[1,1,0] op_sel_hi:[0,1,1] neg_lo:[1,0,0]
    v_cvt_pk_bf16_f32 v174, v180, v181
    ds_write_addtid_b32 v174 offset:25664
    v_pk_mul_f32 v[194:195], v[180:181], v[206:207] op_sel:[0,0] op_sel_hi:[1,0]
    v_pk_fma_f32 v[184:185], v[180:181], v[206:207], v[194:195] op_sel:[1,1,0] op_sel_hi:[0,1,1] neg_lo:[1,0,0]
    v_cvt_pk_bf16_f32 v175, v182, v183
    ds_write_addtid_b32 v175 offset:27744
    v_pk_mul_f32 v[196:197], v[182:183], v[206:207] op_sel:[0,0] op_sel_hi:[1,0]
    v_pk_fma_f32 v[186:187], v[182:183], v[206:207], v[196:197] op_sel:[1,1,0] op_sel_hi:[0,1,1] neg_lo:[1,0,0]
    v_cvt_pk_bf16_f32 v172, v184, v185
    ds_write_addtid_b32 v172 offset:29824
    v_pk_mul_f32 v[198:199], v[184:185], v[206:207] op_sel:[0,0] op_sel_hi:[1,0]
    v_pk_fma_f32 v[188:189], v[184:185], v[206:207], v[198:199] op_sel:[1,1,0] op_sel_hi:[0,1,1] neg_lo:[1,0,0]
    v_cvt_pk_bf16_f32 v173, v186, v187
    ds_write_addtid_b32 v173 offset:31904
    v_pk_mul_f32 v[200:201], v[186:187], v[206:207] op_sel:[0,0] op_sel_hi:[1,0]
    v_pk_fma_f32 v[190:191], v[186:187], v[206:207], v[200:201] op_sel:[1,1,0] op_sel_hi:[0,1,1] neg_lo:[1,0,0]
    v_cvt_pk_bf16_f32 v174, v188, v189
    ds_write_addtid_b32 v174 offset:33984
    v_pk_mul_f32 v[194:195], v[176:177], v[204:205] op_sel:[0,0] op_sel_hi:[1,0]
    v_pk_fma_f32 v[208:209], v[176:177], v[204:205], v[194:195] op_sel:[1,1,0] op_sel_hi:[0,1,1] neg_lo:[1,0,0]
    v_cvt_pk_bf16_f32 v175, v190, v191
    ds_write_addtid_b32 v175 offset:36064
    v_pk_mul_f32 v[196:197], v[180:181], v[204:205] op_sel:[0,0] op_sel_hi:[1,0]
    v_pk_fma_f32 v[210:211], v[180:181], v[204:205], v[196:197] op_sel:[1,1,0] op_sel_hi:[0,1,1] neg_lo:[1,0,0]
    v_cvt_pk_bf16_f32 v172, v208, v209
    ds_write_addtid_b32 v172 offset:38144
    v_pk_mul_f32 v[198:199], v[184:185], v[204:205] op_sel:[0,0] op_sel_hi:[1,0]
    v_pk_fma_f32 v[212:213], v[184:185], v[204:205], v[198:199] op_sel:[1,1,0] op_sel_hi:[0,1,1] neg_lo:[1,0,0]
    v_cvt_pk_bf16_f32 v173, v210, v211
    ds_write_addtid_b32 v173 offset:40224
    v_pk_mul_f32 v[200:201], v[188:189], v[204:205] op_sel:[0,0] op_sel_hi:[1,0]
    v_pk_fma_f32 v[214:215], v[188:189], v[204:205], v[200:201] op_sel:[1,1,0] op_sel_hi:[0,1,1] neg_lo:[1,0,0]
    v_cvt_pk_bf16_f32 v174, v212, v213
    ds_write_addtid_b32 v174 offset:42304
    v_pk_mul_f32 v[194:195], v[208:209], v[204:205] op_sel:[0,0] op_sel_hi:[1,0]
    v_pk_fma_f32 v[216:217], v[208:209], v[204:205], v[194:195] op_sel:[1,1,0] op_sel_hi:[0,1,1] neg_lo:[1,0,0]
    v_cvt_pk_bf16_f32 v175, v214, v215
    ds_write_addtid_b32 v175 offset:44384
    v_pk_mul_f32 v[196:197], v[212:213], v[204:205] op_sel:[0,0] op_sel_hi:[1,0]
    v_pk_fma_f32 v[218:219], v[212:213], v[204:205], v[196:197] op_sel:[1,1,0] op_sel_hi:[0,1,1] neg_lo:[1,0,0]
    v_cvt_pk_bf16_f32 v172, v216, v217
    ds_write_addtid_b32 v172 offset:46464
    v_pk_mul_f32 v[198:199], v[216:217], v[204:205] op_sel:[0,0] op_sel_hi:[1,0]
    v_pk_fma_f32 v[176:177], v[216:217], v[204:205], v[198:199] op_sel:[1,1,0] op_sel_hi:[0,1,1] neg_lo:[1,0,0]
    v_cvt_pk_bf16_f32 v173, v218, v219
    ds_write_addtid_b32 v173 offset:48544
    v_pk_mul_f32 v[200:201], v[218:219], v[204:205] op_sel:[0,0] op_sel_hi:[1,0]
    v_pk_fma_f32 v[178:179], v[218:219], v[204:205], v[200:201] op_sel:[1,1,0] op_sel_hi:[0,1,1] neg_lo:[1,0,0]
    v_cvt_pk_bf16_f32 v174, v176, v177
    ds_write_addtid_b32 v174 offset:50624
    v_pk_mul_f32 v[194:195], v[176:177], v[204:205] op_sel:[0,0] op_sel_hi:[1,0]
    v_pk_fma_f32 v[180:181], v[176:177], v[204:205], v[194:195] op_sel:[1,1,0] op_sel_hi:[0,1,1] neg_lo:[1,0,0]
    v_mul_f32 v168, 0x41000000, v160
    v_mul_f32 v169, 0x41000000, v161
    v_exp_f32 v168, v168
    v_fract_f32 v169, v169
    v_cos_f32_e64 v170, v169
    v_sin_f32 v171, v169
    s_nop 0
    v_pk_mul_f32 v[222:223], v[168:169], v[170:171] op_sel:[0,0] op_sel_hi:[0,1]
    v_cvt_pk_bf16_f32 v175, v178, v179
    ds_write_addtid_b32 v175 offset:52704
    v_pk_mul_f32 v[196:197], v[180:181], v[204:205] op_sel:[0,0] op_sel_hi:[1,0]
    v_pk_fma_f32 v[182:183], v[180:181], v[204:205], v[196:197] op_sel:[1,1,0] op_sel_hi:[0,1,1] neg_lo:[1,0,0]
    v_mov_b32 v220, 1.0
    v_mov_b32 v221, 0
    v_cvt_pk_bf16_f32 v172, v180, v181
    ds_write_addtid_b32 v172 offset:54784
    v_pk_mul_f32 v[198:199], v[182:183], v[204:205] op_sel:[0,0] op_sel_hi:[1,0]
    v_pk_fma_f32 v[184:185], v[182:183], v[204:205], v[198:199] op_sel:[1,1,0] op_sel_hi:[0,1,1] neg_lo:[1,0,0]
    v_pk_mul_f32 v[168:169], v[222:223], v[222:223] op_sel:[0,0] op_sel_hi:[1,0]
    s_branch pg6_s
.p2align 12
pg6_h:
    s_endpgm
pg6_l:
    s_branch pg5_l
pg6_s:
    v_pk_fma_f32 v[224:225], v[222:223], v[222:223], v[168:169] op_sel:[1,1,0] op_sel_hi:[0,1,1] neg_lo:[1,0,0]
    v_cvt_pk_bf16_f32 v173, v182, v183
    ds_write_addtid_b32 v173 offset:56864
    v_pk_mul_f32 v[200:201], v[184:185], v[204:205] op_sel:[0,0] op_sel_hi:[1,0]
    v_pk_fma_f32 v[186:187], v[184:185], v[204:205], v[200:201] op_sel:[1,1,0] op_sel_hi:[0,1,1] neg_lo:[1,0,0]
    v_pk_mul_f32 v[168:169], v[224:225], v[222:223] op_sel:[0,0] op_sel_hi:[1,0]
    v_pk_fma_f32 v[226:227], v[224:225], v[222:223], v[168:169] op_sel:[1,1,0] op_sel_hi:[0,1,1] neg_lo:[1,0,0]
    v_cvt_pk_bf16_f32 v174, v184, v185
    ds_write_addtid_b32 v174 offset:58944
    v_pk_mul_f32 v[194:195], v[186:187], v[204:205] op_sel:[0,0] op_sel_hi:[1,0]
    v_pk_fma_f32 v[188:189], v[186:187], v[204:205], v[194:195] op_sel:[1,1,0] op_sel_hi:[0,1,1] neg_lo:[1,0,0]
    v_pk_mul_f32 v[170:171], v[224:225], v[224:225] op_sel:[0,0] op_sel_hi:[1,0]
    v_pk_fma_f32 v[192:193], v[224:225], v[224:225], v[170:171] op_sel:[1,1,0] op_sel_hi:[0,1,1] neg_lo:[1,0,0]
    v_cvt_pk_bf16_f32 v175, v186, v187
    ds_write_addtid_b32 v175 offset:61024
    v_cvt_pk_bf16_f32 v172, v188, v189
    ds_write_addtid_b32 v172 offset:63104
    s_sub_u32 m0, s94, 46080
    s_waitcnt lgkmcnt(0)
    s_barrier
    v_cvt_pk_bf16_f32 v202, v220, v221
    v_pk_mul_f32 v[194:195], v[220:221], v[192:193] op_sel:[0,0] op_sel_hi:[1,0]
    v_pk_fma_f32 v[176:177], v[220:221], v[192:193], v[194:195] op_sel:[1,1,0] op_sel_hi:[0,1,1] neg_lo:[1,0,0]
    ds_write_addtid_b32 v202 offset:1024
    v_cvt_pk_bf16_f32 v203, v222, v223
    v_pk_mul_f32 v[196:197], v[222:223], v[192:193] op_sel:[0,0] op_sel_hi:[1,0]
    v_pk_fma_f32 v[178:179], v[222:223], v[192:193], v[196:197] op_sel:[1,1,0] op_sel_hi:[0,1,1] neg_lo:[1,0,0]
    ds_write_addtid_b32 v203 offset:3104
    ds_read_b128 a[64:67], v26 offset:0
    v_cvt_pk_bf16_f32 v204, v224, v225
    v_pk_mul_f32 v[198:199], v[224:225], v[192:193] op_sel:[0,0] op_sel_hi:[1,0]
    v_pk_fma_f32 v[180:181], v[224:225], v[192:193], v[198:199] op_sel:[1,1,0] op_sel_hi:[0,1,1] neg_lo:[1,0,0]
    ds_write_addtid_b32 v204 offset:5184
    v_cvt_pk_bf16_f32 v205, v226, v227
    v_pk_mul_f32 v[200:201], v[226:227], v[192:193] op_sel:[0,0] op_sel_hi:[1,0]
    v_pk_fma_f32 v[182:183], v[226:227], v[192:193], v[200:201] op_sel:[1,1,0] op_sel_hi:[0,1,1] neg_lo:[1,0,0]
    ds_write_addtid_b32 v205 offset:7264
    ds_read_b128 a[72:75], v26 offset:64
    v_cvt_pk_bf16_f32 v202, v176, v177
    v_pk_mul_f32 v[194:195], v[176:177], v[192:193] op_sel:[0,0] op_sel_hi:[1,0]
    s_cmp_eq_u32 s20, 0
    s_cselect_b32 s88, s89, 0
    v_mov_b32 v208, 0
    v_mov_b32 v209, 0
    v_mov_b32 v210, 0
    v_mov_b32 v211, 0
    v_writelane_b32 v208, s88, 0
    v_pk_fma_f32 v[184:185], v[176:177], v[192:193], v[194:195] op_sel:[1,1,0] op_sel_hi:[0,1,1] neg_lo:[1,0,0]
    ds_write_addtid_b32 v202 offset:9344
    v_cvt_pk_bf16_f32 v203, v178, v179
    v_pk_mul_f32 v[196:197], v[178:179], v[192:193] op_sel:[0,0] op_sel_hi:[1,0]
    v_pk_fma_f32 v[186:187], v[178:179], v[192:193], v[196:197] op_sel:[1,1,0] op_sel_hi:[0,1,1] neg_lo:[1,0,0]
    ds_write_addtid_b32 v203 offset:11424
    ds_read_b128 a[80:83], v26 offset:128
    v_cvt_pk_bf16_f32 v204, v180, v181
    v_pk_mul_f32 v[198:199], v[180:181], v[192:193] op_sel:[0,0] op_sel_hi:[1,0]
    v_pk_fma_f32 v[188:189], v[180:181], v[192:193], v[198:199] op_sel:[1,1,0] op_sel_hi:[0,1,1] neg_lo:[1,0,0]
    ds_write_addtid_b32 v204 offset:13504
    v_cvt_pk_bf16_f32 v205, v182, v183
    v_pk_mul_f32 v[200:201], v[182:183], v[192:193] op_sel:[0,0] op_sel_hi:[1,0]
    v_pk_fma_f32 v[190:191], v[182:183], v[192:193], v[200:201] op_sel:[1,1,0] op_sel_hi:[0,1,1] neg_lo:[1,0,0]
    ds_write_addtid_b32 v205 offset:15584
    ds_read_b128 a[88:91], v26 offset:192
    v_cvt_pk_bf16_f32 v202, v184, v185
    v_pk_mul_f32 v[194:195], v[184:185], v[192:193] op_sel:[0,0] op_sel_hi:[1,0]
    v_pk_fma_f32 v[176:177], v[184:185], v[192:193], v[194:195] op_sel:[1,1,0] op_sel_hi:[0,1,1] neg_lo:[1,0,0]
    ds_write_addtid_b32 v202 offset:17664
    v_cvt_pk_bf16_f32 v203, v186, v187
    v_pk_mul_f32 v[196:197], v[186:187], v[192:193] op_sel:[0,0] op_sel_hi:[1,0]
    v_pk_fma_f32 v[178:179], v[186:187], v[192:193], v[196:197] op_sel:[1,1,0] op_sel_hi:[0,1,1] neg_lo:[1,0,0]
    ds_write_addtid_b32 v203 offset:19744
    ds_read_b128 a[96:99], v26 offset:256
    v_cvt_pk_bf16_f32 v204, v188, v189
    v_pk_mul_f32 v[198:199], v[188:189], v[192:193] op_sel:[0,0] op_sel_hi:[1,0]
    v_pk_fma_f32 v[180:181], v[188:189], v[192:193], v[198:199] op_sel:[1,1,0] op_sel_hi:[0,1,1] neg_lo:[1,0,0]
    ds_write_addtid_b32 v204 offset:21824
    v_cvt_pk_bf16_f32 v205, v190, v191
    v_pk_mul_f32 v[200:201], v[190:191], v[192:193] op_sel:[0,0] op_sel_hi:[1,0]
    v_pk_fma_f32 v[182:183], v[190:191], v[192:193], v[200:201] op_sel:[1,1,0] op_sel_hi:[0,1,1] neg_lo:[1,0,0]
    ds_write_addtid_b32 v205 offset:23904
    ds_read_b128 a[104:107], v26 offset:320
    v_cvt_pk_bf16_f32 v202, v176, v177
    v_pk_mul_f32 v[194:195], v[176:177], v[192:193] op_sel:[0,0] op_sel_hi:[1,0]
    v_pk_fma_f32 v[184:185], v[176:177], v[192:193], v[194:195] op_sel:[1,1,0] op_sel_hi:[0,1,1] neg_lo:[1,0,0]
    ds_write_addtid_b32 v202 offset:25984
    v_cvt_pk_bf16_f32 v203, v178, v179
    v_pk_mul_f32 v[196:197], v[178:179], v[192:193] op_sel:[0,0] op_sel_hi:[1,0]
    buffer_load_dwordx4 v[64:67], v32, s[16:19], s8 offen offset:0 sc1
    buffer_load_dwordx4 v[68:71], v32, s[16:19], s8 offen offset:64 sc1
    buffer_load_dwordx4 v[72:75], v32, s[16:19], s8 offen offset:128 sc1
    buffer_load_dwordx4 v[76:79], v32, s[16:19], s8 offen offset:192 sc1
    v_pk_fma_f32 v[186:187], v[178:179], v[192:193], v[196:197] op_sel:[1,1,0] op_sel_hi:[0,1,1] neg_lo:[1,0,0]
    ds_write_addtid_b32 v203 offset:28064
    ds_read_b128 a[112:115], v26 offset:384
    v_cvt_pk_bf16_f32 v204, v180, v181
    v_pk_mul_f32 v[198:199], v[180:181], v[192:193] op_sel:[0,0] op_sel_hi:[1,0]
    v_pk_fma_f32 v[188:189], v[180:181], v[192:193], v[198:199] op_sel:[1,1,0] op_sel_hi:[0,1,1] neg_lo:[1,0,0]
    ds_write_addtid_b32 v204 offset:30144
    v_cvt_pk_bf16_f32 v205, v182, v183
    v_pk_mul_f32 v[200:201], v[182:183], v[192:193] op_sel:[0,0] op_sel_hi:[1,0]
    v_pk_fma_f32 v[190:191], v[182:183], v[192:193], v[200:201] op_sel:[1,1,0] op_sel_hi:[0,1,1] neg_lo:[1,0,0]
    s_mov_b32 s7, 2220032
    buffer_load_dwordx4 v[160:163], v3, s[16:19], s7 offen sc1
    ds_write_addtid_b32 v205 offset:32224
    ds_read_b128 a[120:123], v26 offset:448
    v_cvt_pk_bf16_f32 v202, v184, v185
    v_pk_mul_f32 v[194:195], v[184:185], v[192:193] op_sel:[0,0] op_sel_hi:[1,0]
    v_pk_fma_f32 v[176:177], v[184:185], v[192:193], v[194:195] op_sel:[1,1,0] op_sel_hi:[0,1,1] neg_lo:[1,0,0]
    ds_write_addtid_b32 v202 offset:34304
    v_cvt_pk_bf16_f32 v203, v186, v187
    v_pk_mul_f32 v[196:197], v[186:187], v[192:193] op_sel:[0,0] op_sel_hi:[1,0]
    v_pk_fma_f32 v[178:179], v[186:187], v[192:193], v[196:197] op_sel:[1,1,0] op_sel_hi:[0,1,1] neg_lo:[1,0,0]
    ds_write_addtid_b32 v203 offset:36384
    ds_read_b128 a[128:131], v26 offset:512
    v_cvt_pk_bf16_f32 v204, v188, v189
    v_pk_mul_f32 v[198:199], v[188:189], v[192:193] op_sel:[0,0] op_sel_hi:[1,0]
    v_pk_fma_f32 v[180:181], v[188:189], v[192:193], v[198:199] op_sel:[1,1,0] op_sel_hi:[0,1,1] neg_lo:[1,0,0]
    ds_write_addtid_b32 v204 offset:38464
    v_cvt_pk_bf16_f32 v205, v190, v191
    v_pk_mul_f32 v[200:201], v[190:191], v[192:193] op_sel:[0,0] op_sel_hi:[1,0]
    v_pk_fma_f32 v[182:183], v[190:191], v[192:193], v[200:201] op_sel:[1,1,0] op_sel_hi:[0,1,1] neg_lo:[1,0,0]
    ds_write_addtid_b32 v205 offset:40544
    ds_read_b128 a[136:139], v26 offset:576
    s_nop 0
    s_waitcnt vmcnt(5)
    ds_read_b64_tr_b16 a[224:225], v56 offset:0
    v_cvt_pk_bf16_f32 v202, v176, v177
    v_pk_mul_f32 v[194:195], v[176:177], v[192:193] op_sel:[0,0] op_sel_hi:[1,0]
    ds_read_b64_tr_b16 a[226:227], v56 offset:256
    v_pk_fma_f32 v[184:185], v[176:177], v[192:193], v[194:195] op_sel:[1,1,0] op_sel_hi:[0,1,1] neg_lo:[1,0,0]
    ds_write_addtid_b32 v202 offset:42624
    ds_read_b64_tr_b16 a[228:229], v56 offset:1024
    v_cvt_pk_bf16_f32 v203, v178, v179
    v_pk_mul_f32 v[196:197], v[178:179], v[192:193] op_sel:[0,0] op_sel_hi:[1,0]
    ds_read_b64_tr_b16 a[230:231], v56 offset:1280
    v_pk_fma_f32 v[186:187], v[178:179], v[192:193], v[196:197] op_sel:[1,1,0] op_sel_hi:[0,1,1] neg_lo:[1,0,0]
    ds_write_addtid_b32 v203 offset:44704
    ds_read_b64_tr_b16 a[232:233], v56 offset:2048
    ds_read_b128 a[144:147], v26 offset:640
    v_cvt_pk_bf16_f32 v204, v180, v181
    ds_read_b64_tr_b16 a[234:235], v56 offset:2304
    v_pk_mul_f32 v[198:199], v[180:181], v[192:193] op_sel:[0,0] op_sel_hi:[1,0]
    v_pk_fma_f32 v[188:189], v[180:181], v[192:193], v[198:199] op_sel:[1,1,0] op_sel_hi:[0,1,1] neg_lo:[1,0,0]
    ds_read_b64_tr_b16 a[236:237], v56 offset:3072
    ds_write_addtid_b32 v204 offset:46784
    v_cvt_pk_bf16_f32 v205, v182, v183
    ds_read_b64_tr_b16 a[238:239], v56 offset:3328
    v_pk_mul_f32 v[200:201], v[182:183], v[192:193] op_sel:[0,0] op_sel_hi:[1,0]
    v_pk_fma_f32 v[190:191], v[182:183], v[192:193], v[200:201] op_sel:[1,1,0] op_sel_hi:[0,1,1] neg_lo:[1,0,0]
    ds_read_b64_tr_b16 a[240:241], v56 offset:4096
    ds_write_addtid_b32 v205 offset:48864
    ds_read_b128 a[152:155], v26 offset:704
    ds_read_b64_tr_b16 a[242:243], v56 offset:4352
    v_cvt_pk_bf16_f32 v202, v184, v185
    v_pk_mul_f32 v[194:195], v[184:185], v[192:193] op_sel:[0,0] op_sel_hi:[1,0]
    ds_read_b64_tr_b16 a[244:245], v56 offset:5120
    v_pk_fma_f32 v[176:177], v[184:185], v[192:193], v[194:195] op_sel:[1,1,0] op_sel_hi:[0,1,1] neg_lo:[1,0,0]
    ds_write_addtid_b32 v202 offset:50944
    ds_read_b64_tr_b16 a[246:247], v56 offset:5376
    v_cvt_pk_bf16_f32 v203, v186, v187
    v_pk_mul_f32 v[196:197], v[186:187], v[192:193] op_sel:[0,0] op_sel_hi:[1,0]
    ds_read_b64_tr_b16 a[248:249], v56 offset:6144
    v_pk_fma_f32 v[178:179], v[186:187], v[192:193], v[196:197] op_sel:[1,1,0] op_sel_hi:[0,1,1] neg_lo:[1,0,0]
    ds_write_addtid_b32 v203 offset:53024
    ds_read_b64_tr_b16 a[250:251], v56 offset:6400
    s_waitcnt lgkmcnt(15)
    buffer_store_dwordx4 a[224:227], v3, s[40:43], s46 offen sc1
    ds_read_b128 a[160:163], v26 offset:768
    s_add_u32 s46, s46, s47
    v_cvt_pk_bf16_f32 v204, v188, v189
    s_sub_u32 s47, 229376, s47
    v_pk_mul_f32 v[198:199], v[188:189], v[192:193] op_sel:[0,0] op_sel_hi:[1,0]
    buffer_store_dwordx4 a[228:231], v3, s[40:43], s46 offen sc1
    v_pk_fma_f32 v[180:181], v[188:189], v[192:193], v[198:199] op_sel:[1,1,0] op_sel_hi:[0,1,1] neg_lo:[1,0,0]
    s_add_u32 s46, s46, s47
    ds_write_addtid_b32 v204 offset:55104
    s_sub_u32 s47, 229376, s47
    v_cvt_pk_bf16_f32 v205, v190, v191
    s_waitcnt lgkmcnt(15)
    buffer_store_dwordx4 a[232:235], v3, s[40:43], s46 offen sc1
    v_pk_mul_f32 v[200:201], v[190:191], v[192:193] op_sel:[0,0] op_sel_hi:[1,0]
    s_add_u32 s46, s46, s47
    v_pk_fma_f32 v[182:183], v[190:191], v[192:193], v[200:201] op_sel:[1,1,0] op_sel_hi:[0,1,1] neg_lo:[1,0,0]
    s_sub_u32 s47, 229376, s47
    ds_write_addtid_b32 v205 offset:57184
    s_waitcnt lgkmcnt(13)
    buffer_store_dwordx4 a[236:239], v3, s[40:43], s46 offen sc1
    ds_read_b128 a[168:171], v26 offset:832
    s_add_u32 s46, s46, s47
    v_cvt_pk_bf16_f32 v202, v176, v177
    s_sub_u32 s47, 229376, s47
    ds_write_addtid_b32 v202 offset:59264
    s_waitcnt lgkmcnt(11)
    buffer_store_dwordx4 a[240:243], v3, s[40:43], s46 offen sc1
    v_cvt_pk_bf16_f32 v203, v178, v179
    s_add_u32 s46, s46, s47
    ds_write_addtid_b32 v203 offset:61344
    s_sub_u32 s47, 229376, s47
    ds_read_b128 a[176:179], v26 offset:896
    s_waitcnt lgkmcnt(10)
    buffer_store_dwordx4 a[244:247], v3, s[40:43], s46 offen sc1
    v_cvt_pk_bf16_f32 v204, v180, v181
    s_add_u32 s46, s46, s47
    ds_write_addtid_b32 v204 offset:63424
    s_waitcnt lgkmcnt(8)
    buffer_store_dwordx4 a[248:251], v3, s[40:43], s46 offen sc1
    v_cvt_pk_bf16_f32 v205, v182, v183
    ds_write_addtid_b32 v205 offset:65504
    ds_read_b128 a[184:187], v26 offset:960
    s_waitcnt lgkmcnt(0)
    s_barrier
    ds_read_b128 a[0:3], v25 offset:0
    ds_read_b128 a[4:7], v25 offset:64
    ds_read_b128 a[8:11], v25 offset:128
    ds_read_b128 a[12:15], v25 offset:192
    ds_read_b128 a[16:19], v25 offset:256
    ds_read_b128 a[20:23], v25 offset:320
    ds_read_b128 a[24:27], v25 offset:384
    ds_read_b128 a[28:31], v25 offset:448
    ds_read_b128 a[32:35], v25 offset:512
    ds_read_b128 a[36:39], v25 offset:576
    ds_read_b128 a[40:43], v25 offset:640
    ds_read_b128 a[44:47], v25 offset:704
    ds_read_b128 a[48:51], v25 offset:768
    ds_read_b128 a[52:55], v25 offset:832
    ds_read_b128 a[56:59], v25 offset:896
    ds_read_b128 a[60:63], v25 offset:960
    s_waitcnt vmcnt(8)
    v_xor_b32 v56, s59, v64
    v_xor_b32 v57, s59, v68
    v_xor_b32 v58, s59, v72
    v_xor_b32 v59, s59, v76
    v_or3_b32 v56, v56, v57, v58
    v_or_b32 v56, v56, v59
    v_cmp_ne_u32 vcc, 0, v56
    s_cbranch_vccnz kf_rp_l
kf_rp_l_ret:
    buffer_load_dwordx2 v[220:221], v31, s[16:19], s39 offen sc1
    s_waitcnt lgkmcnt(15)
    v_mfma_f32_16x16x32_bf16 v[176:179], a[0:3], a[64:67], v[208:211]
    buffer_load_dwordx4 v[228:231], v33, s[84:87], s30 offen sc1
    s_waitcnt lgkmcnt(14)
    v_mfma_f32_16x16x32_bf16 v[176:179], a[4:7], a[72:75], v[176:179]
    s_waitcnt lgkmcnt(13)
    v_mfma_f32_16x16x32_bf16 v[176:179], a[8:11], a[80:83], v[176:179]
    s_waitcnt lgkmcnt(12)
    v_mfma_f32_16x16x32_bf16 v[176:179], a[12:15], a[88:91], v[176:179]
    s_waitcnt lgkmcnt(11)
    v_mfma_f32_16x16x32_bf16 v[176:179], a[16:19], a[96:99], v[176:179]
    s_waitcnt lgkmcnt(10)
    v_mfma_f32_16x16x32_bf16 v[176:179], a[20:23], a[104:107], v[176:179]
    s_waitcnt lgkmcnt(9)
    v_mfma_f32_16x16x32_bf16 v[176:179], a[24:27], a[112:115], v[176:179]
    s_waitcnt lgkmcnt(8)
    v_mfma_f32_16x16x32_bf16 v[176:179], a[28:31], a[120:123], v[176:179]
    s_waitcnt lgkmcnt(7)
    v_mfma_f32_16x16x32_bf16 v[176:179], a[32:35], a[128:131], v[176:179]
    s_waitcnt lgkmcnt(6)
    v_mfma_f32_16x16x32_bf16 v[176:179], a[36:39], a[136:139], v[176:179]
    s_waitcnt lgkmcnt(5)
    v_mfma_f32_16x16x32_bf16 v[176:179], a[40:43], a[144:147], v[176:179]
    s_waitcnt lgkmcnt(4)
    v_mfma_f32_16x16x32_bf16 v[176:179], a[44:47], a[152:155], v[176:179]
    s_waitcnt lgkmcnt(3)
    v_mfma_f32_16x16x32_bf16 v[176:179], a[48:51], a[160:163], v[176:179]
    s_waitcnt lgkmcnt(2)
    v_mfma_f32_16x16x32_bf16 v[176:179], a[52:55], a[168:171], v[176:179]
    s_waitcnt lgkmcnt(1)
    v_mfma_f32_16x16x32_bf16 v[176:179], a[56:59], a[176:179], v[176:179]
    s_waitcnt lgkmcnt(0)
    v_mfma_f32_16x16x32_bf16 v[176:179], a[60:63], a[184:187], v[176:179]
    s_waitcnt vmcnt(9)
    v_xor_b32 v164, s59, v160
    v_xor_b32 v165, s59, v161
    v_xor_b32 v166, s59, v162
    v_xor_b32 v167, s59, v163
    v_or3_b32 v168, v164, v165, v166
    v_or_b32 v168, v168, v167
    v_cmp_lt_u32 vcc, 31, v168
    s_cbranch_vccnz kf_rv_l
kf_rv_l_ret:
    v_add_u32 v164, v164, v166
    v_add_u32 v165, v165, v167
    v_cmp_gt_u32 vcc, v164, v165
    s_nop 0
    s_xor_b32 vcc_lo, vcc_lo, 0xf0f0f0f0
    s_xor_b32 vcc_hi, vcc_hi, 0xf0f0f0f0
    s_bcnt1_i32_b64 s6, vcc
    s_cmp_ge_u32 s6, 32
    s_cselect_b32 s93, 0x2000, 0
    s_xor_b32 s21, s21, s93
    s_xor_b32 s101, s101, s93
    s_add_u32 s6, s101, 8388608
    buffer_store_dwordx4 v[252:255], v14, s[16:19], s6 offen sc1
    s_sub_u32 s6, s2, 28
    s_cmp_lt_u32 s6, 4
    s_cselect_b32 s42, 0, 0x1c00000
    v_cvt_pk_bf16_f32 v176, v176, v177
    v_cvt_pk_bf16_f32 v177, v178, v179
    ds_write_b16 v28, v176 offset:0
    ds_write_b16_d16_hi v28, v176 offset:16
    ds_write_b16 v28, v177 offset:32
    ds_write_b16_d16_hi v28, v177 offset:48
    s_waitcnt lgkmcnt(0)
    s_barrier
    ds_read_b128 v[180:183], v36 offset:4624
    ds_read_b32 v184, v36 offset:4640
    ds_read_b128 v[176:179], v36 offset:4608
    s_mov_b32 s9, 0x05040100
    v_cmp_gt_u32 vcc, 16, v0
    s_nop 0
    s_and_saveexec_b64 s[36:37], vcc
    ds_write_b128 v37, v[60:63] offset:38656
    s_mov_b64 exec, s[36:37]
    v_cmp_gt_u32 vcc, 160, v0
    s_nop 0
    s_and_saveexec_b64 s[36:37], vcc
    ds_write_b128 v4, v[60:63] offset:32256
    s_mov_b64 exec, s[36:37]
    v_lshlrev_b32 v64, 16, v65
    v_and_b32 v65, 0xffff0000, v65
    v_lshlrev_b32 v68, 16, v69
    v_and_b32 v69, 0xffff0000, v69
    v_lshlrev_b32 v72, 16, v73
    v_and_b32 v73, 0xffff0000, v73
    v_lshlrev_b32 v76, 16, v77
    v_and_b32 v77, 0xffff0000, v77
    v_pk_mul_f32 v[64:65], v[64:65], v[66:67] neg_lo:[1,0] neg_hi:[1,0]
    v_pk_mul_f32 v[68:69], v[68:69], v[70:71] neg_lo:[1,0] neg_hi:[1,0]
    v_pk_mul_f32 v[72:73], v[72:73], v[74:75] neg_lo:[1,0] neg_hi:[1,0]
    v_pk_mul_f32 v[76:77], v[76:77], v[78:79] neg_lo:[1,0] neg_hi:[1,0]
    s_waitcnt lgkmcnt(2)
    v_perm_b32 v185, v184, v180, s9
    v_perm_b32 v186, v182, v180, s9
    v_perm_b32 v192, v184, v183, v16
    v_perm_b32 v195, v180, v180, v19
    v_perm_b32 v193, v185, v182, v17
    v_perm_b32 v194, v186, v181, v18
    v_perm_b32 v187, v180, v176, s9
    v_perm_b32 v196, v180, v179, v20
    v_perm_b32 v197, v187, v178, v21
    ds_write_b128 v249, v[192:195] offset:47040
    v_pk_mov_b32 v[200:201], v[192:193], v[194:195] op_sel:[1,0]
    v_pk_mov_b32 v[202:203], v[194:195], v[196:197] op_sel:[1,0]
    ds_write_b128 v249, v[200:203] offset:38720
    v_alignbit_b32 v208, v193, v192, 16
    v_alignbit_b32 v209, v194, v193, 16
    v_alignbit_b32 v210, v195, v194, 16
    v_alignbit_b32 v211, v196, v195, 16
    ds_write_b128 v249, v[208:211] offset:42880
    s_waitcnt vmcnt(2)
    v_cmp_ne_u32 vcc, s59, v220
    s_cbranch_vccnz kf_rm_l
kf_rm_l_ret:
    v_add_f32_dpp v221, v221, v221 quad_perm:[1,0,3,2] row_mask:0xf bank_mask:0xf
    s_nop 1
    v_add_f32_dpp v221, v221, v221 quad_perm:[2,3,0,1] row_mask:0xf bank_mask:0xf
    v_cvt_pk_bf16_f32 v221, 0, v221
    v_add_f32 v220, 1.0, v221
    v_pk_mov_b32 v[214:215], v[208:209], v[210:211] op_sel:[1,0]
    v_cvt_pk_bf16_f32 v220, 0, v220
    v_mov_b32 v216, v211
    v_readlane_b32 s49, v221, 0
    v_alignbit_b32 v217, v197, v196, 16
    v_add_f32 v220, 0x2b800000, v220
    ds_write_b128 v249, v[214:217] offset:34560
    v_readlane_b32 s53, v221, 16
    v_readlane_b32 s51, v220, 8
    v_readlane_b32 s55, v220, 24
    v_mov_b32 v220, s49
    s_waitcnt vmcnt(1)
    v_lshlrev_b32 v232, 16, v228
    v_and_b32 v233, 0xffff0000, v228
    v_lshlrev_b32 v234, 16, v229
    v_and_b32 v235, 0xffff0000, v229
    v_lshlrev_b32 v236, 16, v230
    v_and_b32 v237, 0xffff0000, v230
    v_lshlrev_b32 v238, 16, v231
    v_and_b32 v239, 0xffff0000, v231
    v_pk_fma_f32 v[232:233], v[232:233], v[66:67], v[64:65]
    v_pk_fma_f32 v[234:235], v[234:235], v[70:71], v[68:69]
    v_pk_fma_f32 v[236:237], v[236:237], v[74:75], v[72:73]
    v_pk_fma_f32 v[238:239], v[238:239], v[78:79], v[76:77]
    v_pk_fma_f32 v[232:233], v[232:233], s[50:51], v[220:221] op_sel:[0,1,0] op_sel_hi:[1,1,0]
    v_pk_fma_f32 v[234:235], v[234:235], s[50:51], v[220:221] op_sel:[0,1,0] op_sel_hi:[1,1,0]
    v_pk_fma_f32 v[236:237], v[236:237], s[50:51], v[220:221] op_sel:[0,1,0] op_sel_hi:[1,1,0]
    v_pk_fma_f32 v[238:239], v[238:239], s[50:51], v[220:221] op_sel:[0,1,0] op_sel_hi:[1,1,0]
    v_cvt_pk_bf16_f32 v240, v232, v233
    ds_write_b32 v250, v240 offset:34816
    v_cvt_pk_bf16_f32 v241, v234, v235
    ds_write_b32 v250, v241 offset:34896
    v_cvt_pk_bf16_f32 v242, v236, v237
    ds_write_b32 v250, v242 offset:34976
    v_cvt_pk_bf16_f32 v243, v238, v239
    ds_write_b32 v250, v243 offset:35056
    buffer_load_dword v244, v245, s[16:19], 0 offen sc1
    s_waitcnt vmcnt(1) lgkmcnt(0)
    s_barrier
    ds_read_b64 v[32:33], v5 offset:37056
    ds_read_b64 v[34:35], v5 offset:37064
    ds_read_b128 v[36:39], v6 offset:32816
    ds_read_b128 v[40:43], v6 offset:35376
    ds_read_b64 v[44:45], v5 offset:35008
    ds_read_b64 v[46:47], v5 offset:35016
    ds_read_b64 v[48:49], v5 offset:37088
    ds_read_b64 v[50:51], v5 offset:37096
    ds_read_b128 v[52:55], v6 offset:32848
    ds_read_b128 v[56:59], v6 offset:35408
    ds_read_b64 v[60:61], v5 offset:35040
    ds_read_b64 v[62:63], v5 offset:35048
    s_waitcnt lgkmcnt(6)
    v_mfma_f32_32x32x16_bf16 v[176:191], v[32:35], v[36:39], 0
    ds_read_b64 v[16:17], v5 offset:36992
    ds_read_b64 v[18:19], v5 offset:37000
    ds_read_b128 v[20:23], v6 offset:32736
    s_lshl_b32 s6, s2, 4
    s_add_u32 s6, s6, 2228224
    v_mov_b32 v2, s59
    s_cmp_eq_u32 s20, 0
    s_cselect_b64 exec, 1, 0
    buffer_store_dword v2, off, s[16:19], s6 sc1
    s_mov_b64 exec, -1
    v_mfma_f32_32x32x16_bf16 v[192:207], v[32:35], v[40:43], 0
    ds_read_b128 v[24:27], v6 offset:35296
    ds_read_b64 v[28:29], v5 offset:34944
    ds_read_b64 v[30:31], v5 offset:34952
    v_min_u32 v110, 3568, v4
    s_mov_b32 s3, 2632192
    buffer_load_dwordx4 v[112:115], v110, s[16:19], s3 offen sc1
    v_mfma_f32_32x32x16_bf16 v[192:207], v[44:47], v[36:39], v[192:207]
    s_mov_b32 s3, 2635776
    buffer_load_dwordx4 v[128:131], v110, s[16:19], s3 offen sc1
    s_mov_b32 s3, 2639360
    buffer_load_dwordx4 v[144:147], v110, s[16:19], s3 offen sc1
    s_mov_b32 s3, 2653696
    s_nop 0
    s_waitcnt lgkmcnt(6)
    v_mfma_f32_32x32x16_bf16 v[176:191], v[48:51], v[52:55], v[176:191]
    ds_read_b64 v[32:33], v5 offset:37024
    ds_read_b64 v[34:35], v5 offset:37032
    ds_read_b128 v[36:39], v6 offset:32768
    buffer_load_dwordx4 v[116:119], v110, s[16:19], s3 offen sc1
    s_mov_b32 s3, 2657280
    buffer_load_dwordx4 v[132:135], v110, s[16:19], s3 offen sc1
    v_mfma_f32_32x32x16_bf16 v[192:207], v[48:51], v[56:59], v[192:207]
    ds_read_b128 v[40:43], v6 offset:35328
    ds_read_b64 v[44:45], v5 offset:34976
    ds_read_b64 v[46:47], v5 offset:34984
    s_mov_b32 s3, 2660864
    buffer_load_dwordx4 v[148:151], v110, s[16:19], s3 offen sc1
    s_mov_b32 s3, 2675200
    v_mfma_f32_32x32x16_bf16 v[192:207], v[60:63], v[52:55], v[192:207]
    buffer_load_dwordx4 v[120:123], v110, s[16:19], s3 offen sc1
    s_mov_b32 s3, 2678784
    buffer_load_dwordx4 v[136:139], v110, s[16:19], s3 offen sc1
    s_mov_b32 s3, 2682368
    buffer_load_dwordx4 v[152:155], v110, s[16:19], s3 offen sc1
    s_waitcnt vmcnt(9)
    v_cmp_ne_u32_e64 vcc, s59, v244
    s_cbranch_vccnz kf_rw_l
kf_rw_l_ret:
    s_waitcnt lgkmcnt(6)
    v_mfma_f32_32x32x16_bf16 v[176:191], v[16:19], v[20:23], v[176:191]
    s_add_u32 s34, s98, s23
    buffer_load_dwordx4 a[0:3], v3, s[40:43], s34 offen offset:0 sc1
    ds_read_b64 v[48:49], v5 offset:36928
    ds_read_b64 v[50:51], v5 offset:36936
    ds_read_b128 v[52:55], v6 offset:32656
    s_mov_b32 s3, 2696704
    buffer_load_dwordx4 v[124:127], v110, s[16:19], s3 offen sc1
    s_mov_b32 s3, 2700288
    buffer_load_dwordx4 a[4:7], v3, s[40:43], s34 offen offset:1024 sc1
    v_mfma_f32_32x32x16_bf16 v[192:207], v[16:19], v[24:27], v[192:207]
    ds_read_b128 v[56:59], v6 offset:35216
    ds_read_b64 v[60:61], v5 offset:34880
    ds_read_b64 v[62:63], v5 offset:34888
    buffer_load_dwordx4 v[140:143], v110, s[16:19], s3 offen sc1
    s_mov_b32 s3, 2703872
    buffer_load_dwordx4 a[8:11], v3, s[40:43], s34 offen offset:2048 sc1
    v_mfma_f32_32x32x16_bf16 v[192:207], v[28:31], v[20:23], v[192:207]
    buffer_load_dwordx4 v[156:159], v110, s[16:19], s3 offen sc1
    s_add_u32 s29, s101, 8388608
    v_lshlrev_b32_e64 v216, 16, v228
    v_and_b32 v220, 0xffff0000, v228
    v_lshlrev_b32 v217, 16, v229
    buffer_load_dwordx4 a[12:15], v3, s[40:43], s34 offen offset:3072 sc1
    s_waitcnt lgkmcnt(6)
    v_mfma_f32_32x32x16_bf16 v[176:191], v[32:35], v[36:39], v[176:191]
    ds_read_b64 v[16:17], v5 offset:36960
    ds_read_b64 v[18:19], v5 offset:36968
    ds_read_b128 v[20:23], v6 offset:32688
    v_and_b32 v221, 0xffff0000, v229
    v_lshlrev_b32 v218, 16, v230
    s_add_u32 s34, s100, s23
    s_add_u32 s34, s34, 24576
    buffer_load_dwordx4 a[96:99], v3, s[40:43], s34 offen offset:0 sc1
    v_mfma_f32_32x32x16_bf16 v[192:207], v[32:35], v[40:43], v[192:207]
    ds_read_b128 v[24:27], v6 offset:35248
    ds_read_b64 v[28:29], v5 offset:34912
    ds_read_b64 v[30:31], v5 offset:34920
    v_and_b32 v222, 0xffff0000, v230
    v_lshlrev_b32_e64 v219, 16, v231
    buffer_load_dwordx4 a[100:103], v3, s[40:43], s34 offen offset:1024 sc1
    v_mfma_f32_32x32x16_bf16 v[192:207], v[44:47], v[36:39], v[192:207]
    v_and_b32 v223, 0xffff0000, v231
    v_and_b32_e64 v7, 3, v0
    v_lshlrev_b32 v7, 3, v7
    v_bfe_u32 v1, v0, 4, 1
    v_lshl_add_u32 v7, v1, 5, v7
    buffer_load_dwordx4 a[104:107], v3, s[40:43], s34 offen offset:2048 sc1
    s_waitcnt lgkmcnt(6)
    v_mfma_f32_32x32x16_bf16 v[176:191], v[48:51], v[52:55], v[176:191]
    ds_read_b64 v[32:33], v5 offset:36864
    ds_read_b64 v[34:35], v5 offset:36872
    ds_read_b128 v[36:39], v6 offset:32576
    v_bfe_u32 v1, v0, 2, 2
    v_lshl_add_u32 v7, v1, 7, v7
    buffer_load_dwordx4 a[108:111], v3, s[40:43], s34 offen offset:3072 sc1
    v_mfma_f32_32x32x16_bf16 v[192:207], v[48:51], v[56:59], v[192:207]
    ds_read_b128 v[40:43], v6 offset:35136
    ds_read_b64 v[44:45], v5 offset:34816
    ds_read_b64 v[46:47], v5 offset:34824
    v_bfe_u32 v1, v0, 5, 1
    v_lshl_add_u32 v7, v1, 10, v7
    s_xor_b32 s34, s100, 4096
    s_add_u32 s34, s34, s23
    s_add_u32 s34, s34, 24576
    buffer_load_dwordx4 a[112:115], v3, s[40:43], s34 offen offset:0 sc1
    v_mfma_f32_32x32x16_bf16 v[192:207], v[60:63], v[52:55], v[192:207]
    v_bfe_u32 v1, v0, 3, 1
    v_lshl_add_u32 v7, v1, 6, v7
    s_waitcnt lgkmcnt(6)
    v_mfma_f32_32x32x16_bf16 v[176:191], v[16:19], v[20:23], v[176:191]
    ds_read_b64 v[48:49], v5 offset:36896
    ds_read_b64 v[50:51], v5 offset:36904
    buffer_load_dwordx4 a[116:119], v3, s[40:43], s34 offen offset:1024 sc1
    ds_read_b128 v[52:55], v6 offset:32608
    v_mfma_f32_32x32x16_bf16 v[192:207], v[16:19], v[24:27], v[192:207]
    ds_read_b128 v[56:59], v6 offset:35168
    ds_read_b64 v[60:61], v5 offset:34848
    ds_read_b64 v[62:63], v5 offset:34856
    v_mfma_f32_32x32x16_bf16 v[192:207], v[28:31], v[20:23], v[192:207]
    buffer_load_dwordx4 a[120:123], v3, s[40:43], s34 offen offset:2048 sc1
    s_nop 0
    s_waitcnt lgkmcnt(6)
    v_mfma_f32_32x32x16_bf16 v[176:191], v[32:35], v[36:39], v[176:191]
    ds_read_b64 v[16:17], v5 offset:36800
    ds_read_b64 v[18:19], v5 offset:36808
    ds_read_b128 v[20:23], v6 offset:32496
    v_mfma_f32_32x32x16_bf16 v[192:207], v[32:35], v[40:43], v[192:207]
    ds_read_b128 v[24:27], v6 offset:35056
    buffer_load_dwordx4 a[124:127], v3, s[40:43], s34 offen offset:3072 sc1
    ds_read_b64 v[28:29], v5 offset:34752
    ds_read_b64 v[30:31], v5 offset:34760
    v_mfma_f32_32x32x16_bf16 v[192:207], v[44:47], v[36:39], v[192:207]
    s_waitcnt lgkmcnt(6)
    v_mfma_f32_32x32x16_bf16 v[176:191], v[48:51], v[52:55], v[176:191]
    ds_read_b64 v[32:33], v5 offset:36832
    ds_read_b64 v[34:35], v5 offset:36840
    s_xor_b32 s34, s99, 16384
    s_add_u32 s34, s34, s23
    buffer_load_dwordx4 a[64:67], v3, s[40:43], s34 offen offset:0 sc1
    ds_read_b128 v[36:39], v6 offset:32528
    v_mfma_f32_32x32x16_bf16 v[192:207], v[48:51], v[56:59], v[192:207]
    ds_read_b128 v[40:43], v6 offset:35088
    ds_read_b64 v[44:45], v5 offset:34784
    ds_read_b64 v[46:47], v5 offset:34792
    v_mfma_f32_32x32x16_bf16 v[192:207], v[60:63], v[52:55], v[192:207]
    buffer_load_dwordx4 a[68:71], v3, s[40:43], s34 offen offset:1024 sc1
    s_waitcnt lgkmcnt(6)
    v_mfma_f32_32x32x16_bf16 v[176:191], v[16:19], v[20:23], v[176:191]
    s_branch pg7_s
.p2align 12
pg7_h:
    s_endpgm
pg7_l:
    s_branch pg8_l
    s_nop 0
pg7_s:
    ds_read_b64 v[48:49], v5 offset:36736
    ds_read_b64 v[50:51], v5 offset:36744
    ds_read_b128 v[52:55], v6 offset:32416
    s_waitcnt vmcnt(11)
    v_xor_b32 v1, s59, v112
    v_xor_b32 v109, s59, v114
    buffer_load_dwordx4 a[72:75], v3, s[40:43], s34 offen offset:2048 sc1
    v_mfma_f32_32x32x16_bf16 v[192:207], v[16:19], v[24:27], v[192:207]
    ds_read_b128 v[56:59], v6 offset:34976
    ds_read_b64 v[60:61], v5 offset:34688
    ds_read_b64 v[62:63], v5 offset:34696
    v_or_b32 v2, v1, v109
    v_xor_b32 v1, s59, v116
    buffer_load_dwordx4 a[76:79], v3, s[40:43], s34 offen offset:3072 sc1
    v_mfma_f32_32x32x16_bf16 v[192:207], v[28:31], v[20:23], v[192:207]
    v_xor_b32_e64 v109, s59, v118
    v_or3_b32 v2, v2, v1, v109
    v_xor_b32 v1, s59, v120
    v_xor_b32 v109, s59, v122
    v_or3_b32 v2, v2, v1, v109
    s_xor_b32 s34, s98, 4096
    s_add_u32 s34, s34, s23
    buffer_load_dwordx4 a[16:19], v3, s[40:43], s34 offen offset:0 sc1
    s_waitcnt lgkmcnt(6)
    v_mfma_f32_32x32x16_bf16 v[176:191], v[32:35], v[36:39], v[176:191]
    ds_read_b64 v[16:17], v5 offset:36768
    ds_read_b64 v[18:19], v5 offset:36776
    ds_read_b128 v[20:23], v6 offset:32448
    v_xor_b32 v1, s59, v124
    v_xor_b32 v109, s59, v126
    buffer_load_dwordx4 a[20:23], v3, s[40:43], s34 offen offset:1024 sc1
    v_mfma_f32_32x32x16_bf16 v[192:207], v[32:35], v[40:43], v[192:207]
    ds_read_b128 v[24:27], v6 offset:35008
    ds_read_b64 v[28:29], v5 offset:34720
    ds_read_b64 v[30:31], v5 offset:34728
    v_or3_b32 v2, v2, v1, v109
    v_xor_b32_e64 v1, s59, v128
    buffer_load_dwordx4 a[24:27], v3, s[40:43], s34 offen offset:2048 sc1
    v_mfma_f32_32x32x16_bf16 v[192:207], v[44:47], v[36:39], v[192:207]
    v_xor_b32 v109, s59, v130
    v_or3_b32 v2, v2, v1, v109
    v_xor_b32 v1, s59, v132
    v_xor_b32 v109, s59, v134
    v_or3_b32 v2, v2, v1, v109
    buffer_load_dwordx4 a[28:31], v3, s[40:43], s34 offen offset:3072 sc1
    s_waitcnt lgkmcnt(6)
    v_mfma_f32_32x32x16_bf16 v[176:191], v[48:51], v[52:55], v[176:191]
    ds_read_b64 v[32:33], v5 offset:36672
    ds_read_b64 v[34:35], v5 offset:36680
    ds_read_b128 v[36:39], v6 offset:32336
    v_xor_b32_e64 v1, s59, v136
    v_xor_b32 v109, s59, v138
    s_xor_b32 s34, s100, 8192
    s_add_u32 s34, s34, s23
    s_add_u32 s34, s34, 24576
    buffer_load_dwordx4 a[128:131], v3, s[40:43], s34 offen offset:0 sc1
    v_mfma_f32_32x32x16_bf16 v[192:207], v[48:51], v[56:59], v[192:207]
    ds_read_b128 v[40:43], v6 offset:34896
    ds_read_b64 v[44:45], v5 offset:34624
    ds_read_b64 v[46:47], v5 offset:34632
    v_or3_b32 v2, v2, v1, v109
    v_xor_b32_e64 v1, s59, v140
    buffer_load_dwordx4 a[132:135], v3, s[40:43], s34 offen offset:1024 sc1
    v_mfma_f32_32x32x16_bf16 v[192:207], v[60:63], v[52:55], v[192:207]
    v_xor_b32 v109, s59, v142
    v_or3_b32 v2, v2, v1, v109
    v_xor_b32 v1, s59, v144
    v_xor_b32 v109, s59, v146
    v_or3_b32 v2, v2, v1, v109
    buffer_load_dwordx4 a[136:139], v3, s[40:43], s34 offen offset:2048 sc1
    s_waitcnt lgkmcnt(6)
    v_mfma_f32_32x32x16_bf16 v[176:191], v[16:19], v[20:23], v[176:191]
    ds_read_b64 v[48:49], v5 offset:36704
    ds_read_b64 v[50:51], v5 offset:36712
    ds_read_b128 v[52:55], v6 offset:32368
    v_xor_b32 v1, s59, v148
    v_xor_b32 v109, s59, v150
    buffer_load_dwordx4 a[140:143], v3, s[40:43], s34 offen offset:3072 sc1
    v_mfma_f32_32x32x16_bf16 v[192:207], v[16:19], v[24:27], v[192:207]
    ds_read_b128 v[56:59], v6 offset:34928
    ds_read_b64 v[60:61], v5 offset:34656
    ds_read_b64 v[62:63], v5 offset:34664
    v_or3_b32 v2, v2, v1, v109
    v_xor_b32 v1, s59, v152
    s_xor_b32 s34, s100, 12288
    s_add_u32 s34, s34, s23
    s_add_u32 s34, s34, 24576
    buffer_load_dwordx4 a[144:147], v3, s[40:43], s34 offen offset:0 sc1
    v_mfma_f32_32x32x16_bf16 v[192:207], v[28:31], v[20:23], v[192:207]
    v_xor_b32 v109, s59, v154
    v_or3_b32 v2, v2, v1, v109
    v_xor_b32 v1, s59, v156
    v_xor_b32 v109, s59, v158
    v_or3_b32 v2, v2, v1, v109
    buffer_load_dwordx4 a[148:151], v3, s[40:43], s34 offen offset:1024 sc1
    s_mov_b32 s7, 2228224
    buffer_load_dword v252, v4, s[16:19], s7 offen sc1
    s_waitcnt lgkmcnt(6)
    v_mfma_f32_32x32x16_bf16 v[176:191], v[32:35], v[36:39], v[176:191]
    ds_read_b64 v[16:17], v5 offset:36608
    ds_read_b64 v[18:19], v5 offset:36616
    ds_read_b128 v[20:23], v6 offset:32256
    buffer_load_dwordx4 a[152:155], v3, s[40:43], s34 offen offset:2048 sc1
    v_cmp_ne_u32 vcc, 0, v2
    s_cbranch_vccnz kf_rt
kf_rt_ret:
    v_mfma_f32_32x32x16_bf16 v[192:207], v[32:35], v[40:43], v[192:207]
    ds_read_b128 v[24:27], v6 offset:34816
    ds_read_b64 v[28:29], v5 offset:34560
    ds_read_b64 v[30:31], v5 offset:34568
    buffer_load_dwordx4 a[156:159], v3, s[40:43], s34 offen offset:3072 sc1
    v_add_f32 v113, v113, v117
    v_mfma_f32_32x32x16_bf16 v[192:207], v[44:47], v[36:39], v[192:207]
    v_add_f32 v113, v113, v121
    v_add_f32 v113, v113, v125
    v_add_f32 v115, v115, v119
    v_add_f32 v115, v115, v123
    s_mov_b32 s42, s58
    s_xor_b32 s34, s98, 8192
    s_add_u32 s34, s34, s23
    buffer_load_dwordx4 a[32:35], v3, s[40:43], s34 offen offset:0 sc1
    s_waitcnt lgkmcnt(6)
    v_mfma_f32_32x32x16_bf16 v[176:191], v[48:51], v[52:55], v[176:191]
    ds_read_b64 v[32:33], v5 offset:36640
    ds_read_b64 v[34:35], v5 offset:36648
    ds_read_b128 v[36:39], v6 offset:32288
    v_add_f32 v115, v115, v127
    v_add_f32 v129, v129, v133
    buffer_load_dwordx4 a[36:39], v3, s[40:43], s34 offen offset:1024 sc1
    v_mfma_f32_32x32x16_bf16 v[192:207], v[48:51], v[56:59], v[192:207]
    ds_read_b128 v[40:43], v6 offset:34848
    ds_read_b64 v[44:45], v5 offset:34592
    ds_read_b64 v[46:47], v5 offset:34600
    v_add_f32 v129, v129, v137
    v_add_f32 v129, v129, v141
    buffer_load_dwordx4 a[40:43], v3, s[40:43], s34 offen offset:2048 sc1
    v_mfma_f32_32x32x16_bf16 v[192:207], v[60:63], v[52:55], v[192:207]
    v_add_f32 v131, v131, v135
    v_add_f32 v131, v131, v139
    v_add_f32 v131, v131, v143
    v_add_f32 v145, v145, v149
    v_add_f32 v145, v145, v153
    buffer_load_dwordx4 a[44:47], v3, s[40:43], s34 offen offset:3072 sc1
    s_waitcnt lgkmcnt(6)
    v_mfma_f32_32x32x16_bf16 v[176:191], v[16:19], v[20:23], v[176:191]
    v_add_f32 v145, v145, v157
    v_add_f32 v147, v147, v151
    v_add_f32_e64 v147, v147, v155
    v_add_f32 v147, v147, v159
    v_cvt_pk_bf16_f32 v129, 0, v129
    s_xor_b32 s34, s99, 20480
    s_add_u32 s34, s34, s23
    buffer_load_dwordx4 a[80:83], v3, s[40:43], s34 offen offset:0 sc1
    v_mfma_f32_32x32x16_bf16 v[192:207], v[16:19], v[24:27], v[192:207]
    v_cvt_pk_bf16_f32 v131, 0, v131
    v_add_f32 v129, 1.0, v129
    v_add_f32 v131, 1.0, v131
    v_mov_b32_e64 v116, s59
    v_cvt_pk_bf16_f32 v117, v145, v147
    buffer_load_dwordx4 a[84:87], v3, s[40:43], s34 offen offset:1024 sc1
    v_mfma_f32_32x32x16_bf16 v[192:207], v[28:31], v[20:23], v[192:207]
    v_cvt_pk_bf16_f32 v120, v129, v131
    v_cvt_pk_bf16_f32 v121, v113, v115
    v_lshlrev_b32_e64 v118, 16, v120
    v_and_b32 v119, 0xffff0000, v120
    v_add_f32 v118, 0x2b800000, v118
    buffer_load_dwordx4 a[88:91], v3, s[40:43], s34 offen offset:2048 sc1
    s_waitcnt lgkmcnt(0)
    v_mfma_f32_32x32x16_bf16 v[176:191], v[32:35], v[36:39], v[176:191]
    v_add_f32 v119, 0x2b800000, v119
    v_rcp_f32 v118, v118
    v_rcp_f32_e64 v119, v119
    ds_write2st64_b32 v111, v120, v121 offset0:8 offset1:12
    s_cmp_eq_u32 s2, 31
    s_cselect_b32 s3, 0, 0x40000000
    buffer_load_dwordx4 a[92:95], v3, s[40:43], s34 offen offset:3072 sc1
    v_or_b32 v110, s3, v4
    s_mov_b32 s3, 2211840
    buffer_store_dwordx4 v[116:119], v110, s[16:19], s3 offen sc1
    v_mfma_f32_32x32x16_bf16 v[192:207], v[32:35], v[40:43], v[192:207]
    ds_write2st64_b32 v111, v118, v119 offset0:0 offset1:4
    v_mfma_f32_32x32x16_bf16 v[192:207], v[44:47], v[36:39], v[192:207]
    s_xor_b32 s34, s98, 12288
    s_add_u32 s34, s34, s23
    buffer_load_dwordx4 a[48:51], v3, s[40:43], s34 offen offset:0 sc1
    s_add_u32 m0, s25, 62400
    s_load_dwordx2 s[36:37], s[0:1], 120
    ds_write_addtid_b32 v176 offset:35904
    ds_write_addtid_b32 v177 offset:36160
    ds_write_addtid_b32 v178 offset:52352
    ds_write_addtid_b32 v179 offset:52608
    ds_write_addtid_b32 v180 offset:36416
    ds_write_addtid_b32 v181 offset:36672
    ds_write_addtid_b32 v182 offset:52864
    ds_write_addtid_b32 v183 offset:53120
    ds_write_addtid_b32 v184 offset:44128
    ds_write_addtid_b32 v185 offset:44384
    ds_write_addtid_b32 v186 offset:60576
    ds_write_addtid_b32 v187 offset:60832
    ds_write_addtid_b32 v188 offset:44640
    ds_write_addtid_b32 v189 offset:44896
    ds_write_addtid_b32 v190 offset:61088
    ds_write_addtid_b32 v191 offset:61344
    ds_write_addtid_b32 v192 offset:40000
    ds_write_addtid_b32 v193 offset:40256
    ds_write_addtid_b32 v194 offset:56448
    ds_write_addtid_b32 v195 offset:56704
    ds_write_addtid_b32 v196 offset:40512
    ds_write_addtid_b32 v197 offset:40768
    ds_write_addtid_b32 v198 offset:56960
    ds_write_addtid_b32 v199 offset:57216
    ds_write_addtid_b32 v200 offset:48224
    ds_write_addtid_b32 v201 offset:48480
    ds_write_addtid_b32 v202 offset:64672
    ds_write_addtid_b32 v203 offset:64928
    ds_write_addtid_b32 v204 offset:48736
    ds_write_addtid_b32 v205 offset:48992
    ds_write_addtid_b32 v206 offset:65184
    ds_write_addtid_b32 v207 offset:65440
    buffer_load_dwordx4 a[52:55], v3, s[40:43], s34 offen offset:1024 sc1
    buffer_load_dwordx4 a[56:59], v3, s[40:43], s34 offen offset:2048 sc1
    buffer_load_dwordx4 a[60:63], v3, s[40:43], s34 offen offset:3072 sc1
    s_waitcnt vmcnt(15)
    v_cmp_ne_u32_e64 vcc, s59, v252
    s_cbranch_vccnz kf_rf_l
kf_rf_l_ret:
    s_cmp_ge_u32 s2, 32
    s_cbranch_scc1 kf_tail0
    s_waitcnt lgkmcnt(0)
    s_barrier
    ds_read_b128 v[176:179], v12 offset:0
    ds_read_b128 v[180:183], v12 offset:256
    ds_read_b128 v[184:187], v12 offset:1024
    ds_read_b128 v[188:191], v12 offset:1280
    ds_read_b128 v[192:195], v12 offset:2048
    ds_read_b128 v[196:199], v12 offset:2304
    ds_read_b128 v[200:203], v12 offset:3072
    ds_read_b128 v[204:207], v12 offset:3328
    s_waitcnt lgkmcnt(4)
    v_pk_add_f32 v[176:177], v[176:177], v[184:185]
    v_pk_add_f32 v[178:179], v[178:179], v[186:187]
    v_pk_add_f32 v[180:181], v[180:181], v[188:189]
    v_pk_add_f32 v[182:183], v[182:183], v[190:191]
    s_waitcnt lgkmcnt(0)
    v_pk_add_f32 v[192:193], v[192:193], v[200:201]
    v_pk_add_f32 v[194:195], v[194:195], v[202:203]
    v_pk_add_f32 v[196:197], v[196:197], v[204:205]
    v_pk_add_f32 v[198:199], v[198:199], v[206:207]
    v_pk_add_f32 v[176:177], v[176:177], v[192:193]
    v_pk_add_f32 v[178:179], v[178:179], v[194:195]
    v_pk_add_f32 v[180:181], v[180:181], v[196:197]
    v_pk_add_f32 v[182:183], v[182:183], v[198:199]
    v_pk_fma_f32 v[176:177], v[176:177], s[52:53], v[216:217] op_sel:[0,1,0] op_sel_hi:[1,1,1]
    v_pk_fma_f32 v[178:179], v[178:179], s[52:53], v[218:219] op_sel:[0,1,0] op_sel_hi:[1,1,1]
    v_pk_fma_f32 v[180:181], v[180:181], s[52:53], v[220:221] op_sel:[0,1,0] op_sel_hi:[1,1,1]
    v_pk_fma_f32 v[182:183], v[182:183], s[52:53], v[222:223] op_sel:[0,1,0] op_sel_hi:[1,1,1]
    v_pk_mul_f32 v[192:193], v[176:177], s[54:55] op_sel:[0,1] op_sel_hi:[1,1]
    v_pk_mul_f32 v[194:195], v[178:179], s[54:55] op_sel:[0,1] op_sel_hi:[1,1]
    v_pk_mul_f32 v[196:197], v[180:181], s[54:55] op_sel:[0,1] op_sel_hi:[1,1]
    v_pk_mul_f32 v[198:199], v[182:183], s[54:55] op_sel:[0,1] op_sel_hi:[1,1]
    v_cvt_pk_bf16_f32 v188, v192, v193
    v_cvt_pk_bf16_f32 v189, v194, v195
    v_cvt_pk_bf16_f32 v190, v196, v197
    v_cvt_pk_bf16_f32 v191, v198, v199
    buffer_store_dwordx4 v[188:191], v14, s[16:19], s29 offen sc1
    s_branch kf_help
    s_nop 0
pg8_l:
    s_branch wl_ret
pg8_s:
kf_help:
    s_lshl_b32 s24, s22, 11
    s_lshr_b32 s6, s99, 2
    s_add_u32 s24, s24, s6
    s_add_u32 s24, s24, 3014656
    v_bfe_u32 v1, v0, 2, 1
    v_bfe_u32 v2, v0, 4, 1
    v_cmp_eq_u32 vcc, v1, v2
    v_bfe_u32 v1, v0, 3, 1
    v_bfe_u32 v2, v0, 5, 1
    v_lshlrev_b32 v1, 10, v1
    v_lshl_add_u32 v1, v2, 4, v1
    v_mov_b32 v2, 3072
    v_cndmask_b32_e64 v1, v2, v1, vcc
    v_add_u32 v110, 159744, v1
    s_lshr_b32 s6, s98, 6
    v_add_u32 v107, s6, v110
    s_lshr_b32 s6, s99, 6
    v_add_u32 v108, s6, v110
    s_lshr_b32 s6, s100, 6
    v_add_u32 v109, s6, v110
    ds_read_b128 v[112:115], v107 offset:0
    ds_read_b128 v[116:119], v107 offset:32
    ds_read_b128 v[120:123], v109 offset:384
    ds_read_b128 v[124:127], v109 offset:416
    ds_read_b128 v[128:131], v109 offset:448
    ds_read_b128 v[132:135], v109 offset:480
    ds_read_b128 v[136:139], v108 offset:256
    ds_read_b128 v[140:143], v108 offset:288
    ds_read_b128 v[144:147], v107 offset:64
    ds_read_b128 v[148:151], v107 offset:96
    ds_read_b128 v[152:155], v109 offset:512
    ds_read_b128 v[156:159], v109 offset:544
    ds_read_b128 v[160:163], v109 offset:576
    ds_read_b128 v[164:167], v109 offset:608
    v_and_b32 v5, 7, v0
    v_and_b32 v6, 16, v0
    v_lshlrev_b32 v6, 2, v6
    v_xor_b32 v4, v4, v6
    s_and_b32 s6, s2, 6
    s_lshl_b32 s6, s6, 2
    s_lshr_b32 s7, s2, 3
    s_lshl_b32 s7, s7, 1
    s_add_u32 s6, s6, s7
    s_and_b32 s7, s2, 1
    s_add_u32 s3, s6, s7
    s_lshl_b32 s21, s3, 16
    s_lshr_b32 s6, s20, 1
    s_lshl_b32 s6, s6, 13
    s_xor_b32 s6, s6, s93
    s_add_u32 s21, s21, s6
    v_and_b32 v4, 0x7ff, v4
    s_add_u32 s21, s21, 8388608
    v_bfe_u32 v6, v0, 3, 1
    v_lshrrev_b32_e64 v7, 4, v0
    v_lshl_add_u32 v6, v6, 8, v7
    v_mov_b32 v7, 157696
    v_lshl_add_u32 v6, v6, 2, v7
    ds_read2_b32 v[10:11], v6 offset0:0 offset1:16
    ds_read2_b32 v[12:13], v6 offset0:32 offset1:48
    ds_read2_b32 v[14:15], v6 offset0:64 offset1:80
    ds_read2_b32 v[16:17], v6 offset0:96 offset1:112
    ds_read2_b32 v[18:19], v6 offset0:128 offset1:144
    ds_read2_b32 v[20:21], v6 offset0:160 offset1:176
    ds_read2_b32 v[22:23], v6 offset0:192 offset1:208
    s_bfe_u32 s6, s3, 0x30001
    s_lshr_b32 s7, s3, 4
    s_xor_b32 s7, s7, s6
    s_and_b32 s7, s7, 1
    s_lshl_b32 s7, s7, 13
    s_xor_b32 s7, s7, s93
    s_lshl_b32 s6, s6, 21
    s_add_u32 s7, s7, s6
    s_and_b32 s9, s3, 1
    s_mul_i32 s6, s9, 114688
    s_add_u32 s7, s7, s6
    s_lshl_b32 s6, s20, 11
    s_add_u32 s26, s7, s6
    s_lshr_b32 s6, s3, 1
    s_lshl4_add_u32 s6, s6, s9
    s_lshl2_add_u32 s6, s6, s20
    s_lshl_b32 s27, s6, 7
    s_add_u32 s27, s27, 2300928
    v_mov_b32 v168, -1
    v_mov_b32 v169, -1
    v_mov_b32 v170, -1
    v_mov_b32 v171, -1
    v_mov_b32 v172, s59
    v_mov_b32 v173, 0
    v_mov_b32 v174, 0
    v_mov_b32 v175, 0
    s_lshl_b32 s22, s3, 9
    s_add_u32 s22, s22, 2195456
    v_bfe_u32 v6, v0, 4, 1
    v_lshlrev_b32 v6, 4, v6
    v_lshl_add_u32 v6, v5, 5, v6
    v_lshrrev_b32 v7, 5, v0
    v_lshl_add_u32 v6, v7, 8, v6
    v_lshrrev_b32_e64 v7, 2, v3
    v_lshrrev_b32 v8, 1, v3
    s_add_u32 s8, s21, 0
    buffer_load_dwordx4 v[64:67], v4, s[16:19], s8 offen sc1
    s_add_u32 s8, s21, 2048
    buffer_load_dwordx4 v[68:71], v4, s[16:19], s8 offen sc1
    s_add_u32 s8, s21, 4096
    buffer_load_dwordx4 v[72:75], v4, s[16:19], s8 offen sc1
    s_add_u32 s8, s21, 6144
    buffer_load_dwordx4 v[76:79], v4, s[16:19], s8 offen sc1
    s_add_u32 s8, s21, 16384
    buffer_load_dwordx4 v[80:83], v4, s[16:19], s8 offen sc1
    s_add_u32 s8, s21, 18432
    buffer_load_dwordx4 v[84:87], v4, s[16:19], s8 offen sc1
    s_cmp_ge_u32 s2, 28
    s_cbranch_scc1 kf_hnosb
    s_nop 0
    s_waitcnt vmcnt(7) lgkmcnt(0)
    v_mfma_f32_16x16x32_bf16 v[56:59], v[112:115], a[0:3], 0
    v_mfma_f32_16x16x32_bf16 v[60:63], v[112:115], a[4:7], 0
    v_mfma_f32_16x16x32_bf16 v[56:59], v[116:119], a[8:11], v[56:59]
    v_mfma_f32_16x16x32_bf16 v[60:63], v[116:119], a[12:15], v[60:63]
    v_mfma_f32_16x16x32_bf16 v[56:59], v[120:123], a[96:99], v[56:59]
    v_mfma_f32_16x16x32_bf16 v[60:63], v[120:123], a[100:103], v[60:63]
    v_mfma_f32_16x16x32_bf16 v[56:59], v[124:127], a[104:107], v[56:59]
    v_mfma_f32_16x16x32_bf16 v[60:63], v[124:127], a[108:111], v[60:63]
    v_mfma_f32_16x16x32_bf16 v[56:59], v[128:131], a[112:115], v[56:59]
    v_mfma_f32_16x16x32_bf16 v[60:63], v[128:131], a[116:119], v[60:63]
    v_mfma_f32_16x16x32_bf16 v[56:59], v[132:135], a[120:123], v[56:59]
    v_mfma_f32_16x16x32_bf16 v[60:63], v[132:135], a[124:127], v[60:63]
    v_mfma_f32_16x16x32_bf16 v[56:59], v[136:139], a[64:67], v[56:59]
    v_mfma_f32_16x16x32_bf16 v[60:63], v[136:139], a[68:71], v[60:63]
    v_mfma_f32_16x16x32_bf16 v[56:59], v[140:143], a[72:75], v[56:59]
    v_mfma_f32_16x16x32_bf16 v[60:63], v[140:143], a[76:79], v[60:63]
    v_mfma_f32_16x16x32_bf16 v[56:59], v[144:147], a[16:19], v[56:59]
    v_mfma_f32_16x16x32_bf16 v[60:63], v[144:147], a[20:23], v[60:63]
    v_mfma_f32_16x16x32_bf16 v[56:59], v[148:151], a[24:27], v[56:59]
    v_mfma_f32_16x16x32_bf16 v[60:63], v[148:151], a[28:31], v[60:63]
    v_mfma_f32_16x16x32_bf16 v[56:59], v[152:155], a[128:131], v[56:59]
    v_mfma_f32_16x16x32_bf16 v[60:63], v[152:155], a[132:135], v[60:63]
    v_mfma_f32_16x16x32_bf16 v[56:59], v[156:159], a[136:139], v[56:59]
    v_mfma_f32_16x16x32_bf16 v[60:63], v[156:159], a[140:143], v[60:63]
    v_mfma_f32_16x16x32_bf16 v[56:59], v[160:163], a[144:147], v[56:59]
    v_mfma_f32_16x16x32_bf16 v[60:63], v[160:163], a[148:151], v[60:63]
    v_mfma_f32_16x16x32_bf16 v[56:59], v[164:167], a[152:155], v[56:59]
    v_mfma_f32_16x16x32_bf16 v[60:63], v[164:167], a[156:159], v[60:63]
    s_nop 6
    v_cvt_pk_bf16_f32 v57, 0, v56
    v_cvt_pk_bf16_f32 v61, 0, v60
    v_sub_f32 v56, v56, v57
    v_sub_f32 v60, v60, v61
    v_mov_b32 v48, s59
    v_cvt_pk_bf16_f32 v49, v57, v56
    v_cvt_pk_bf16_f32 v50, v61, v60
    v_mov_b32_e64 v51, 0
    buffer_store_dwordx4 v[48:51], v3, s[16:19], s24 offen sc1
kf_hnosb:
    s_add_u32 s8, s21, 20480
    buffer_load_dwordx4 v[88:91], v4, s[16:19], s8 offen sc1
    s_add_u32 s8, s21, 22528
    buffer_load_dwordx4 v[92:95], v4, s[16:19], s8 offen sc1
    s_add_u32 s8, s21, 32768
    buffer_load_dwordx4 v[96:99], v4, s[16:19], s8 offen sc1
    s_add_u32 s8, s21, 34816
    buffer_load_dwordx4 v[100:103], v4, s[16:19], s8 offen sc1
    s_add_u32 s8, s21, 36864
    buffer_load_dwordx4 v[104:107], v4, s[16:19], s8 offen sc1
    s_add_u32 s8, s21, 38912
    buffer_load_dwordx4 v[108:111], v4, s[16:19], s8 offen sc1
    s_waitcnt lgkmcnt(0)
    s_waitcnt vmcnt(11)
    v_cmp_eq_u32 vcc, -1, v64
    s_cbranch_vccnz kf_hr0
kf_hr0_ret:
    s_add_u32 s8, s21, 49152
    buffer_load_dwordx4 v[112:115], v4, s[16:19], s8 offen sc1
    s_add_u32 s8, s21, 51200
    buffer_load_dwordx4 v[116:119], v4, s[16:19], s8 offen sc1
    v_lshlrev_b32 v40, 16, v64
    v_and_b32 v41, 0xffff0000, v64
    v_lshlrev_b32 v42, 16, v65
    v_and_b32 v43, 0xffff0000, v65
    v_lshlrev_b32 v44, 16, v66
    v_and_b32 v45, 0xffff0000, v66
    v_lshlrev_b32 v46, 16, v67
    v_and_b32 v47, 0xffff0000, v67
    v_pk_mul_f32 v[24:25], v[40:41], v[10:11] op_sel:[0,0] op_sel_hi:[1,0]
    v_pk_mul_f32 v[26:27], v[42:43], v[10:11] op_sel:[0,0] op_sel_hi:[1,0]
    v_pk_mul_f32 v[28:29], v[44:45], v[10:11] op_sel:[0,0] op_sel_hi:[1,0]
    v_pk_mul_f32 v[30:31], v[46:47], v[10:11] op_sel:[0,0] op_sel_hi:[1,0]
    v_pk_mul_f32 v[32:33], v[24:25], v[24:25]
    v_pk_mul_f32 v[34:35], v[26:27], v[26:27]
    v_pk_mul_f32 v[36:37], v[28:29], v[28:29]
    v_pk_mul_f32 v[38:39], v[30:31], v[30:31]
    s_waitcnt vmcnt(12)
    v_cmp_eq_u32 vcc, -1, v68
    s_cbranch_vccnz kf_hr1
kf_hr1_ret:
    v_lshlrev_b32 v48, 16, v68
    v_and_b32 v49, 0xffff0000, v68
    v_lshlrev_b32 v50, 16, v69
    v_and_b32 v51, 0xffff0000, v69
    v_lshlrev_b32 v52, 16, v70
    v_and_b32 v53, 0xffff0000, v70
    v_lshlrev_b32_e64 v54, 16, v71
    v_and_b32 v55, 0xffff0000, v71
    v_pk_mul_f32 v[48:49], v[48:49], v[10:11] op_sel:[0,1] op_sel_hi:[1,1]
    v_pk_mul_f32 v[50:51], v[50:51], v[10:11] op_sel:[0,1] op_sel_hi:[1,1]
    v_pk_mul_f32 v[52:53], v[52:53], v[10:11] op_sel:[0,1] op_sel_hi:[1,1]
    v_pk_mul_f32 v[54:55], v[54:55], v[10:11] op_sel:[0,1] op_sel_hi:[1,1]
    v_pk_add_f32 v[24:25], v[24:25], v[48:49]
    v_pk_fma_f32 v[32:33], v[48:49], v[48:49], v[32:33]
    v_pk_add_f32 v[26:27], v[26:27], v[50:51]
    v_pk_fma_f32 v[34:35], v[50:51], v[50:51], v[34:35]
    v_pk_add_f32 v[28:29], v[28:29], v[52:53]
    v_pk_fma_f32 v[36:37], v[52:53], v[52:53], v[36:37]
    v_pk_add_f32 v[30:31], v[30:31], v[54:55]
    v_pk_fma_f32 v[38:39], v[54:55], v[54:55], v[38:39]
    s_waitcnt vmcnt(11)
    v_cmp_eq_u32 vcc, -1, v72
    s_cbranch_vccnz kf_hr2
kf_hr2_ret:
    s_add_u32 s28, s26, 13041664
    buffer_store_dwordx4 v[168:171], v3, s[16:19], s28 offen offset:0 sc1
    v_lshlrev_b32 v40, 16, v72
    v_and_b32 v41, 0xffff0000, v72
    v_lshlrev_b32 v42, 16, v73
    v_and_b32 v43, 0xffff0000, v73
    v_lshlrev_b32 v44, 16, v74
    v_and_b32 v45, 0xffff0000, v74
    v_lshlrev_b32_e64 v46, 16, v75
    v_and_b32 v47, 0xffff0000, v75
    v_pk_mul_f32 v[40:41], v[40:41], v[12:13] op_sel:[0,0] op_sel_hi:[1,0]
    v_pk_mul_f32 v[42:43], v[42:43], v[12:13] op_sel:[0,0] op_sel_hi:[1,0]
    v_pk_mul_f32 v[44:45], v[44:45], v[12:13] op_sel:[0,0] op_sel_hi:[1,0]
    v_pk_mul_f32 v[46:47], v[46:47], v[12:13] op_sel:[0,0] op_sel_hi:[1,0]
    v_pk_add_f32 v[24:25], v[24:25], v[40:41]
    v_pk_fma_f32 v[32:33], v[40:41], v[40:41], v[32:33]
    v_pk_add_f32 v[26:27], v[26:27], v[42:43]
    v_pk_fma_f32 v[34:35], v[42:43], v[42:43], v[34:35]
    v_pk_add_f32 v[28:29], v[28:29], v[44:45]
    v_pk_fma_f32 v[36:37], v[44:45], v[44:45], v[36:37]
    v_pk_add_f32 v[30:31], v[30:31], v[46:47]
    v_pk_fma_f32 v[38:39], v[46:47], v[46:47], v[38:39]
    s_waitcnt vmcnt(11)
    v_cmp_eq_u32 vcc, -1, v76
    s_cbranch_vccnz kf_hr3
kf_hr3_ret:
    buffer_store_dwordx4 v[168:171], v3, s[16:19], s28 offen offset:1024 sc1
    v_lshlrev_b32 v48, 16, v76
    v_and_b32 v49, 0xffff0000, v76
    v_lshlrev_b32 v50, 16, v77
    v_and_b32 v51, 0xffff0000, v77
    v_lshlrev_b32 v52, 16, v78
    v_and_b32 v53, 0xffff0000, v78
    v_lshlrev_b32_e64 v54, 16, v79
    v_and_b32 v55, 0xffff0000, v79
    v_pk_mul_f32 v[48:49], v[48:49], v[12:13] op_sel:[0,1] op_sel_hi:[1,1]
    v_pk_mul_f32 v[50:51], v[50:51], v[12:13] op_sel:[0,1] op_sel_hi:[1,1]
    v_pk_mul_f32 v[52:53], v[52:53], v[12:13] op_sel:[0,1] op_sel_hi:[1,1]
    v_pk_mul_f32 v[54:55], v[54:55], v[12:13] op_sel:[0,1] op_sel_hi:[1,1]
    v_pk_add_f32 v[24:25], v[24:25], v[48:49]
    v_pk_fma_f32 v[32:33], v[48:49], v[48:49], v[32:33]
    v_pk_add_f32 v[26:27], v[26:27], v[50:51]
    v_pk_fma_f32 v[34:35], v[50:51], v[50:51], v[34:35]
    v_pk_add_f32 v[28:29], v[28:29], v[52:53]
    v_pk_fma_f32 v[36:37], v[52:53], v[52:53], v[36:37]
    v_pk_add_f32 v[30:31], v[30:31], v[54:55]
    v_pk_fma_f32 v[38:39], v[54:55], v[54:55], v[38:39]
    s_waitcnt vmcnt(11)
    v_cmp_eq_u32 vcc, -1, v80
    s_cbranch_vccnz kf_hr4
kf_hr4_ret:
    s_add_u32 s28, s26, 13058048
    buffer_store_dwordx4 v[168:171], v3, s[16:19], s28 offen offset:0 sc1
    v_lshlrev_b32 v40, 16, v80
    v_and_b32 v41, 0xffff0000, v80
    v_lshlrev_b32 v42, 16, v81
    v_and_b32 v43, 0xffff0000, v81
    v_lshlrev_b32 v44, 16, v82
    v_and_b32 v45, 0xffff0000, v82
    v_lshlrev_b32_e64 v46, 16, v83
    v_and_b32 v47, 0xffff0000, v83
    v_pk_mul_f32 v[40:41], v[40:41], v[14:15] op_sel:[0,0] op_sel_hi:[1,0]
    v_pk_mul_f32 v[42:43], v[42:43], v[14:15] op_sel:[0,0] op_sel_hi:[1,0]
    v_pk_mul_f32 v[44:45], v[44:45], v[14:15] op_sel:[0,0] op_sel_hi:[1,0]
    v_pk_mul_f32 v[46:47], v[46:47], v[14:15] op_sel:[0,0] op_sel_hi:[1,0]
    v_pk_add_f32 v[24:25], v[24:25], v[40:41]
    v_pk_fma_f32 v[32:33], v[40:41], v[40:41], v[32:33]
    v_pk_add_f32 v[26:27], v[26:27], v[42:43]
    v_pk_fma_f32 v[34:35], v[42:43], v[42:43], v[34:35]
    v_pk_add_f32 v[28:29], v[28:29], v[44:45]
    v_pk_fma_f32 v[36:37], v[44:45], v[44:45], v[36:37]
    v_pk_add_f32 v[30:31], v[30:31], v[46:47]
    v_pk_fma_f32 v[38:39], v[46:47], v[46:47], v[38:39]
    s_waitcnt vmcnt(11)
    v_cmp_eq_u32 vcc, -1, v84
    s_cbranch_vccnz kf_hr5
kf_hr5_ret:
    buffer_store_dwordx4 v[168:171], v3, s[16:19], s28 offen offset:1024 sc1
    v_lshlrev_b32 v48, 16, v84
    v_and_b32 v49, 0xffff0000, v84
    v_lshlrev_b32 v50, 16, v85
    v_and_b32 v51, 0xffff0000, v85
    v_lshlrev_b32 v52, 16, v86
    v_and_b32 v53, 0xffff0000, v86
    v_lshlrev_b32_e64 v54, 16, v87
    v_and_b32 v55, 0xffff0000, v87
    v_pk_mul_f32 v[48:49], v[48:49], v[14:15] op_sel:[0,1] op_sel_hi:[1,1]
    v_pk_mul_f32 v[50:51], v[50:51], v[14:15] op_sel:[0,1] op_sel_hi:[1,1]
    v_pk_mul_f32 v[52:53], v[52:53], v[14:15] op_sel:[0,1] op_sel_hi:[1,1]
    v_pk_mul_f32 v[54:55], v[54:55], v[14:15] op_sel:[0,1] op_sel_hi:[1,1]
    v_pk_add_f32 v[24:25], v[24:25], v[48:49]
    v_pk_fma_f32 v[32:33], v[48:49], v[48:49], v[32:33]
    v_pk_add_f32 v[26:27], v[26:27], v[50:51]
    v_pk_fma_f32 v[34:35], v[50:51], v[50:51], v[34:35]
    v_pk_add_f32 v[28:29], v[28:29], v[52:53]
    v_pk_fma_f32 v[36:37], v[52:53], v[52:53], v[36:37]
    v_pk_add_f32 v[30:31], v[30:31], v[54:55]
    v_pk_fma_f32 v[38:39], v[54:55], v[54:55], v[38:39]
    s_waitcnt vmcnt(11)
    v_cmp_eq_u32 vcc, -1, v88
    s_cbranch_vccnz kf_hr6
kf_hr6_ret:
    s_add_u32 s28, s26, 13074432
    buffer_store_dwordx4 v[168:171], v3, s[16:19], s28 offen offset:0 sc1
    v_lshlrev_b32 v40, 16, v88
    v_and_b32 v41, 0xffff0000, v88
    v_lshlrev_b32 v42, 16, v89
    v_and_b32 v43, 0xffff0000, v89
    v_lshlrev_b32 v44, 16, v90
    v_and_b32 v45, 0xffff0000, v90
    v_lshlrev_b32_e64 v46, 16, v91
    v_and_b32 v47, 0xffff0000, v91
    v_pk_mul_f32 v[40:41], v[40:41], v[16:17] op_sel:[0,0] op_sel_hi:[1,0]
    v_pk_mul_f32 v[42:43], v[42:43], v[16:17] op_sel:[0,0] op_sel_hi:[1,0]
    v_pk_mul_f32 v[44:45], v[44:45], v[16:17] op_sel:[0,0] op_sel_hi:[1,0]
    v_pk_mul_f32 v[46:47], v[46:47], v[16:17] op_sel:[0,0] op_sel_hi:[1,0]
    v_pk_add_f32 v[24:25], v[24:25], v[40:41]
    v_pk_fma_f32 v[32:33], v[40:41], v[40:41], v[32:33]
    v_pk_add_f32 v[26:27], v[26:27], v[42:43]
    v_pk_fma_f32 v[34:35], v[42:43], v[42:43], v[34:35]
    v_pk_add_f32 v[28:29], v[28:29], v[44:45]
    v_pk_fma_f32 v[36:37], v[44:45], v[44:45], v[36:37]
    s_branch pg9_s
.p2align 12
pg9_h:
    s_endpgm
pg9_l:
    s_branch wl_ret
pg9_s:
    v_pk_add_f32 v[30:31], v[30:31], v[46:47]
    v_pk_fma_f32 v[38:39], v[46:47], v[46:47], v[38:39]
    s_waitcnt vmcnt(11)
    v_cmp_eq_u32 vcc, -1, v92
    s_cbranch_vccnz kf_hr7
kf_hr7_ret:
    buffer_store_dwordx4 v[168:171], v3, s[16:19], s28 offen offset:1024 sc1
    v_lshlrev_b32 v48, 16, v92
    v_and_b32 v49, 0xffff0000, v92
    v_lshlrev_b32 v50, 16, v93
    v_and_b32 v51, 0xffff0000, v93
    v_lshlrev_b32 v52, 16, v94
    v_and_b32 v53, 0xffff0000, v94
    v_lshlrev_b32_e64 v54, 16, v95
    v_and_b32 v55, 0xffff0000, v95
    v_pk_mul_f32 v[48:49], v[48:49], v[16:17] op_sel:[0,1] op_sel_hi:[1,1]
    v_pk_mul_f32 v[50:51], v[50:51], v[16:17] op_sel:[0,1] op_sel_hi:[1,1]
    v_pk_mul_f32 v[52:53], v[52:53], v[16:17] op_sel:[0,1] op_sel_hi:[1,1]
    v_pk_mul_f32 v[54:55], v[54:55], v[16:17] op_sel:[0,1] op_sel_hi:[1,1]
    v_pk_add_f32 v[24:25], v[24:25], v[48:49]
    v_pk_fma_f32 v[32:33], v[48:49], v[48:49], v[32:33]
    v_pk_add_f32 v[26:27], v[26:27], v[50:51]
    v_pk_fma_f32 v[34:35], v[50:51], v[50:51], v[34:35]
    v_pk_add_f32 v[28:29], v[28:29], v[52:53]
    v_pk_fma_f32 v[36:37], v[52:53], v[52:53], v[36:37]
    v_pk_add_f32 v[30:31], v[30:31], v[54:55]
    v_pk_fma_f32 v[38:39], v[54:55], v[54:55], v[38:39]
    s_waitcnt vmcnt(11)
    v_cmp_eq_u32 vcc, -1, v96
    s_cbranch_vccnz kf_hr8
kf_hr8_ret:
    s_add_u32 s28, s26, 13090816
    buffer_store_dwordx4 v[168:171], v3, s[16:19], s28 offen offset:0 sc1
    v_lshlrev_b32 v40, 16, v96
    v_and_b32 v41, 0xffff0000, v96
    v_lshlrev_b32 v42, 16, v97
    v_and_b32 v43, 0xffff0000, v97
    v_lshlrev_b32 v44, 16, v98
    v_and_b32 v45, 0xffff0000, v98
    v_lshlrev_b32_e64 v46, 16, v99
    v_and_b32 v47, 0xffff0000, v99
    v_pk_mul_f32 v[40:41], v[40:41], v[18:19] op_sel:[0,0] op_sel_hi:[1,0]
    v_pk_mul_f32 v[42:43], v[42:43], v[18:19] op_sel:[0,0] op_sel_hi:[1,0]
    v_pk_mul_f32 v[44:45], v[44:45], v[18:19] op_sel:[0,0] op_sel_hi:[1,0]
    v_pk_mul_f32 v[46:47], v[46:47], v[18:19] op_sel:[0,0] op_sel_hi:[1,0]
    v_pk_add_f32 v[24:25], v[24:25], v[40:41]
    v_pk_fma_f32 v[32:33], v[40:41], v[40:41], v[32:33]
    v_pk_add_f32 v[26:27], v[26:27], v[42:43]
    v_pk_fma_f32 v[34:35], v[42:43], v[42:43], v[34:35]
    v_pk_add_f32 v[28:29], v[28:29], v[44:45]
    v_pk_fma_f32 v[36:37], v[44:45], v[44:45], v[36:37]
    v_pk_add_f32 v[30:31], v[30:31], v[46:47]
    v_pk_fma_f32 v[38:39], v[46:47], v[46:47], v[38:39]
    s_waitcnt vmcnt(11)
    v_cmp_eq_u32 vcc, -1, v100
    s_cbranch_vccnz kf_hr9
kf_hr9_ret:
    buffer_store_dwordx4 v[168:171], v3, s[16:19], s28 offen offset:1024 sc1
    v_lshlrev_b32 v48, 16, v100
    v_and_b32 v49, 0xffff0000, v100
    v_lshlrev_b32 v50, 16, v101
    v_and_b32 v51, 0xffff0000, v101
    v_lshlrev_b32 v52, 16, v102
    v_and_b32 v53, 0xffff0000, v102
    v_lshlrev_b32_e64 v54, 16, v103
    v_and_b32 v55, 0xffff0000, v103
    v_pk_mul_f32 v[48:49], v[48:49], v[18:19] op_sel:[0,1] op_sel_hi:[1,1]
    v_pk_mul_f32 v[50:51], v[50:51], v[18:19] op_sel:[0,1] op_sel_hi:[1,1]
    v_pk_mul_f32 v[52:53], v[52:53], v[18:19] op_sel:[0,1] op_sel_hi:[1,1]
    v_pk_mul_f32 v[54:55], v[54:55], v[18:19] op_sel:[0,1] op_sel_hi:[1,1]
    v_pk_add_f32 v[24:25], v[24:25], v[48:49]
    v_pk_fma_f32 v[32:33], v[48:49], v[48:49], v[32:33]
    v_pk_add_f32 v[26:27], v[26:27], v[50:51]
    v_pk_fma_f32 v[34:35], v[50:51], v[50:51], v[34:35]
    v_pk_add_f32 v[28:29], v[28:29], v[52:53]
    v_pk_fma_f32 v[36:37], v[52:53], v[52:53], v[36:37]
    v_pk_add_f32 v[30:31], v[30:31], v[54:55]
    v_pk_fma_f32 v[38:39], v[54:55], v[54:55], v[38:39]
    s_waitcnt vmcnt(11)
    v_cmp_eq_u32 vcc, -1, v104
    s_cbranch_vccnz kf_hr10
kf_hr10_ret:
    v_lshlrev_b32 v40, 16, v104
    v_and_b32 v41, 0xffff0000, v104
    v_lshlrev_b32 v42, 16, v105
    v_and_b32 v43, 0xffff0000, v105
    v_lshlrev_b32 v44, 16, v106
    v_and_b32 v45, 0xffff0000, v106
    v_lshlrev_b32_e64 v46, 16, v107
    v_and_b32 v47, 0xffff0000, v107
    v_pk_mul_f32 v[40:41], v[40:41], v[20:21] op_sel:[0,0] op_sel_hi:[1,0]
    v_pk_mul_f32 v[42:43], v[42:43], v[20:21] op_sel:[0,0] op_sel_hi:[1,0]
    v_pk_mul_f32 v[44:45], v[44:45], v[20:21] op_sel:[0,0] op_sel_hi:[1,0]
    v_pk_mul_f32 v[46:47], v[46:47], v[20:21] op_sel:[0,0] op_sel_hi:[1,0]
    v_pk_add_f32 v[24:25], v[24:25], v[40:41]
    v_pk_fma_f32 v[32:33], v[40:41], v[40:41], v[32:33]
    v_pk_add_f32 v[26:27], v[26:27], v[42:43]
    v_pk_fma_f32 v[34:35], v[42:43], v[42:43], v[34:35]
    v_pk_add_f32 v[28:29], v[28:29], v[44:45]
    v_pk_fma_f32 v[36:37], v[44:45], v[44:45], v[36:37]
    v_pk_add_f32 v[30:31], v[30:31], v[46:47]
    v_pk_fma_f32 v[38:39], v[46:47], v[46:47], v[38:39]
    s_waitcnt vmcnt(10)
    v_cmp_eq_u32 vcc, -1, v108
    s_cbranch_vccnz kf_hr11
kf_hr11_ret:
    v_lshlrev_b32 v48, 16, v108
    v_and_b32 v49, 0xffff0000, v108
    v_lshlrev_b32 v50, 16, v109
    v_and_b32 v51, 0xffff0000, v109
    v_lshlrev_b32 v52, 16, v110
    v_and_b32 v53, 0xffff0000, v110
    v_lshlrev_b32_e64 v54, 16, v111
    v_and_b32 v55, 0xffff0000, v111
    v_pk_mul_f32 v[48:49], v[48:49], v[20:21] op_sel:[0,1] op_sel_hi:[1,1]
    v_pk_mul_f32 v[50:51], v[50:51], v[20:21] op_sel:[0,1] op_sel_hi:[1,1]
    v_pk_mul_f32 v[52:53], v[52:53], v[20:21] op_sel:[0,1] op_sel_hi:[1,1]
    v_pk_mul_f32 v[54:55], v[54:55], v[20:21] op_sel:[0,1] op_sel_hi:[1,1]
    v_pk_add_f32 v[24:25], v[24:25], v[48:49]
    v_pk_fma_f32 v[32:33], v[48:49], v[48:49], v[32:33]
    v_pk_add_f32 v[26:27], v[26:27], v[50:51]
    v_pk_fma_f32 v[34:35], v[50:51], v[50:51], v[34:35]
    v_pk_add_f32 v[28:29], v[28:29], v[52:53]
    v_pk_fma_f32 v[36:37], v[52:53], v[52:53], v[36:37]
    v_pk_add_f32 v[30:31], v[30:31], v[54:55]
    v_pk_fma_f32 v[38:39], v[54:55], v[54:55], v[38:39]
    s_waitcnt vmcnt(9)
    v_cmp_eq_u32 vcc, -1, v112
    s_cbranch_vccnz kf_hr12
kf_hr12_ret:
    v_lshlrev_b32 v40, 16, v112
    v_and_b32 v41, 0xffff0000, v112
    v_lshlrev_b32 v42, 16, v113
    v_and_b32 v43, 0xffff0000, v113
    v_lshlrev_b32 v44, 16, v114
    v_and_b32 v45, 0xffff0000, v114
    v_lshlrev_b32_e64 v46, 16, v115
    v_and_b32 v47, 0xffff0000, v115
    v_pk_mul_f32 v[40:41], v[40:41], v[22:23] op_sel:[0,0] op_sel_hi:[1,0]
    v_pk_mul_f32 v[42:43], v[42:43], v[22:23] op_sel:[0,0] op_sel_hi:[1,0]
    v_pk_mul_f32 v[44:45], v[44:45], v[22:23] op_sel:[0,0] op_sel_hi:[1,0]
    v_pk_mul_f32 v[46:47], v[46:47], v[22:23] op_sel:[0,0] op_sel_hi:[1,0]
    v_pk_add_f32 v[24:25], v[24:25], v[40:41]
    v_pk_fma_f32 v[32:33], v[40:41], v[40:41], v[32:33]
    v_pk_add_f32 v[26:27], v[26:27], v[42:43]
    v_pk_fma_f32 v[34:35], v[42:43], v[42:43], v[34:35]
    v_pk_add_f32 v[28:29], v[28:29], v[44:45]
    v_pk_fma_f32 v[36:37], v[44:45], v[44:45], v[36:37]
    v_pk_add_f32 v[30:31], v[30:31], v[46:47]
    v_pk_fma_f32 v[38:39], v[46:47], v[46:47], v[38:39]
    s_waitcnt vmcnt(8)
    v_cmp_eq_u32 vcc, -1, v116
    s_cbranch_vccnz kf_hr13
kf_hr13_ret:
    v_lshlrev_b32 v48, 16, v116
    v_and_b32 v49, 0xffff0000, v116
    v_lshlrev_b32 v50, 16, v117
    v_and_b32 v51, 0xffff0000, v117
    v_lshlrev_b32 v52, 16, v118
    v_and_b32 v53, 0xffff0000, v118
    v_lshlrev_b32_e64 v54, 16, v119
    v_and_b32 v55, 0xffff0000, v119
    v_pk_mul_f32 v[48:49], v[48:49], v[22:23] op_sel:[0,1] op_sel_hi:[1,1]
    v_pk_mul_f32 v[50:51], v[50:51], v[22:23] op_sel:[0,1] op_sel_hi:[1,1]
    v_pk_mul_f32 v[52:53], v[52:53], v[22:23] op_sel:[0,1] op_sel_hi:[1,1]
    v_pk_mul_f32 v[54:55], v[54:55], v[22:23] op_sel:[0,1] op_sel_hi:[1,1]
    v_pk_add_f32 v[24:25], v[24:25], v[48:49]
    v_pk_fma_f32 v[32:33], v[48:49], v[48:49], v[32:33]
    v_pk_add_f32 v[26:27], v[26:27], v[50:51]
    v_pk_fma_f32 v[34:35], v[50:51], v[50:51], v[34:35]
    v_pk_add_f32 v[28:29], v[28:29], v[52:53]
    v_pk_fma_f32 v[36:37], v[52:53], v[52:53], v[36:37]
    v_pk_add_f32 v[30:31], v[30:31], v[54:55]
    v_pk_fma_f32 v[38:39], v[54:55], v[54:55], v[38:39]
    v_permlane32_swap_b32 v24, v32
    v_permlane32_swap_b32 v25, v33
    v_permlane32_swap_b32 v26, v34
    v_permlane32_swap_b32 v27, v35
    v_permlane32_swap_b32 v28, v36
    v_permlane32_swap_b32 v29, v37
    v_permlane32_swap_b32 v30, v38
    v_permlane32_swap_b32 v31, v39
    v_add_f32 v24, v24, v32
    v_add_f32 v25, v25, v33
    v_add_f32 v26, v26, v34
    v_add_f32 v27, v27, v35
    v_add_f32 v28, v28, v36
    v_add_f32 v29, v29, v37
    v_add_f32 v30, v30, v38
    v_add_f32 v31, v31, v39
    v_permlane16_swap_b32 v24, v28
    v_permlane16_swap_b32 v25, v29
    v_permlane16_swap_b32 v26, v30
    v_permlane16_swap_b32 v27, v31
    v_add_f32 v24, v24, v28
    v_add_f32 v25, v25, v29
    v_add_f32 v26, v26, v30
    v_add_f32 v27, v27, v31
    v_add_f32_dpp v24, v24, v24 row_ror:8 row_mask:0xf bank_mask:0xf
    v_add_f32_dpp v25, v25, v25 row_ror:8 row_mask:0xf bank_mask:0xf
    v_add_f32_dpp v26, v26, v26 row_ror:8 row_mask:0xf bank_mask:0xf
    v_add_f32_dpp v27, v27, v27 row_ror:8 row_mask:0xf bank_mask:0xf
    ds_write_b128 v6, v[24:27]
    s_waitcnt lgkmcnt(0)
    s_barrier
    s_cmp_lg_u32 s20, 0
    s_cbranch_scc1 kf_hz
    ds_read_b32 v32, v7 offset:0
    ds_read_b32 v33, v7 offset:256
    ds_read_b32 v34, v7 offset:512
    ds_read_b32 v35, v7 offset:768
    ds_read_b32 v36, v7 offset:1024
    ds_read_b32 v37, v7 offset:1280
    ds_read_b32 v38, v7 offset:1536
    ds_read_b32 v39, v7 offset:1792
    v_mov_b32 v40, s59
    s_waitcnt lgkmcnt(0)
    v_add_f32 v32, v32, v34
    v_add_f32 v33, v33, v35
    v_add_f32 v36, v36, v38
    v_add_f32 v37, v37, v39
    v_add_f32 v32, v32, v36
    v_add_f32 v33, v33, v37
    v_mul_f32 v32, 0x3b124925, v32
    v_mul_f32 v33, 0x3b124925, v33
    v_fma_f32 v33, -v32, v32, v33
    v_max_f32_e64 v33, 0, v33
    v_cvt_pk_bf16_f32 v33, 0, v33
    v_add_f32 v33, 0x3727c5ac, v33
    v_cvt_pk_bf16_f32 v33, 0, v33
    v_sqrt_f32 v33, v33
    s_nop 0
    v_cvt_pk_bf16_f32 v41, -v32, v33
    buffer_store_dwordx2 v[40:41], v8, s[16:19], s22 offen sc1
kf_hz:
    s_add_u32 s28, s26, 13107200
    buffer_store_dwordx4 v[168:171], v3, s[16:19], s28 offen offset:0 sc1
    buffer_store_dwordx4 v[168:171], v3, s[16:19], s28 offen offset:1024 sc1
    s_add_u32 s28, s26, 13123584
    buffer_store_dwordx4 v[168:171], v3, s[16:19], s28 offen offset:0 sc1
    buffer_store_dwordx4 v[168:171], v3, s[16:19], s28 offen offset:1024 sc1
    s_add_u32 s28, s26, 13139968
    buffer_store_dwordx4 v[168:171], v3, s[16:19], s28 offen offset:0 sc1
    buffer_store_dwordx4 v[168:171], v3, s[16:19], s28 offen offset:1024 sc1
    s_add_u32 s28, s26, 13271040
    buffer_store_dwordx4 v[168:171], v3, s[16:19], s28 offen offset:0 sc1
    buffer_store_dwordx4 v[168:171], v3, s[16:19], s28 offen offset:1024 sc1
    s_add_u32 s28, s26, 13287424
    buffer_store_dwordx4 v[168:171], v3, s[16:19], s28 offen offset:0 sc1
    buffer_store_dwordx4 v[168:171], v3, s[16:19], s28 offen offset:1024 sc1
    s_add_u32 s28, s26, 13303808
    buffer_store_dwordx4 v[168:171], v3, s[16:19], s28 offen offset:0 sc1
    buffer_store_dwordx4 v[168:171], v3, s[16:19], s28 offen offset:1024 sc1
    s_waitcnt vmcnt(6)
    s_mov_b64 exec, 255
    buffer_store_dwordx4 v[172:175], v3, s[16:19], s27 offen sc1
    s_mov_b64 exec, -1
    s_add_u32 s28, s26, 13320192
    buffer_store_dwordx4 v[168:171], v3, s[16:19], s28 offen offset:0 sc1
    buffer_store_dwordx4 v[168:171], v3, s[16:19], s28 offen offset:1024 sc1
    s_add_u32 s28, s26, 13336576
    buffer_store_dwordx4 v[168:171], v3, s[16:19], s28 offen offset:0 sc1
    buffer_store_dwordx4 v[168:171], v3, s[16:19], s28 offen offset:1024 sc1
    s_add_u32 s28, s26, 13352960
    buffer_store_dwordx4 v[168:171], v3, s[16:19], s28 offen offset:0 sc1
    buffer_store_dwordx4 v[168:171], v3, s[16:19], s28 offen offset:1024 sc1
    s_add_u32 s28, s26, 13369344
    buffer_store_dwordx4 v[168:171], v3, s[16:19], s28 offen offset:0 sc1
    buffer_store_dwordx4 v[168:171], v3, s[16:19], s28 offen offset:1024 sc1
    s_mov_b64 exec, 255
    s_waitcnt vmcnt(0)
    v_mov_b32 v173, s59
    buffer_store_dwordx4 v[172:175], v3, s[16:19], s27 offen sc1
    s_endpgm
kf_rn_h:
    s_mov_b32 s92, 200000
kf_rn_h_l:
    s_sleep 1
    global_load_dword v30, v29, s[56:57] sc1
    s_sub_u32 s92, s92, 1
    s_cbranch_scc1 kf_end
    s_waitcnt vmcnt(0)
    v_readfirstlane_b32 s59, v30
    s_nop 0
    s_cmp_eq_u32 s59, 0
    s_cbranch_scc1 kf_rn_h_l
    s_branch kf_rn_h_ret
kf_rp_h:
    s_mov_b32 s92, 200000
kf_rp_h_l:
    s_mov_b64 exec, vcc
    s_sleep 1
    buffer_load_dwordx4 v[64:67], v32, s[16:19], s8 offen offset:0 sc1
    buffer_load_dwordx4 v[68:71], v32, s[16:19], s8 offen offset:64 sc1
    buffer_load_dwordx4 v[72:75], v32, s[16:19], s8 offen offset:128 sc1
    buffer_load_dwordx4 v[76:79], v32, s[16:19], s8 offen offset:192 sc1
    s_sub_u32 s92, s92, 1
    s_cbranch_scc1 kf_end
    s_waitcnt vmcnt(0)
    v_xor_b32 v56, s59, v64
    v_xor_b32 v57, s59, v68
    v_xor_b32 v58, s59, v72
    v_xor_b32 v59, s59, v76
    v_or3_b32 v56, v56, v57, v58
    v_or_b32 v56, v56, v59
    v_cmp_ne_u32 vcc, 0, v56
    s_cbranch_vccnz kf_rp_h_l
    s_mov_b64 exec, -1
    s_branch kf_rp_h_ret
kf_rm_h:
    s_mov_b32 s92, 200000
kf_rm_h_l:
    s_mov_b64 exec, vcc
    s_sleep 1
    buffer_load_dwordx2 v[124:125], v31, s[16:19], s38 offen sc1
    buffer_load_dwordx2 v[220:221], v31, s[16:19], s39 offen sc1
    s_sub_u32 s92, s92, 1
    s_cbranch_scc1 kf_end
    s_waitcnt vmcnt(0)
    v_xor_b32 v57, s59, v124
    v_xor_b32 v58, s59, v220
    v_or_b32 v57, v57, v58
    v_cmp_ne_u32 vcc, 0, v57
    s_cbranch_vccnz kf_rm_h_l
    s_mov_b64 exec, -1
    s_branch kf_rm_h_ret
kf_rv_h:
    s_mov_b32 s92, 200000
kf_rv_h_l:
    s_mov_b64 exec, vcc
    s_sleep 1
    s_mov_b32 s7, 2220032
    buffer_load_dwordx4 v[160:163], v3, s[16:19], s7 offen sc1
    s_sub_u32 s92, s92, 1
    s_cbranch_scc1 kf_end
    s_waitcnt vmcnt(0)
    v_xor_b32 v164, s59, v160
    v_xor_b32 v165, s59, v161
    v_xor_b32 v166, s59, v162
    v_xor_b32 v167, s59, v163
    v_or3_b32 v168, v164, v165, v166
    v_or_b32 v168, v168, v167
    v_cmp_lt_u32 vcc, 31, v168
    s_cbranch_vccnz kf_rv_h_l
    s_mov_b64 exec, -1
    s_branch kf_rv_h_ret
kf_rw_h:
    s_mov_b32 s92, 200000
kf_rw_h_l:
    s_mov_b64 exec, vcc
    s_sleep 1
    buffer_load_dword v244, v245, s[16:19], 0 offen sc1
    s_sub_u32 s92, s92, 1
    s_cbranch_scc1 kf_end
    s_waitcnt vmcnt(0)
    v_cmp_ne_u32 vcc, s59, v244
    s_cbranch_vccnz kf_rw_h_l
    s_mov_b64 exec, -1
    s_branch kf_rw_h_ret
kf_rf_h:
    s_mov_b32 s92, 200000
kf_rf_h_l:
    s_mov_b64 exec, vcc
    s_mov_b32 s7, 2228224
    buffer_load_dword v252, v4, s[16:19], s7 offen sc1
    s_sub_u32 s92, s92, 1
    s_cbranch_scc1 kf_end
    s_waitcnt vmcnt(0)
    v_cmp_ne_u32 vcc, s59, v252
    s_cbranch_vccnz kf_rf_h_l
    s_mov_b64 exec, -1
    s_branch kf_rf_h_ret
kf_rx0:
    s_mov_b32 s92, 200000
kf_rx0_l:
    s_mov_b64 exec, vcc
    s_sleep 1
    s_mov_b64 exec, -1
    s_add_u32 m0, s25, 0
    s_xor_b32 s15, s21, 0
    buffer_load_dwordx4 v3, s[16:19], s15 offen sc1 lds
    s_add_u32 m0, s25, 4096
    s_xor_b32 s15, s21, 2048
    buffer_load_dwordx4 v3, s[16:19], s15 offen sc1 lds
    s_add_u32 m0, s25, 57344
    s_xor_b32 s15, s21, 65536
    buffer_load_dwordx4 v3, s[16:19], s15 offen sc1 lds
    s_add_u32 m0, s25, 61440
    s_xor_b32 s15, s21, 67584
    buffer_load_dwordx4 v3, s[16:19], s15 offen sc1 lds
    s_add_u32 m0, s25, 8192
    s_xor_b32 s15, s21, 4096
    buffer_load_dwordx4 v3, s[16:19], s15 offen sc1 lds
    s_add_u32 m0, s25, 12288
    s_xor_b32 s15, s21, 6144
    buffer_load_dwordx4 v3, s[16:19], s15 offen sc1 lds
    s_add_u32 m0, s25, 16384
    s_xor_b32 s15, s21, 16384
    buffer_load_dwordx4 v3, s[16:19], s15 offen sc1 lds
    s_add_u32 m0, s25, 20480
    s_xor_b32 s15, s21, 18432
    buffer_load_dwordx4 v3, s[16:19], s15 offen sc1 lds
    s_add_u32 m0, s25, 65536
    s_xor_b32 s15, s21, 69632
    buffer_load_dwordx4 v3, s[16:19], s15 offen sc1 lds
    s_add_u32 m0, s25, 69632
    s_xor_b32 s15, s21, 71680
    buffer_load_dwordx4 v3, s[16:19], s15 offen sc1 lds
    s_add_u32 m0, s25, 73728
    s_xor_b32 s15, s21, 81920
    buffer_load_dwordx4 v3, s[16:19], s15 offen sc1 lds
    s_add_u32 m0, s25, 77824
    s_xor_b32 s15, s21, 83968
    buffer_load_dwordx4 v3, s[16:19], s15 offen sc1 lds
    s_sub_u32 s92, s92, 1
    s_cbranch_scc1 kf_end
    s_waitcnt vmcnt(0)
    ds_read2st64_b32 v[118:119], v15 offset0:0 offset1:16
    ds_read2st64_b32 v[120:121], v10 offset0:0 offset1:16
    s_waitcnt lgkmcnt(0)
    v_max_u32 v118, v118, v119
    v_max3_u32 v118, v118, v120, v121
    v_cmp_eq_u32 vcc, -1, v118
    s_cbranch_vccnz kf_rx0_l
    s_mov_b64 exec, -1
    s_branch kf_rx0_ret
kf_rx1:
    s_mov_b32 s92, 200000
kf_rx1_l:
    s_mov_b64 exec, vcc
    s_sleep 1
    s_mov_b64 exec, -1
    s_add_u32 m0, s25, 8192
    s_xor_b32 s15, s21, 4096
    buffer_load_dwordx4 v3, s[16:19], s15 offen sc1 lds
    s_add_u32 m0, s25, 12288
    s_xor_b32 s15, s21, 6144
    buffer_load_dwordx4 v3, s[16:19], s15 offen sc1 lds
    s_add_u32 m0, s25, 16384
    s_xor_b32 s15, s21, 16384
    buffer_load_dwordx4 v3, s[16:19], s15 offen sc1 lds
    s_add_u32 m0, s25, 20480
    s_xor_b32 s15, s21, 18432
    buffer_load_dwordx4 v3, s[16:19], s15 offen sc1 lds
    s_add_u32 m0, s25, 65536
    s_xor_b32 s15, s21, 69632
    buffer_load_dwordx4 v3, s[16:19], s15 offen sc1 lds
    s_add_u32 m0, s25, 69632
    s_xor_b32 s15, s21, 71680
    buffer_load_dwordx4 v3, s[16:19], s15 offen sc1 lds
    s_add_u32 m0, s25, 73728
    s_xor_b32 s15, s21, 81920
    buffer_load_dwordx4 v3, s[16:19], s15 offen sc1 lds
    s_add_u32 m0, s25, 77824
    s_xor_b32 s15, s21, 83968
    buffer_load_dwordx4 v3, s[16:19], s15 offen sc1 lds
    s_sub_u32 s92, s92, 1
    s_cbranch_scc1 kf_end
    s_waitcnt vmcnt(0)
    ds_read2st64_b32 v[118:119], v15 offset0:32 offset1:48
    ds_read2st64_b32 v[120:121], v15 offset0:64 offset1:80
    ds_read2st64_b32 v[122:123], v10 offset0:32 offset1:48
    ds_read2st64_b32 v[124:125], v10 offset0:64 offset1:80
    s_waitcnt lgkmcnt(0)
    v_max_u32_e64 v118, v118, v119
    v_max3_u32 v118, v118, v120, v121
    v_max3_u32 v118, v118, v122, v123
    v_max3_u32 v118, v118, v124, v125
    v_cmp_eq_u32 vcc, -1, v118
    s_cbranch_vccnz kf_rx1_l
    s_mov_b64 exec, -1
    s_branch kf_rx1_ret
    s_nop 0
kf_rx2:
    s_mov_b32 s92, 200000
kf_rx2_l:
    s_mov_b64 exec, vcc
    s_sleep 1
    s_mov_b64 exec, -1
    s_add_u32 m0, s25, 24576
    s_xor_b32 s15, s21, 20480
    buffer_load_dwordx4 v3, s[16:19], s15 offen sc1 lds
    s_add_u32 m0, s25, 28672
    s_xor_b32 s15, s21, 22528
    buffer_load_dwordx4 v3, s[16:19], s15 offen sc1 lds
    s_add_u32 m0, s25, 32768
    s_xor_b32 s15, s21, 32768
    buffer_load_dwordx4 v3, s[16:19], s15 offen sc1 lds
    s_add_u32 m0, s25, 36864
    s_xor_b32 s15, s21, 34816
    buffer_load_dwordx4 v3, s[16:19], s15 offen sc1 lds
    s_add_u32 m0, s25, 40960
    s_xor_b32 s15, s21, 36864
    buffer_load_dwordx4 v3, s[16:19], s15 offen sc1 lds
    s_add_u32 m0, s25, 45056
    s_xor_b32 s15, s21, 38912
    buffer_load_dwordx4 v3, s[16:19], s15 offen sc1 lds
    s_add_u32 m0, s25, 49152
    s_xor_b32 s15, s21, 49152
    buffer_load_dwordx4 v3, s[16:19], s15 offen sc1 lds
    s_add_u32 m0, s25, 53248
    s_xor_b32 s15, s21, 51200
    buffer_load_dwordx4 v3, s[16:19], s15 offen sc1 lds
    s_add_u32 m0, s25, 81920
    s_xor_b32 s15, s21, 86016
    buffer_load_dwordx4 v3, s[16:19], s15 offen sc1 lds
    s_add_u32 m0, s25, 86016
    s_xor_b32 s15, s21, 88064
    buffer_load_dwordx4 v3, s[16:19], s15 offen sc1 lds
    s_add_u32 m0, s25, 90112
    s_xor_b32 s15, s21, 98304
    buffer_load_dwordx4 v3, s[16:19], s15 offen sc1 lds
    s_add_u32 m0, s25, 94208
    s_xor_b32 s15, s21, 100352
    buffer_load_dwordx4 v3, s[16:19], s15 offen sc1 lds
    s_add_u32 m0, s25, 98304
    s_xor_b32 s15, s21, 102400
    buffer_load_dwordx4 v3, s[16:19], s15 offen sc1 lds
    s_add_u32 m0, s25, 102400
    s_xor_b32 s15, s21, 104448
    buffer_load_dwordx4 v3, s[16:19], s15 offen sc1 lds
    s_add_u32 m0, s25, 106496
    s_xor_b32 s15, s21, 114688
    buffer_load_dwordx4 v3, s[16:19], s15 offen sc1 lds
    s_add_u32 m0, s25, 110592
    s_xor_b32 s15, s21, 116736
    buffer_load_dwordx4 v3, s[16:19], s15 offen sc1 lds
    s_sub_u32 s92, s92, 1
    s_cbranch_scc1 kf_end
    s_waitcnt vmcnt(0)
    ds_read2st64_b32 v[118:119], v15 offset0:96 offset1:112
    s_waitcnt lgkmcnt(0)
    v_max_u32 v118, v118, v119
    v_cmp_eq_u32 vcc, -1, v118
    s_cbranch_vccnz kf_rx2_l
    s_mov_b64 exec, -1
    s_branch kf_rx2_ret
kf_rx3:
    s_mov_b32 s92, 200000
kf_rx3_l:
    s_mov_b64 exec, vcc
    s_sleep 1
    s_mov_b64 exec, -1
    s_add_u32 m0, s25, 32768
    s_xor_b32 s15, s21, 32768
    buffer_load_dwordx4 v3, s[16:19], s15 offen sc1 lds
    s_add_u32 m0, s25, 36864
    s_xor_b32 s15, s21, 34816
    buffer_load_dwordx4 v3, s[16:19], s15 offen sc1 lds
    s_add_u32 m0, s25, 40960
    s_xor_b32 s15, s21, 36864
    buffer_load_dwordx4 v3, s[16:19], s15 offen sc1 lds
    s_add_u32 m0, s25, 45056
    s_xor_b32 s15, s21, 38912
    buffer_load_dwordx4 v3, s[16:19], s15 offen sc1 lds
    s_add_u32 m0, s25, 49152
    s_xor_b32 s15, s21, 49152
    buffer_load_dwordx4 v3, s[16:19], s15 offen sc1 lds
    s_add_u32 m0, s25, 53248
    s_xor_b32 s15, s21, 51200
    buffer_load_dwordx4 v3, s[16:19], s15 offen sc1 lds
    s_add_u32 m0, s25, 81920
    s_xor_b32 s15, s21, 86016
    buffer_load_dwordx4 v3, s[16:19], s15 offen sc1 lds
    s_add_u32 m0, s25, 86016
    s_xor_b32 s15, s21, 88064
    buffer_load_dwordx4 v3, s[16:19], s15 offen sc1 lds
    s_add_u32 m0, s25, 90112
    s_xor_b32 s15, s21, 98304
    buffer_load_dwordx4 v3, s[16:19], s15 offen sc1 lds
    s_add_u32 m0, s25, 94208
    s_xor_b32 s15, s21, 100352
    buffer_load_dwordx4 v3, s[16:19], s15 offen sc1 lds
    s_add_u32 m0, s25, 98304
    s_xor_b32 s15, s21, 102400
    buffer_load_dwordx4 v3, s[16:19], s15 offen sc1 lds
    s_add_u32 m0, s25, 102400
    s_xor_b32 s15, s21, 104448
    buffer_load_dwordx4 v3, s[16:19], s15 offen sc1 lds
    s_add_u32 m0, s25, 106496
    s_xor_b32 s15, s21, 114688
    buffer_load_dwordx4 v3, s[16:19], s15 offen sc1 lds
    s_add_u32 m0, s25, 110592
    s_xor_b32 s15, s21, 116736
    buffer_load_dwordx4 v3, s[16:19], s15 offen sc1 lds
    s_sub_u32 s92, s92, 1
    s_cbranch_scc1 kf_end
    s_waitcnt vmcnt(0)
    ds_read2st64_b32 v[118:119], v15 offset0:128 offset1:144
    ds_read2st64_b32 v[120:121], v15 offset0:160 offset1:176
    s_waitcnt lgkmcnt(0)
    v_max_u32 v118, v118, v119
    v_max3_u32 v118, v118, v120, v121
    v_cmp_eq_u32 vcc, -1, v118
    s_cbranch_vccnz kf_rx3_l
    s_mov_b64 exec, -1
    s_branch kf_rx3_ret
    s_nop 0
kf_rg:
    s_mov_b32 s92, 200000
kf_rg_l:
    s_mov_b64 exec, vcc
    s_sleep 1
    buffer_load_dwordx4 v[114:117], v4, s[16:19], s40 offen sc1
    s_sub_u32 s92, s92, 1
    s_cbranch_scc1 kf_end
    s_waitcnt vmcnt(0)
    v_cmp_ne_u32 vcc, s59, v114
    s_cbranch_vccnz kf_rg_l
    s_mov_b64 exec, -1
    s_branch kf_rg_ret
kf_rx4:
    s_mov_b32 s92, 200000
kf_rx4_l:
    s_mov_b64 exec, vcc
    s_sleep 1
    s_mov_b64 exec, -1
    s_add_u32 m0, s25, 49152
    s_xor_b32 s15, s21, 49152
    buffer_load_dwordx4 v3, s[16:19], s15 offen sc1 lds
    s_add_u32 m0, s25, 53248
    s_xor_b32 s15, s21, 51200
    buffer_load_dwordx4 v3, s[16:19], s15 offen sc1 lds
    s_add_u32 m0, s25, 81920
    s_xor_b32 s15, s21, 86016
    buffer_load_dwordx4 v3, s[16:19], s15 offen sc1 lds
    s_add_u32 m0, s25, 86016
    s_xor_b32 s15, s21, 88064
    buffer_load_dwordx4 v3, s[16:19], s15 offen sc1 lds
    s_add_u32 m0, s25, 90112
    s_xor_b32 s15, s21, 98304
    buffer_load_dwordx4 v3, s[16:19], s15 offen sc1 lds
    s_add_u32 m0, s25, 94208
    s_xor_b32 s15, s21, 100352
    buffer_load_dwordx4 v3, s[16:19], s15 offen sc1 lds
    s_add_u32 m0, s25, 98304
    s_xor_b32 s15, s21, 102400
    buffer_load_dwordx4 v3, s[16:19], s15 offen sc1 lds
    s_add_u32 m0, s25, 102400
    s_xor_b32 s15, s21, 104448
    buffer_load_dwordx4 v3, s[16:19], s15 offen sc1 lds
    s_add_u32 m0, s25, 106496
    s_xor_b32 s15, s21, 114688
    buffer_load_dwordx4 v3, s[16:19], s15 offen sc1 lds
    s_add_u32 m0, s25, 110592
    s_xor_b32 s15, s21, 116736
    buffer_load_dwordx4 v3, s[16:19], s15 offen sc1 lds
    s_sub_u32 s92, s92, 1
    s_cbranch_scc1 kf_end
    s_waitcnt vmcnt(0)
    ds_read2st64_b32 v[118:119], v15 offset0:192 offset1:208
    ds_read2st64_b32 v[120:121], v10 offset0:96 offset1:112
    ds_read2st64_b32 v[122:123], v10 offset0:128 offset1:144
    ds_read2st64_b32 v[124:125], v10 offset0:160 offset1:176
    ds_read2st64_b32 v[126:127], v10 offset0:192 offset1:208
    s_waitcnt lgkmcnt(0)
    v_max_u32_e64 v118, v118, v119
    v_max3_u32 v118, v118, v120, v121
    v_max3_u32 v118, v118, v122, v123
    v_max3_u32 v118, v118, v124, v125
    v_max3_u32 v118, v118, v126, v127
    v_cmp_eq_u32 vcc, -1, v118
    s_cbranch_vccnz kf_rx4_l
    s_mov_b64 exec, -1
    s_branch kf_rx4_ret
kf_rb:
    s_mov_b32 s92, 200000
kf_rb_l:
    s_mov_b64 exec, vcc
    s_sleep 1
    buffer_load_dwordx3 v[76:78], v3, s[16:19], s24 offen offset:0 sc1
    buffer_load_dwordx3 v[80:82], v3, s[16:19], s24 offen offset:1024 sc1
    s_sub_u32 s92, s92, 1
    s_cbranch_scc1 kf_end
    s_waitcnt vmcnt(0)
    v_xor_b32 v90, s59, v76
    v_xor_b32 v91, s59, v80
    v_or_b32 v90, v90, v91
    v_cmp_ne_u32 vcc, 0, v90
    s_cbranch_vccnz kf_rb_l
    s_mov_b64 exec, -1
    s_branch kf_rb_ret
kf_rs:
    s_mov_b32 s92, 200000
kf_rs_l:
    s_mov_b64 exec, vcc
    s_sleep 1
    buffer_load_dwordx2 v[96:97], v9, s[16:19], s31 offen offset:0 sc1
    buffer_load_dwordx2 v[98:99], v9, s[16:19], s31 offen offset:256 sc1
    buffer_load_dwordx2 v[100:101], v104, s[16:19], s31 offen offset:0 sc1
    buffer_load_dwordx2 v[102:103], v104, s[16:19], s31 offen offset:256 sc1
    s_sub_u32 s92, s92, 1
    s_cbranch_scc1 kf_end
    s_waitcnt vmcnt(0)
    v_xor_b32 v90, s59, v96
    v_xor_b32 v91, s59, v98
    v_xor_b32 v92, s59, v100
    v_xor_b32 v93, s59, v102
    v_or3_b32 v90, v90, v91, v92
    v_or_b32 v90, v90, v93
    v_cmp_ne_u32 vcc, 0, v90
    s_cbranch_vccnz kf_rs_l
    s_mov_b64 exec, -1
    s_branch kf_rs_ret
kf_rq:
    s_mov_b32 s92, 200000
kf_rq_l:
    s_mov_b64 exec, vcc
    s_sleep 1
    buffer_load_dword v89, v109, s[16:19], s33 offen sc1
    s_sub_u32 s92, s92, 1
    s_cbranch_scc1 kf_end
    s_waitcnt vmcnt(0)
    v_cmp_ne_u32 vcc, s59, v89
    s_cbranch_vccnz kf_rq_l
    s_mov_b64 exec, -1
    s_branch kf_rq_ret
    s_nop 0
kf_rh0_0:
    s_mov_b32 s92, 200000
kf_rh0_0_l:
    s_mov_b64 exec, vcc
    s_sleep 1
    s_mov_b64 exec, -1
    s_add_u32 s48, s29, s50
    buffer_load_dwordx4 v[136:139], v3, s[16:19], s48 offen offset:0 sc1
    buffer_load_dwordx4 v[140:143], v3, s[16:19], s48 offen offset:1024 sc1
    s_add_u32 s48, s29, s51
    buffer_load_dwordx4 v[144:147], v3, s[16:19], s48 offen offset:0 sc1
    buffer_load_dwordx4 v[148:151], v3, s[16:19], s48 offen offset:1024 sc1
    s_add_u32 s48, s29, s52
    buffer_load_dwordx4 v[152:155], v3, s[16:19], s48 offen offset:0 sc1
    buffer_load_dwordx4 v[156:159], v3, s[16:19], s48 offen offset:1024 sc1
    s_add_u32 s48, s29, s53
    buffer_load_dwordx4 v[168:171], v3, s[16:19], s48 offen offset:0 sc1
    buffer_load_dwordx4 v[172:175], v3, s[16:19], s48 offen offset:1024 sc1
    s_add_u32 s48, s29, s54
    buffer_load_dwordx4 v[176:179], v3, s[16:19], s48 offen offset:0 sc1
    buffer_load_dwordx4 v[180:183], v3, s[16:19], s48 offen offset:1024 sc1
    s_add_u32 s48, s29, s55
    buffer_load_dwordx4 v[184:187], v3, s[16:19], s48 offen offset:0 sc1
    buffer_load_dwordx4 v[188:191], v3, s[16:19], s48 offen offset:1024 sc1
    s_sub_u32 s92, s92, 1
    s_cbranch_scc1 kf_end
    s_waitcnt vmcnt(0)
    v_max_u32 v94, v136, v140
    v_cmp_eq_u32 vcc, -1, v94
    s_cbranch_vccnz kf_rh0_0_l
    s_mov_b64 exec, -1
    s_branch kf_rh0_0_ret
    s_nop 0
kf_rt2:
    s_mov_b32 s92, 200000
kf_rt2_l:
    s_mov_b64 exec, vcc
    s_sleep 1
    buffer_load_dword v90, v112, s[16:19], s33 offen offset:4 sc1
    s_sub_u32 s92, s92, 1
    s_cbranch_scc1 kf_end
    s_waitcnt vmcnt(0)
    v_cmp_ne_u32 vcc, s59, v90
    s_cbranch_vccnz kf_rt2_l
    s_mov_b64 exec, -1
    s_branch kf_rt2_ret
    s_nop 0
kf_rh0_2:
    s_mov_b32 s92, 200000
kf_rh0_2_l:
    s_mov_b64 exec, vcc
    s_sleep 1
    s_mov_b64 exec, -1
    s_add_u32 s48, s29, s51
    buffer_load_dwordx4 v[144:147], v3, s[16:19], s48 offen offset:0 sc1
    buffer_load_dwordx4 v[148:151], v3, s[16:19], s48 offen offset:1024 sc1
    s_add_u32 s48, s29, s52
    buffer_load_dwordx4 v[152:155], v3, s[16:19], s48 offen offset:0 sc1
    buffer_load_dwordx4 v[156:159], v3, s[16:19], s48 offen offset:1024 sc1
    s_add_u32 s48, s29, s53
    buffer_load_dwordx4 v[168:171], v3, s[16:19], s48 offen offset:0 sc1
    buffer_load_dwordx4 v[172:175], v3, s[16:19], s48 offen offset:1024 sc1
    s_add_u32 s48, s29, s54
    buffer_load_dwordx4 v[176:179], v3, s[16:19], s48 offen offset:0 sc1
    buffer_load_dwordx4 v[180:183], v3, s[16:19], s48 offen offset:1024 sc1
    s_add_u32 s48, s29, s55
    buffer_load_dwordx4 v[184:187], v3, s[16:19], s48 offen offset:0 sc1
    buffer_load_dwordx4 v[188:191], v3, s[16:19], s48 offen offset:1024 sc1
    s_sub_u32 s92, s92, 1
    s_cbranch_scc1 kf_end
    s_waitcnt vmcnt(0)
    v_max_u32 v94, v144, v148
    v_cmp_eq_u32 vcc, -1, v94
    s_cbranch_vccnz kf_rh0_2_l
    s_mov_b64 exec, -1
    s_branch kf_rh0_2_ret
kf_rh0_4:
    s_mov_b32 s92, 200000
kf_rh0_4_l:
    s_mov_b64 exec, vcc
    s_sleep 1
    s_mov_b64 exec, -1
    s_add_u32 s48, s29, s52
    buffer_load_dwordx4 v[152:155], v3, s[16:19], s48 offen offset:0 sc1
    buffer_load_dwordx4 v[156:159], v3, s[16:19], s48 offen offset:1024 sc1
    s_add_u32 s48, s29, s53
    buffer_load_dwordx4 v[168:171], v3, s[16:19], s48 offen offset:0 sc1
    buffer_load_dwordx4 v[172:175], v3, s[16:19], s48 offen offset:1024 sc1
    s_add_u32 s48, s29, s54
    buffer_load_dwordx4 v[176:179], v3, s[16:19], s48 offen offset:0 sc1
    buffer_load_dwordx4 v[180:183], v3, s[16:19], s48 offen offset:1024 sc1
    s_add_u32 s48, s29, s55
    buffer_load_dwordx4 v[184:187], v3, s[16:19], s48 offen offset:0 sc1
    buffer_load_dwordx4 v[188:191], v3, s[16:19], s48 offen offset:1024 sc1
    s_sub_u32 s92, s92, 1
    s_cbranch_scc1 kf_end
    s_waitcnt vmcnt(0)
    v_max_u32 v94, v152, v156
    v_cmp_eq_u32 vcc, -1, v94
    s_cbranch_vccnz kf_rh0_4_l
    s_mov_b64 exec, -1
    s_branch kf_rh0_4_ret
    s_nop 0
kf_rh0_6:
    s_mov_b32 s92, 200000
kf_rh0_6_l:
    s_mov_b64 exec, vcc
    s_sleep 1
    s_mov_b64 exec, -1
    s_add_u32 s48, s29, s53
    buffer_load_dwordx4 v[168:171], v3, s[16:19], s48 offen offset:0 sc1
    buffer_load_dwordx4 v[172:175], v3, s[16:19], s48 offen offset:1024 sc1
    s_add_u32 s48, s29, s54
    buffer_load_dwordx4 v[176:179], v3, s[16:19], s48 offen offset:0 sc1
    buffer_load_dwordx4 v[180:183], v3, s[16:19], s48 offen offset:1024 sc1
    s_add_u32 s48, s29, s55
    buffer_load_dwordx4 v[184:187], v3, s[16:19], s48 offen offset:0 sc1
    buffer_load_dwordx4 v[188:191], v3, s[16:19], s48 offen offset:1024 sc1
    s_sub_u32 s92, s92, 1
    s_cbranch_scc1 kf_end
    s_waitcnt vmcnt(0)
    v_max_u32 v94, v168, v172
    v_cmp_eq_u32 vcc, -1, v94
    s_cbranch_vccnz kf_rh0_6_l
    s_mov_b64 exec, -1
    s_branch kf_rh0_6_ret
kf_rh0_8:
    s_mov_b32 s92, 200000
kf_rh0_8_l:
    s_mov_b64 exec, vcc
    s_sleep 1
    s_mov_b64 exec, -1
    s_add_u32 s48, s29, s54
    buffer_load_dwordx4 v[176:179], v3, s[16:19], s48 offen offset:0 sc1
    buffer_load_dwordx4 v[180:183], v3, s[16:19], s48 offen offset:1024 sc1
    s_add_u32 s48, s29, s55
    buffer_load_dwordx4 v[184:187], v3, s[16:19], s48 offen offset:0 sc1
    buffer_load_dwordx4 v[188:191], v3, s[16:19], s48 offen offset:1024 sc1
    s_sub_u32 s92, s92, 1
    s_cbranch_scc1 kf_end
    s_waitcnt vmcnt(0)
    v_max_u32 v94, v176, v180
    v_cmp_eq_u32 vcc, -1, v94
    s_cbranch_vccnz kf_rh0_8_l
    s_mov_b64 exec, -1
    s_branch kf_rh0_8_ret
    s_nop 0
kf_rh0_10:
    s_mov_b32 s92, 200000
kf_rh0_10_l:
    s_mov_b64 exec, vcc
    s_sleep 1
    s_mov_b64 exec, -1
    s_add_u32 s48, s29, s55
    buffer_load_dwordx4 v[184:187], v3, s[16:19], s48 offen offset:0 sc1
    buffer_load_dwordx4 v[188:191], v3, s[16:19], s48 offen offset:1024 sc1
    s_sub_u32 s92, s92, 1
    s_cbranch_scc1 kf_end
    s_waitcnt vmcnt(0)
    v_max_u32 v94, v184, v188
    v_cmp_eq_u32 vcc, -1, v94
    s_cbranch_vccnz kf_rh0_10_l
    s_mov_b64 exec, -1
    s_branch kf_rh0_10_ret
    s_nop 0
kf_rh1_0n:
    s_mov_b32 s92, 200000
kf_rh1_0n_l:
    s_mov_b64 exec, vcc
    s_sleep 1
    s_mov_b64 exec, -1
    s_add_u32 s48, s42, s50
    buffer_load_dwordx4 v[200:203], v3, s[16:19], s48 offen offset:0 sc1
    buffer_load_dwordx4 v[204:207], v3, s[16:19], s48 offen offset:1024 sc1
    s_add_u32 s48, s42, s51
    buffer_load_dwordx4 v[208:211], v3, s[16:19], s48 offen offset:0 sc1
    buffer_load_dwordx4 v[212:215], v3, s[16:19], s48 offen offset:1024 sc1
    s_add_u32 s48, s42, s52
    buffer_load_dwordx4 v[216:219], v3, s[16:19], s48 offen offset:0 sc1
    buffer_load_dwordx4 v[220:223], v3, s[16:19], s48 offen offset:1024 sc1
    s_add_u32 s48, s42, s53
    buffer_load_dwordx4 v[128:131], v3, s[16:19], s48 offen offset:0 sc1
    buffer_load_dwordx4 v[132:135], v3, s[16:19], s48 offen offset:1024 sc1
    s_add_u32 s48, s42, s54
    buffer_load_dwordx4 v[136:139], v3, s[16:19], s48 offen offset:0 sc1
    buffer_load_dwordx4 v[140:143], v3, s[16:19], s48 offen offset:1024 sc1
    s_add_u32 s48, s42, s55
    buffer_load_dwordx4 v[144:147], v3, s[16:19], s48 offen offset:0 sc1
    buffer_load_dwordx4 v[148:151], v3, s[16:19], s48 offen offset:1024 sc1
    s_sub_u32 s92, s92, 1
    s_cbranch_scc1 kf_end
    s_waitcnt vmcnt(0)
    v_max_u32 v94, v200, v204
    v_max3_u32 v94, v94, v208, v212
    v_max3_u32 v94, v94, v216, v220
    v_max3_u32 v94, v94, v128, v132
    v_max3_u32 v94, v94, v136, v140
    v_max3_u32 v94, v94, v144, v148
    v_cmp_eq_u32_e64 vcc, -1, v94
    s_cbranch_vccnz kf_rh1_0n_l
    s_mov_b64 exec, -1
    v_mfma_f32_32x32x16_bf16 v[96:111], a[0:3], v[160:163], 0
    v_mfma_f32_32x32x16_bf16 v[112:127], a[4:7], v[160:163], 0
    v_mfma_f32_32x32x16_bf16 v[96:111], a[8:11], v[164:167], v[96:111]
    v_mfma_f32_32x32x16_bf16 v[112:127], a[12:15], v[164:167], v[112:127]
    v_mfma_f32_32x32x16_bf16 v[96:111], a[16:19], v[200:203], v[96:111]
    v_mfma_f32_32x32x16_bf16 v[112:127], a[20:23], v[200:203], v[112:127]
    v_mfma_f32_32x32x16_bf16 v[96:111], a[24:27], v[204:207], v[96:111]
    v_mfma_f32_32x32x16_bf16 v[112:127], a[28:31], v[204:207], v[112:127]
    v_mfma_f32_32x32x16_bf16 v[96:111], a[32:35], v[208:211], v[96:111]
    v_mfma_f32_32x32x16_bf16 v[112:127], a[36:39], v[208:211], v[112:127]
    v_mfma_f32_32x32x16_bf16 v[96:111], a[40:43], v[212:215], v[96:111]
    v_mfma_f32_32x32x16_bf16 v[112:127], a[44:47], v[212:215], v[112:127]
    v_mfma_f32_32x32x16_bf16 v[112:127], a[52:55], v[216:219], v[112:127]
    v_mfma_f32_32x32x16_bf16 v[112:127], a[60:63], v[220:223], v[112:127]
    v_mfma_f32_32x32x16_bf16 v[112:127], a[68:71], v[128:131], v[112:127]
    v_mfma_f32_32x32x16_bf16 v[112:127], a[76:79], v[132:135], v[112:127]
    v_mfma_f32_32x32x16_bf16 v[112:127], a[84:87], v[136:139], v[112:127]
    v_mfma_f32_32x32x16_bf16 v[112:127], a[92:95], v[140:143], v[112:127]
    v_mfma_f32_32x32x16_bf16 v[112:127], a[240:243], v[144:147], v[112:127]
    v_mfma_f32_32x32x16_bf16 v[112:127], a[232:235], v[148:151], v[112:127]
    v_mfma_f32_32x32x16_bf16 v[96:111], a[48:51], v[216:219], v[96:111]
    v_mfma_f32_32x32x16_bf16 v[96:111], a[56:59], v[220:223], v[96:111]
    v_mfma_f32_32x32x16_bf16 v[96:111], a[64:67], v[128:131], v[96:111]
    s_nop 15
    s_branch kf_rh1_0n_ret
    s_nop 0
kf_rh1x:
    s_mov_b32 s92, 200000
kf_rh1x_l:
    s_mov_b64 exec, vcc
    s_sleep 1
    s_mov_b64 exec, -1
    s_add_u32 s48, s30, s50
    buffer_load_dwordx4 v[232:235], v3, s[16:19], s48 offen offset:0 sc1
    buffer_load_dwordx4 v[236:239], v3, s[16:19], s48 offen offset:1024 sc1
    s_add_u32 s48, s30, s51
    buffer_load_dwordx4 v[240:243], v3, s[16:19], s48 offen offset:0 sc1
    buffer_load_dwordx4 v[244:247], v3, s[16:19], s48 offen offset:1024 sc1
    s_add_u32 s48, s30, s52
    buffer_load_dwordx4 v[248:251], v3, s[16:19], s48 offen offset:0 sc1
    buffer_load_dwordx4 v[252:255], v3, s[16:19], s48 offen offset:1024 sc1
    s_add_u32 s48, s30, s53
    buffer_load_dwordx4 v[152:155], v3, s[16:19], s48 offen offset:0 sc1
    buffer_load_dwordx4 v[156:159], v3, s[16:19], s48 offen offset:1024 sc1
    s_add_u32 s48, s30, s54
    buffer_load_dwordx4 v[168:171], v3, s[16:19], s48 offen offset:0 sc1
    buffer_load_dwordx4 v[172:175], v3, s[16:19], s48 offen offset:1024 sc1
    s_add_u32 s48, s30, s55
    buffer_load_dwordx4 v[176:179], v3, s[16:19], s48 offen offset:0 sc1
    buffer_load_dwordx4 v[180:183], v3, s[16:19], s48 offen offset:1024 sc1
    s_sub_u32 s92, s92, 1
    s_cbranch_scc1 kf_end
    s_waitcnt vmcnt(0)
    v_max_u32 v94, v232, v236
    v_max3_u32 v94, v94, v240, v244
    v_max3_u32 v94, v94, v248, v252
    v_max3_u32 v94, v94, v152, v156
    v_max3_u32 v94, v94, v168, v172
    v_max3_u32 v94, v94, v176, v180
    v_cmp_eq_u32_e64 vcc, -1, v94
    s_cbranch_vccnz kf_rh1x_l
    s_mov_b64 exec, -1
    v_mfma_f32_32x32x16_bf16 v[16:31], a[0:3], v[192:195], 0
    v_mfma_f32_32x32x16_bf16 v[32:47], a[4:7], v[192:195], 0
    v_mfma_f32_32x32x16_bf16 v[16:31], a[8:11], v[196:199], v[16:31]
    v_mfma_f32_32x32x16_bf16 v[32:47], a[12:15], v[196:199], v[32:47]
    v_mfma_f32_32x32x16_bf16 v[16:31], a[16:19], v[232:235], v[16:31]
    v_mfma_f32_32x32x16_bf16 v[32:47], a[20:23], v[232:235], v[32:47]
    v_mfma_f32_32x32x16_bf16 v[16:31], a[24:27], v[236:239], v[16:31]
    v_mfma_f32_32x32x16_bf16 v[32:47], a[28:31], v[236:239], v[32:47]
    v_mfma_f32_32x32x16_bf16 v[16:31], a[32:35], v[240:243], v[16:31]
    v_mfma_f32_32x32x16_bf16 v[32:47], a[36:39], v[240:243], v[32:47]
    v_mfma_f32_32x32x16_bf16 v[16:31], a[40:43], v[244:247], v[16:31]
    v_mfma_f32_32x32x16_bf16 v[32:47], a[44:47], v[244:247], v[32:47]
    v_mfma_f32_32x32x16_bf16 v[32:47], a[52:55], v[248:251], v[32:47]
    v_mfma_f32_32x32x16_bf16 v[32:47], a[60:63], v[252:255], v[32:47]
    v_mfma_f32_32x32x16_bf16 v[32:47], a[68:71], v[152:155], v[32:47]
    v_mfma_f32_32x32x16_bf16 v[32:47], a[76:79], v[156:159], v[32:47]
    v_mfma_f32_32x32x16_bf16 v[32:47], a[84:87], v[168:171], v[32:47]
    v_mfma_f32_32x32x16_bf16 v[32:47], a[92:95], v[172:175], v[32:47]
    v_mfma_f32_32x32x16_bf16 v[32:47], a[240:243], v[176:179], v[32:47]
    v_mfma_f32_32x32x16_bf16 v[32:47], a[232:235], v[180:183], v[32:47]
    v_mfma_f32_32x32x16_bf16 v[16:31], a[48:51], v[248:251], v[16:31]
    v_mfma_f32_32x32x16_bf16 v[16:31], a[56:59], v[252:255], v[16:31]
    v_mfma_f32_32x32x16_bf16 v[16:31], a[64:67], v[152:155], v[16:31]
    s_nop 15
    s_branch kf_rh1x_ret
    s_nop 0
kf_rh1y:
    s_mov_b32 s92, 200000
kf_rh1y_l:
    s_mov_b64 exec, vcc
    s_sleep 1
    s_mov_b64 exec, -1
    s_add_u32 s48, s43, s50
    buffer_load_dwordx4 v[184:187], v3, s[16:19], s48 offen offset:0 sc1
    buffer_load_dwordx4 v[188:191], v3, s[16:19], s48 offen offset:1024 sc1
    s_add_u32 s48, s43, s51
    buffer_load_dwordx4 v[160:163], v3, s[16:19], s48 offen offset:0 sc1
    buffer_load_dwordx4 v[164:167], v3, s[16:19], s48 offen offset:1024 sc1
    s_add_u32 s48, s43, s52
    buffer_load_dwordx4 v[200:203], v3, s[16:19], s48 offen offset:0 sc1
    buffer_load_dwordx4 v[204:207], v3, s[16:19], s48 offen offset:1024 sc1
    s_add_u32 s48, s43, s53
    buffer_load_dwordx4 v[208:211], v3, s[16:19], s48 offen offset:0 sc1
    buffer_load_dwordx4 v[212:215], v3, s[16:19], s48 offen offset:1024 sc1
    s_add_u32 s48, s43, s54
    buffer_load_dwordx4 v[216:219], v3, s[16:19], s48 offen offset:0 sc1
    buffer_load_dwordx4 v[220:223], v3, s[16:19], s48 offen offset:1024 sc1
    s_add_u32 s48, s43, s55
    buffer_load_dwordx4 v[128:131], v3, s[16:19], s48 offen offset:0 sc1
    buffer_load_dwordx4 v[132:135], v3, s[16:19], s48 offen offset:1024 sc1
    s_sub_u32 s92, s92, 1
    s_cbranch_scc1 kf_end
    s_waitcnt vmcnt(0)
    v_max_u32 v94, v184, v188
    v_max3_u32 v94, v94, v160, v164
    v_max3_u32 v94, v94, v200, v204
    v_max3_u32 v94, v94, v208, v212
    v_max3_u32 v94, v94, v216, v220
    v_max3_u32 v94, v94, v128, v132
    v_cmp_eq_u32_e64 vcc, -1, v94
    s_cbranch_vccnz kf_rh1y_l
    s_mov_b64 exec, -1
    v_mfma_f32_32x32x16_bf16 v[112:127], a[4:7], v[224:227], 0
    v_mfma_f32_32x32x16_bf16 v[112:127], a[12:15], v[228:231], v[112:127]
    v_mfma_f32_32x32x16_bf16 v[112:127], a[20:23], v[184:187], v[112:127]
    v_mfma_f32_32x32x16_bf16 v[112:127], a[28:31], v[188:191], v[112:127]
    v_mfma_f32_32x32x16_bf16 v[112:127], a[36:39], v[160:163], v[112:127]
    v_mfma_f32_32x32x16_bf16 v[112:127], a[44:47], v[164:167], v[112:127]
    v_mfma_f32_32x32x16_bf16 v[112:127], a[52:55], v[200:203], v[112:127]
    v_mfma_f32_32x32x16_bf16 v[112:127], a[60:63], v[204:207], v[112:127]
    v_mfma_f32_32x32x16_bf16 v[112:127], a[68:71], v[208:211], v[112:127]
    v_mfma_f32_32x32x16_bf16 v[112:127], a[76:79], v[212:215], v[112:127]
    v_mfma_f32_32x32x16_bf16 v[112:127], a[84:87], v[216:219], v[112:127]
    v_mfma_f32_32x32x16_bf16 v[112:127], a[92:95], v[220:223], v[112:127]
    v_mfma_f32_32x32x16_bf16 v[112:127], a[240:243], v[128:131], v[112:127]
    v_mfma_f32_32x32x16_bf16 v[112:127], a[232:235], v[132:135], v[112:127]
    v_mfma_f32_32x32x16_bf16 v[96:111], a[0:3], v[224:227], 0
    v_mfma_f32_32x32x16_bf16 v[96:111], a[8:11], v[228:231], v[96:111]
    v_mfma_f32_32x32x16_bf16 v[96:111], a[16:19], v[184:187], v[96:111]
    s_nop 15
    s_branch kf_rh1y_ret
kf_rx0p:
    s_mov_b32 s92, 200000
kf_rx0p_l:
    s_mov_b64 exec, vcc
    s_sleep 1
    s_add_u32 s48, s32, 917504
    buffer_load_dwordx4 v[136:139], v3, s[16:19], s48 offen offset:0 sc0 sc1
    buffer_load_dwordx4 v[140:143], v3, s[16:19], s48 offen offset:1024 sc0 sc1
    s_sub_u32 s92, s92, 1
    s_cbranch_scc1 kf_end
    s_waitcnt vmcnt(0)
    v_xor_b32 v68, s59, v139
    v_xor_b32 v69, s59, v143
    v_or_b32 v68, v68, v69
    v_cmp_ne_u32 vcc, 0, v68
    s_cbranch_vccnz kf_rx0p_l
    s_mov_b64 exec, -1
    s_branch kf_rx0p_ret
kf_rx1p:
    s_mov_b32 s92, 200000
    buffer_load_dwordx4 v[232:235], v3, s[84:87], s101 offen offset:0 sc0 sc1
    buffer_load_dwordx4 v[236:239], v3, s[84:87], s101 offen offset:1024 sc0 sc1
    s_waitcnt vmcnt(2)
    v_xor_b32 v68, s59, v195
    v_xor_b32 v69, s59, v199
    v_or_b32 v68, v68, v69
    v_cmp_ne_u32 vcc, 0, v68
    s_nop 4
    s_cbranch_vccnz kf_rx1p_c
    v_mov_b32 v144, v192
    v_mov_b32 v145, v193
    v_mov_b32 v146, v194
    v_mov_b32 v148, v196
    v_mov_b32 v149, v197
    v_mov_b32 v150, v198
    s_branch kf_rx1p_ret
    s_nop 0
kf_rx1p_c:
    s_waitcnt vmcnt(0)
    v_xor_b32 v68, s59, v235
    v_xor_b32 v69, s59, v239
    v_or_b32 v68, v68, v69
    v_cmp_ne_u32 vcc, 0, v68
    s_nop 4
    s_cbranch_vccz kf_rx1p_d
kf_rx1p_l:
    s_mov_b64 exec, vcc
    s_sleep 1
    buffer_load_dwordx4 v[232:235], v3, s[84:87], s101 offen offset:0 sc0 sc1
    buffer_load_dwordx4 v[236:239], v3, s[84:87], s101 offen offset:1024 sc0 sc1
    s_sub_u32 s92, s92, 1
    s_cbranch_scc1 kf_end
    s_waitcnt vmcnt(0)
    v_xor_b32 v68, s59, v235
    v_xor_b32 v69, s59, v239
    v_or_b32 v68, v68, v69
    v_cmp_ne_u32 vcc, 0, v68
    s_cbranch_vccnz kf_rx1p_l
    s_mov_b64 exec, -1
kf_rx1p_d:
    v_mov_b32 v144, v232
    v_mov_b32 v145, v233
    v_mov_b32 v146, v234
    v_mov_b32 v148, v236
    v_mov_b32 v149, v237
    v_mov_b32 v150, v238
    s_branch kf_rx1p_ret
    s_nop 0
kf_rn_l:
    s_mov_b32 s92, 200000
kf_rn_l_l:
    s_sleep 1
    global_load_dword v30, v29, s[56:57] sc1
    s_sub_u32 s92, s92, 1
    s_cbranch_scc1 kf_end
    s_waitcnt vmcnt(0)
    v_readfirstlane_b32 s59, v30
    s_nop 0
    s_cmp_eq_u32 s59, 0
    s_cbranch_scc1 kf_rn_l_l
    s_branch kf_rn_l_ret
kf_rp_l:
    s_mov_b32 s92, 200000
kf_rp_l_l:
    s_mov_b64 exec, vcc
    s_sleep 1
    buffer_load_dwordx4 v[64:67], v32, s[16:19], s8 offen offset:0 sc1
    buffer_load_dwordx4 v[68:71], v32, s[16:19], s8 offen offset:64 sc1
    buffer_load_dwordx4 v[72:75], v32, s[16:19], s8 offen offset:128 sc1
    buffer_load_dwordx4 v[76:79], v32, s[16:19], s8 offen offset:192 sc1
    s_sub_u32 s92, s92, 1
    s_cbranch_scc1 kf_end
    s_waitcnt vmcnt(0)
    v_xor_b32 v56, s59, v64
    v_xor_b32 v57, s59, v68
    v_xor_b32 v58, s59, v72
    v_xor_b32 v59, s59, v76
    v_or3_b32 v56, v56, v57, v58
    v_or_b32 v56, v56, v59
    v_cmp_ne_u32 vcc, 0, v56
    s_cbranch_vccnz kf_rp_l_l
    s_mov_b64 exec, -1
    s_branch kf_rp_l_ret
kf_rv_l:
    s_mov_b32 s92, 200000
kf_rv_l_l:
    s_mov_b64 exec, vcc
    s_sleep 1
    s_mov_b32 s7, 2220032
    buffer_load_dwordx4 v[160:163], v3, s[16:19], s7 offen sc1
    s_sub_u32 s92, s92, 1
    s_cbranch_scc1 kf_end
    s_waitcnt vmcnt(0)
    v_xor_b32 v164, s59, v160
    v_xor_b32 v165, s59, v161
    v_xor_b32 v166, s59, v162
    v_xor_b32 v167, s59, v163
    v_or3_b32 v168, v164, v165, v166
    v_or_b32 v168, v168, v167
    v_cmp_lt_u32 vcc, 31, v168
    s_cbranch_vccnz kf_rv_l_l
    s_mov_b64 exec, -1
    s_branch kf_rv_l_ret
kf_rm_l:
    s_mov_b32 s92, 200000
kf_rm_l_l:
    s_mov_b64 exec, vcc
    s_sleep 1
    buffer_load_dwordx2 v[220:221], v31, s[16:19], s39 offen sc1
    s_sub_u32 s92, s92, 1
    s_cbranch_scc1 kf_end
    s_waitcnt vmcnt(0)
    v_cmp_ne_u32 vcc, s59, v220
    s_cbranch_vccnz kf_rm_l_l
    s_mov_b64 exec, -1
    s_branch kf_rm_l_ret
    s_nop 0
kf_rw_l:
    s_mov_b32 s92, 200000
kf_rw_l_l:
    s_mov_b64 exec, vcc
    s_sleep 1
    buffer_load_dword v244, v245, s[16:19], 0 offen sc1
    s_sub_u32 s92, s92, 1
    s_cbranch_scc1 kf_end
    s_waitcnt vmcnt(0)
    v_cmp_ne_u32 vcc, s59, v244
    s_cbranch_vccnz kf_rw_l_l
    s_mov_b64 exec, -1
    s_branch kf_rw_l_ret
    s_nop 0
kf_rt:
    s_mov_b32 s92, 200000
kf_rt_l:
    s_mov_b64 exec, vcc
    s_sleep 1
    s_mov_b32 s3, 2632192
    buffer_load_dwordx4 v[112:115], v110, s[16:19], s3 offen sc1
    s_mov_b32 s3, 2635776
    buffer_load_dwordx4 v[128:131], v110, s[16:19], s3 offen sc1
    s_mov_b32 s3, 2639360
    buffer_load_dwordx4 v[144:147], v110, s[16:19], s3 offen sc1
    s_mov_b32 s3, 2653696
    buffer_load_dwordx4 v[116:119], v110, s[16:19], s3 offen sc1
    s_mov_b32 s3, 2657280
    buffer_load_dwordx4 v[132:135], v110, s[16:19], s3 offen sc1
    s_mov_b32 s3, 2660864
    buffer_load_dwordx4 v[148:151], v110, s[16:19], s3 offen sc1
    s_mov_b32 s3, 2675200
    buffer_load_dwordx4 v[120:123], v110, s[16:19], s3 offen sc1
    s_mov_b32 s3, 2678784
    buffer_load_dwordx4 v[136:139], v110, s[16:19], s3 offen sc1
    s_mov_b32 s3, 2682368
    buffer_load_dwordx4 v[152:155], v110, s[16:19], s3 offen sc1
    s_mov_b32 s3, 2696704
    buffer_load_dwordx4 v[124:127], v110, s[16:19], s3 offen sc1
    s_mov_b32 s3, 2700288
    buffer_load_dwordx4 v[140:143], v110, s[16:19], s3 offen sc1
    s_mov_b32 s3, 2703872
    buffer_load_dwordx4 v[156:159], v110, s[16:19], s3 offen sc1
    s_sub_u32 s92, s92, 1
    s_cbranch_scc1 kf_end
    s_waitcnt vmcnt(0)
    v_xor_b32 v1, s59, v112
    v_xor_b32 v109, s59, v114
    v_or_b32 v2, v1, v109
    v_xor_b32 v1, s59, v116
    v_xor_b32 v109, s59, v118
    v_or3_b32 v2, v2, v1, v109
    v_xor_b32 v1, s59, v120
    v_xor_b32 v109, s59, v122
    v_or3_b32 v2, v2, v1, v109
    v_xor_b32 v1, s59, v124
    v_xor_b32 v109, s59, v126
    v_or3_b32 v2, v2, v1, v109
    v_xor_b32 v1, s59, v128
    v_xor_b32 v109, s59, v130
    v_or3_b32 v2, v2, v1, v109
    v_xor_b32 v1, s59, v132
    v_xor_b32 v109, s59, v134
    v_or3_b32 v2, v2, v1, v109
    v_xor_b32 v1, s59, v136
    v_xor_b32 v109, s59, v138
    v_or3_b32 v2, v2, v1, v109
    v_xor_b32 v1, s59, v140
    v_xor_b32 v109, s59, v142
    v_or3_b32 v2, v2, v1, v109
    v_xor_b32 v1, s59, v144
    v_xor_b32 v109, s59, v146
    v_or3_b32 v2, v2, v1, v109
    v_xor_b32 v1, s59, v148
    v_xor_b32 v109, s59, v150
    v_or3_b32 v2, v2, v1, v109
    v_xor_b32 v1, s59, v152
    v_xor_b32 v109, s59, v154
    v_or3_b32 v2, v2, v1, v109
    v_xor_b32 v1, s59, v156
    v_xor_b32 v109, s59, v158
    v_or3_b32 v2, v2, v1, v109
    v_cmp_ne_u32 vcc, 0, v2
    s_cbranch_vccnz kf_rt_l
    s_mov_b64 exec, -1
    s_branch kf_rt_ret
    s_nop 0
kf_rf_l:
    s_mov_b32 s92, 200000
kf_rf_l_l:
    s_mov_b64 exec, vcc
    s_mov_b32 s7, 2228224
    buffer_load_dword v252, v4, s[16:19], s7 offen sc1
    s_sub_u32 s92, s92, 1
    s_cbranch_scc1 kf_end
    s_waitcnt vmcnt(0)
    v_cmp_ne_u32 vcc, s59, v252
    s_cbranch_vccnz kf_rf_l_l
    s_mov_b64 exec, -1
    s_branch kf_rf_l_ret
    s_nop 0
kf_hr0:
    s_mov_b32 s92, 200000
kf_hr0_l:
    s_mov_b64 exec, vcc
    s_sleep 1
    s_mov_b64 exec, -1
    s_add_u32 s8, s21, 0
    buffer_load_dwordx4 v[64:67], v4, s[16:19], s8 offen sc1
    s_add_u32 s8, s21, 2048
    buffer_load_dwordx4 v[68:71], v4, s[16:19], s8 offen sc1
    s_add_u32 s8, s21, 4096
    buffer_load_dwordx4 v[72:75], v4, s[16:19], s8 offen sc1
    s_add_u32 s8, s21, 6144
    buffer_load_dwordx4 v[76:79], v4, s[16:19], s8 offen sc1
    s_add_u32 s8, s21, 16384
    buffer_load_dwordx4 v[80:83], v4, s[16:19], s8 offen sc1
    s_add_u32 s8, s21, 18432
    buffer_load_dwordx4 v[84:87], v4, s[16:19], s8 offen sc1
    s_sub_u32 s92, s92, 1
    s_cbranch_scc1 kf_end
    s_waitcnt vmcnt(0)
    v_cmp_eq_u32 vcc, -1, v64
    s_cbranch_vccnz kf_hr0_l
    s_mov_b64 exec, -1
    s_branch kf_hr0_ret
kf_hr1:
    s_mov_b32 s92, 200000
kf_hr1_l:
    s_mov_b64 exec, vcc
    s_sleep 1
    s_mov_b64 exec, -1
    s_add_u32 s8, s21, 2048
    buffer_load_dwordx4 v[68:71], v4, s[16:19], s8 offen sc1
    s_add_u32 s8, s21, 4096
    buffer_load_dwordx4 v[72:75], v4, s[16:19], s8 offen sc1
    s_add_u32 s8, s21, 6144
    buffer_load_dwordx4 v[76:79], v4, s[16:19], s8 offen sc1
    s_add_u32 s8, s21, 16384
    buffer_load_dwordx4 v[80:83], v4, s[16:19], s8 offen sc1
    s_add_u32 s8, s21, 18432
    buffer_load_dwordx4 v[84:87], v4, s[16:19], s8 offen sc1
    s_sub_u32 s92, s92, 1
    s_cbranch_scc1 kf_end
    s_waitcnt vmcnt(0)
    v_cmp_eq_u32 vcc, -1, v68
    s_cbranch_vccnz kf_hr1_l
    s_mov_b64 exec, -1
    s_branch kf_hr1_ret
kf_hr2:
    s_mov_b32 s92, 200000
kf_hr2_l:
    s_mov_b64 exec, vcc
    s_sleep 1
    s_mov_b64 exec, -1
    s_add_u32 s8, s21, 4096
    buffer_load_dwordx4 v[72:75], v4, s[16:19], s8 offen sc1
    s_add_u32 s8, s21, 6144
    buffer_load_dwordx4 v[76:79], v4, s[16:19], s8 offen sc1
    s_add_u32 s8, s21, 16384
    buffer_load_dwordx4 v[80:83], v4, s[16:19], s8 offen sc1
    s_add_u32 s8, s21, 18432
    buffer_load_dwordx4 v[84:87], v4, s[16:19], s8 offen sc1
    s_sub_u32 s92, s92, 1
    s_cbranch_scc1 kf_end
    s_waitcnt vmcnt(0)
    v_cmp_eq_u32 vcc, -1, v72
    s_cbranch_vccnz kf_hr2_l
    s_mov_b64 exec, -1
    s_branch kf_hr2_ret
kf_hr3:
    s_mov_b32 s92, 200000
kf_hr3_l:
    s_mov_b64 exec, vcc
    s_sleep 1
    s_mov_b64 exec, -1
    s_add_u32 s8, s21, 6144
    buffer_load_dwordx4 v[76:79], v4, s[16:19], s8 offen sc1
    s_add_u32 s8, s21, 16384
    buffer_load_dwordx4 v[80:83], v4, s[16:19], s8 offen sc1
    s_add_u32 s8, s21, 18432
    buffer_load_dwordx4 v[84:87], v4, s[16:19], s8 offen sc1
    s_sub_u32 s92, s92, 1
    s_cbranch_scc1 kf_end
    s_waitcnt vmcnt(0)
    v_cmp_eq_u32 vcc, -1, v76
    s_cbranch_vccnz kf_hr3_l
    s_mov_b64 exec, -1
    s_branch kf_hr3_ret
kf_hr4:
    s_mov_b32 s92, 200000
kf_hr4_l:
    s_mov_b64 exec, vcc
    s_sleep 1
    s_mov_b64 exec, -1
    s_add_u32 s8, s21, 16384
    buffer_load_dwordx4 v[80:83], v4, s[16:19], s8 offen sc1
    s_add_u32 s8, s21, 18432
    buffer_load_dwordx4 v[84:87], v4, s[16:19], s8 offen sc1
    s_sub_u32 s92, s92, 1
    s_cbranch_scc1 kf_end
    s_waitcnt vmcnt(0)
    v_cmp_eq_u32 vcc, -1, v80
    s_cbranch_vccnz kf_hr4_l
    s_mov_b64 exec, -1
    s_branch kf_hr4_ret
kf_hr5:
    s_mov_b32 s92, 200000
kf_hr5_l:
    s_mov_b64 exec, vcc
    s_sleep 1
    s_mov_b64 exec, -1
    s_add_u32 s8, s21, 18432
    buffer_load_dwordx4 v[84:87], v4, s[16:19], s8 offen sc1
    s_sub_u32 s92, s92, 1
    s_cbranch_scc1 kf_end
    s_waitcnt vmcnt(0)
    v_cmp_eq_u32 vcc, -1, v84
    s_cbranch_vccnz kf_hr5_l
    s_mov_b64 exec, -1
    s_branch kf_hr5_ret
kf_hr6:
    s_mov_b32 s92, 200000
kf_hr6_l:
    s_mov_b64 exec, vcc
    s_sleep 1
    s_mov_b64 exec, -1
    s_add_u32 s8, s21, 20480
    buffer_load_dwordx4 v[88:91], v4, s[16:19], s8 offen sc1
    s_add_u32 s8, s21, 22528
    buffer_load_dwordx4 v[92:95], v4, s[16:19], s8 offen sc1
    s_add_u32 s8, s21, 32768
    buffer_load_dwordx4 v[96:99], v4, s[16:19], s8 offen sc1
    s_add_u32 s8, s21, 34816
    buffer_load_dwordx4 v[100:103], v4, s[16:19], s8 offen sc1
    s_add_u32 s8, s21, 36864
    buffer_load_dwordx4 v[104:107], v4, s[16:19], s8 offen sc1
    s_add_u32 s8, s21, 38912
    buffer_load_dwordx4 v[108:111], v4, s[16:19], s8 offen sc1
    s_add_u32 s8, s21, 49152
    buffer_load_dwordx4 v[112:115], v4, s[16:19], s8 offen sc1
    s_add_u32 s8, s21, 51200
    buffer_load_dwordx4 v[116:119], v4, s[16:19], s8 offen sc1
    s_sub_u32 s92, s92, 1
    s_cbranch_scc1 kf_end
    s_waitcnt vmcnt(0)
    v_cmp_eq_u32 vcc, -1, v88
    s_cbranch_vccnz kf_hr6_l
    s_mov_b64 exec, -1
    s_branch kf_hr6_ret
kf_hr7:
    s_mov_b32 s92, 200000
kf_hr7_l:
    s_mov_b64 exec, vcc
    s_sleep 1
    s_mov_b64 exec, -1
    s_add_u32 s8, s21, 22528
    buffer_load_dwordx4 v[92:95], v4, s[16:19], s8 offen sc1
    s_add_u32 s8, s21, 32768
    buffer_load_dwordx4 v[96:99], v4, s[16:19], s8 offen sc1
    s_add_u32 s8, s21, 34816
    buffer_load_dwordx4 v[100:103], v4, s[16:19], s8 offen sc1
    s_add_u32 s8, s21, 36864
    buffer_load_dwordx4 v[104:107], v4, s[16:19], s8 offen sc1
    s_add_u32 s8, s21, 38912
    buffer_load_dwordx4 v[108:111], v4, s[16:19], s8 offen sc1
    s_add_u32 s8, s21, 49152
    buffer_load_dwordx4 v[112:115], v4, s[16:19], s8 offen sc1
    s_add_u32 s8, s21, 51200
    buffer_load_dwordx4 v[116:119], v4, s[16:19], s8 offen sc1
    s_sub_u32 s92, s92, 1
    s_cbranch_scc1 kf_end
    s_waitcnt vmcnt(0)
    v_cmp_eq_u32 vcc, -1, v92
    s_cbranch_vccnz kf_hr7_l
    s_mov_b64 exec, -1
    s_branch kf_hr7_ret
kf_hr8:
    s_mov_b32 s92, 200000
kf_hr8_l:
    s_mov_b64 exec, vcc
    s_sleep 1
    s_mov_b64 exec, -1
    s_add_u32 s8, s21, 32768
    buffer_load_dwordx4 v[96:99], v4, s[16:19], s8 offen sc1
    s_add_u32 s8, s21, 34816
    buffer_load_dwordx4 v[100:103], v4, s[16:19], s8 offen sc1
    s_add_u32 s8, s21, 36864
    buffer_load_dwordx4 v[104:107], v4, s[16:19], s8 offen sc1
    s_add_u32 s8, s21, 38912
    buffer_load_dwordx4 v[108:111], v4, s[16:19], s8 offen sc1
    s_add_u32 s8, s21, 49152
    buffer_load_dwordx4 v[112:115], v4, s[16:19], s8 offen sc1
    s_add_u32 s8, s21, 51200
    buffer_load_dwordx4 v[116:119], v4, s[16:19], s8 offen sc1
    s_sub_u32 s92, s92, 1
    s_cbranch_scc1 kf_end
    s_waitcnt vmcnt(0)
    v_cmp_eq_u32 vcc, -1, v96
    s_cbranch_vccnz kf_hr8_l
    s_mov_b64 exec, -1
    s_branch kf_hr8_ret
kf_hr9:
    s_mov_b32 s92, 200000
kf_hr9_l:
    s_mov_b64 exec, vcc
    s_sleep 1
    s_mov_b64 exec, -1
    s_add_u32 s8, s21, 34816
    buffer_load_dwordx4 v[100:103], v4, s[16:19], s8 offen sc1
    s_add_u32 s8, s21, 36864
    buffer_load_dwordx4 v[104:107], v4, s[16:19], s8 offen sc1
    s_add_u32 s8, s21, 38912
    buffer_load_dwordx4 v[108:111], v4, s[16:19], s8 offen sc1
    s_add_u32 s8, s21, 49152
    buffer_load_dwordx4 v[112:115], v4, s[16:19], s8 offen sc1
    s_add_u32 s8, s21, 51200
    buffer_load_dwordx4 v[116:119], v4, s[16:19], s8 offen sc1
    s_sub_u32 s92, s92, 1
    s_cbranch_scc1 kf_end
    s_waitcnt vmcnt(0)
    v_cmp_eq_u32 vcc, -1, v100
    s_cbranch_vccnz kf_hr9_l
    s_mov_b64 exec, -1
    s_branch kf_hr9_ret
kf_hr10:
    s_mov_b32 s92, 200000
kf_hr10_l:
    s_mov_b64 exec, vcc
    s_sleep 1
    s_mov_b64 exec, -1
    s_add_u32 s8, s21, 36864
    buffer_load_dwordx4 v[104:107], v4, s[16:19], s8 offen sc1
    s_add_u32 s8, s21, 38912
    buffer_load_dwordx4 v[108:111], v4, s[16:19], s8 offen sc1
    s_add_u32 s8, s21, 49152
    buffer_load_dwordx4 v[112:115], v4, s[16:19], s8 offen sc1
    s_add_u32 s8, s21, 51200
    buffer_load_dwordx4 v[116:119], v4, s[16:19], s8 offen sc1
    s_sub_u32 s92, s92, 1
    s_cbranch_scc1 kf_end
    s_waitcnt vmcnt(0)
    v_cmp_eq_u32 vcc, -1, v104
    s_cbranch_vccnz kf_hr10_l
    s_mov_b64 exec, -1
    s_branch kf_hr10_ret
kf_hr11:
    s_mov_b32 s92, 200000
kf_hr11_l:
    s_mov_b64 exec, vcc
    s_sleep 1
    s_mov_b64 exec, -1
    s_add_u32 s8, s21, 38912
    buffer_load_dwordx4 v[108:111], v4, s[16:19], s8 offen sc1
    s_add_u32 s8, s21, 49152
    buffer_load_dwordx4 v[112:115], v4, s[16:19], s8 offen sc1
    s_add_u32 s8, s21, 51200
    buffer_load_dwordx4 v[116:119], v4, s[16:19], s8 offen sc1
    s_sub_u32 s92, s92, 1
    s_cbranch_scc1 kf_end
    s_waitcnt vmcnt(0)
    v_cmp_eq_u32 vcc, -1, v108
    s_cbranch_vccnz kf_hr11_l
    s_mov_b64 exec, -1
    s_branch kf_hr11_ret
kf_hr12:
    s_mov_b32 s92, 200000
kf_hr12_l:
    s_mov_b64 exec, vcc
    s_sleep 1
    s_mov_b64 exec, -1
    s_add_u32 s8, s21, 49152
    buffer_load_dwordx4 v[112:115], v4, s[16:19], s8 offen sc1
    s_add_u32 s8, s21, 51200
    buffer_load_dwordx4 v[116:119], v4, s[16:19], s8 offen sc1
    s_sub_u32 s92, s92, 1
    s_cbranch_scc1 kf_end
    s_waitcnt vmcnt(0)
    v_cmp_eq_u32 vcc, -1, v112
    s_cbranch_vccnz kf_hr12_l
    s_mov_b64 exec, -1
    s_branch kf_hr12_ret
kf_hr13:
    s_mov_b32 s92, 200000
kf_hr13_l:
    s_mov_b64 exec, vcc
    s_sleep 1
    s_mov_b64 exec, -1
    s_add_u32 s8, s21, 51200
    buffer_load_dwordx4 v[116:119], v4, s[16:19], s8 offen sc1
    s_sub_u32 s92, s92, 1
    s_cbranch_scc1 kf_end
    s_waitcnt vmcnt(0)
    v_cmp_eq_u32 vcc, -1, v116
    s_cbranch_vccnz kf_hr13_l
    s_mov_b64 exec, -1
    s_branch kf_hr13_ret
kf_end:
    s_endpgm
code_end:
.section .rodata,"a"
.p2align 6
.amdhsa_kernel adaLN_cond__ssm_conv_s4__glu_gated_reglu__prompt_kernel
  .amdhsa_next_free_vgpr 512
  .amdhsa_next_free_sgpr 102
  .amdhsa_accum_offset 256
  .amdhsa_group_segment_fixed_size 0
  .amdhsa_kernarg_size 144
  .amdhsa_user_sgpr_count 2
  .amdhsa_user_sgpr_kernarg_segment_ptr 1
  .amdhsa_system_sgpr_workgroup_id_x 1
.end_amdhsa_kernel
```
